```python
import torch

def _softmax(x, axis=-1):
    return torch.softmax(x, dim=axis)

def _gelu(x):
    return torch.nn.functional.gelu(x, approximate='tanh')

def _silu(x):
    return torch.nn.functional.silu(x)

def _sigmoid(x):
    return torch.sigmoid(x)

def _layernorm(x, axis=-1, eps=1e-05):
    m = x.mean(dim=axis, keepdim=True)
    v = x.var(dim=axis, keepdim=True, unbiased=False)
    return (x - m) / torch.sqrt(v + eps)

def _scatter_add(tgt, idx, src, axis=0):
    return tgt.clone().index_add_(axis, idx, src)

def _segment_sum(src, seg, n):
    out = torch.zeros((n,) + src.shape[1:], dtype=src.dtype)
    return out.index_add_(0, seg, src)

def _pad(x, pw):
    flat = tuple((v for pair in reversed(pw) for v in pair))
    return torch.nn.functional.pad(x, flat)
kernel_name = 'sequential_preLN__grouped_kv_mqa__mixer_gmlp__prompt'

def setup_inputs():

    _w = lambda a: (lambda t: t.to(torch.bfloat16) if t.is_floating_point() else t)(torch.as_tensor(a))

    def _A_setup():
        B, S, D, H = (1, 2048, 512, 32)
        Dh = D // H
        return {'x': _w((lambda *s: torch.randn(*s, dtype=torch.bfloat16) * 0.05)(B, S, D)), 'wq': _w((lambda *s: torch.randn(*s, dtype=torch.bfloat16) * 0.05)(D, H * Dh)), 'wk': _w((lambda *s: torch.randn(*s, dtype=torch.bfloat16) * 0.05)(D, Dh)), 'wv': _w((lambda *s: torch.randn(*s, dtype=torch.bfloat16) * 0.05)(D, Dh)), 'wo': _w((lambda *s: torch.randn(*s, dtype=torch.bfloat16) * 0.05)(H * Dh, D))}
    _A_in = _A_setup()

    def _B_setup():
        B, S, D, F = (1, 2048, 512, 1792)
        Fh = F // 2
        return {'x': _w((lambda *s: torch.randn(*s, dtype=torch.bfloat16) * 0.05)(B, S, D)), 'w_in': _w((lambda *s: torch.randn(*s, dtype=torch.bfloat16) * 0.8)(D, 2 * Fh)), 'w_sp': _w(0.01 * (lambda *s: torch.randn(*s, dtype=torch.bfloat16) * 0.8)(S, S)), 'b_sp': _w(1.0 + 0.01 * (lambda *s: torch.randn(*s, dtype=torch.bfloat16) * 0.05)(S)), 'w_out': _w((lambda *s: torch.randn(*s, dtype=torch.bfloat16) * 0.05)(Fh, D))}
    _B_in = _B_setup()
    return {'A_x': _A_in['x'], 'A_wq': _A_in['wq'], 'A_wk': _A_in['wk'], 'A_wv': _A_in['wv'], 'A_wo': _A_in['wo'], 'B_x': _B_in['x'], 'B_w_in': _B_in['w_in'], 'B_w_sp': _B_in['w_sp'], 'B_b_sp': _B_in['b_sp'], 'B_w_out': _B_in['w_out']}

def reference(A_x, A_wq, A_wk, A_wv, A_wo, B_x, B_w_in, B_w_sp, B_b_sp, B_w_out):

    def _A_ref(x, wq, wk, wv, wo):
        B, S, D = x.shape
        H = 32
        Dh = D // H
        q = (lambda x, *d: x.permute(*d))((x @ wq).reshape(B, S, H, Dh), 0, 2, 1, 3)
        k = x @ wk
        v = x @ wv
        scores = torch.einsum('bhqd,bkd->bhqk', q, k) * Dh ** (-0.5)
        p = _softmax(scores, axis=-1)
        o = torch.einsum('bhqk,bkd->bhqd', p, v)
        return (lambda x, *d: x.permute(*d))(o, 0, 2, 1, 3).reshape(B, S, H * Dh) @ wo

    def _B_ref(x, w_in, w_sp, b_sp, w_out):
        B, S, D = x.shape
        F = w_in.shape[-1]
        Fh = F // 2
        z = _gelu(torch.einsum('bsd,df->bsf', x, w_in))
        z1 = z[..., :Fh].clone()
        z2 = _layernorm(z[..., Fh:], axis=-1)
        g = torch.einsum('ts,bsf->btf', w_sp, z2) + b_sp[None, :, None]
        return torch.einsum('bsf,fd->bsd', z1 * g, w_out)
    x = A_x
    h = x + _A_ref(_layernorm(x, axis=-1), A_wq, A_wk, A_wv, A_wo)
    h2 = h + _B_ref(_layernorm(h, axis=-1), B_w_in, B_w_sp, B_b_sp, B_w_out)
    return h2
```

```asm
; @launch grid=(256,1,1) block=(512,1,1) lds=163840
.amdgcn_target "amdgcn-amd-amdhsa--gfx950"
.text
.globl sequential_preLN__grouped_kv_mqa__mixer_gmlp__prompt_kernel
.p2align 8
.type sequential_preLN__grouped_kv_mqa__mixer_gmlp__prompt_kernel,@function
sequential_preLN__grouped_kv_mqa__mixer_gmlp__prompt_kernel:
sequential_preLN__grouped_kv_mqa__mixer_gmlp__prompt_kernel_codebeg:
    s_load_dwordx16 s[16:31], s[0:1], 0
    s_load_dwordx8 s[32:39], s[0:1], 64
    s_load_dwordx2 s[40:41], s[0:1], 96
    s_cmp_ge_u32 s2, 256
    s_cbranch_scc1 sequential_preLN__grouped_kv_mqa__mixer_gmlp__prompt_kernel_end
    v_lshrrev_b32 v1, 6, v0
    s_nop 0
    v_readfirstlane_b32 s44, v1
    v_and_b32 v1, 63, v0
    s_and_b32 s52, s2, 7
    s_lshr_b32 s53, s2, 3
    s_lshl_b32 s45, s52, 2
    s_lshr_b32 s46, s53, 2
    s_and_b32 s53, s53, 3
    s_add_u32 s45, s45, s53
    s_lshl_b32 s47, s45, 6
    s_sub_u32 s51, s44, 4
    s_and_b32 s77, s2, 1
    s_lshl_b32 s77, s77, 2
    s_lshr_b32 s76, s2, 6
    s_add_u32 s77, s77, s76
    s_bfe_u32 s76, s2, 0x20001
    s_lshl_b32 s76, s76, 3
    s_bfe_u32 s78, s2, 0x30003
    s_add_u32 s76, s76, s78
    s_lshl_b32 s78, s76, 6
    v_lshlrev_b32 v6, 4, v1
    s_cmp_ge_u32 s44, 4
    s_cbranch_scc1 sequential_preLN__grouped_kv_mqa__mixer_gmlp__prompt_kernel_loader
    s_and_b32 s79, s44, 1
    s_lshr_b32 s80, s44, 1
    s_mov_b32 s81, 0x3727c5ac
    v_and_b32 v2, 15, v1
    v_lshrrev_b32 v3, 4, v1
    v_lshrrev_b32 v4, 1, v2
    s_lshl_b32 s5, s79, 12
    v_add_u32 v5, 0, v3
    v_xor_b32 v5, v5, v4
    v_lshlrev_b32 v5, 4, v5
    v_lshl_add_u32 v5, v2, 7, v5
    v_add_u32 v5, s5, v5
    v_add_u32 v120, 0, v5
    v_add_u32 v5, 4, v3
    v_xor_b32 v5, v5, v4
    v_lshlrev_b32 v5, 4, v5
    v_lshl_add_u32 v5, v2, 7, v5
    v_add_u32 v5, s5, v5
    v_add_u32 v121, 0, v5
    v_lshrrev_b32 v4, 2, v2
    v_and_b32 v2, 3, v2
    v_lshl_add_u32 v5, v3, 3, v4
    v_lshlrev_b32 v5, 7, v5
    v_lshl_add_u32 v5, v2, 3, v5
    v_and_b32 v3, 1, v3
    v_lshrrev_b32 v4, 1, v4
    v_lshl_or_b32 v4, v3, 1, v4
    s_mul_i32 s5, s80, 2
    v_mov_b32 v2, s5
    v_xor_b32 v2, v2, v4
    v_lshl_add_u32 v2, v2, 5, v5
    v_add_u32 v122, 65536, v2
    v_mov_b32 v2, s5
    v_add_u32 v2, 1, v2
    v_xor_b32 v2, v2, v4
    v_lshl_add_u32 v2, v2, 5, v5
    v_add_u32 v123, 65536, v2
    v_lshrrev_b32 v2, 4, v1
    v_and_b32 v3, 15, v1
    v_lshrrev_b32 v4, 2, v3
    v_and_b32 v3, 3, v3
    v_lshl_add_u32 v4, v2, 3, v4
    v_and_b32 v2, 1, v2
    v_xor_b32 v5, 0, v2
    v_lshl_add_u32 v5, v5, 2, v4
    v_lshlrev_b32 v5, 5, v5
    v_lshl_add_u32 v5, v3, 3, v5
    v_add_u32 v124, 131072, v5
    v_xor_b32 v5, 1, v2
    v_lshl_add_u32 v5, v5, 2, v4
    v_lshlrev_b32 v5, 5, v5
    v_lshl_add_u32 v5, v3, 3, v5
    v_add_u32 v125, 131072, v5
    v_mov_b32 v40, 0
    v_mov_b32 v41, 0
    v_mov_b32 v42, 0
    v_mov_b32 v43, 0
    v_mov_b32 v44, 0
    v_mov_b32 v45, 0
    v_mov_b32 v46, 0
    v_mov_b32 v47, 0
    v_mov_b32 v48, 0
    v_mov_b32 v49, 0
    v_mov_b32 v50, 0
    v_mov_b32 v51, 0
    v_mov_b32 v52, 0
    v_mov_b32 v53, 0
    v_mov_b32 v54, 0
    v_mov_b32 v55, 0
    v_mov_b32 v128, 0x3f803f80
    v_mov_b32 v129, 0x3f803f80
    v_mov_b32 v130, 0x3f803f80
    v_mov_b32 v131, 0x3f803f80
    v_mov_b32 v132, 0
    v_mov_b32 v133, 0
    v_mov_b32 v134, 0
    v_mov_b32 v135, 0
    v_mov_b32 v136, 0
    v_mov_b32 v137, 0
    v_mov_b32 v138, 0
    v_mov_b32 v139, 0
    v_mov_b32 v140, 0
    v_mov_b32 v141, 0
    v_mov_b32 v142, 0
    v_mov_b32 v143, 0
    v_mov_b32 v144, 0
    v_mov_b32 v145, 0
    v_mov_b32 v146, 0
    v_mov_b32 v147, 0
    v_mov_b32 v148, 0
    v_mov_b32 v149, 0
    v_mov_b32 v150, 0
    v_mov_b32 v151, 0
    v_mov_b32 v168, 0
    v_mov_b32 v170, 0
    v_mov_b32 v169, 0
    v_mov_b32 v171, 0
    v_lshlrev_b32 v2, 2, v0
    v_add_u32 v2, 156672, v2
    v_mov_b32 v3, 0
    ds_write_b32 v2, v3
    s_lshl_b32 s84, s80, 1
    s_lshl_b32 s4, s46, 2
    s_add_u32 s84, s84, s4
    s_lshl_b32 s4, s45, 1
    s_add_u32 s87, s79, s4
    s_lshl_b32 s82, s45, 7
    s_lshl_b32 s88, s76, 7
    s_and_b32 s4, s46, 3
    s_cmp_lg_u32 s4, 0
    s_cbranch_scc1 sequential_preLN__grouped_kv_mqa__mixer_gmlp__prompt_kernel_qonly
    s_barrier
    ds_read_b128 v[56:59], v120 offset:0
    ds_read_b128 v[60:63], v120 offset:2048
    ds_read_b64_tr_b16 v[152:153], v124 offset:0
    ds_read_b64_tr_b16 v[154:155], v125 offset:0
    ds_read_b128 v[64:67], v121 offset:0
    ds_read_b128 v[68:71], v121 offset:2048
    ds_read_b64_tr_b16 v[156:157], v124 offset:1024
    ds_read_b64_tr_b16 v[158:159], v125 offset:1024
    s_waitcnt lgkmcnt(0)
    s_barrier
    v_mfma_f32_16x16x32_bf16 v[144:147], v[152:155], v[56:59], v[144:147]
    ds_read_b128 v[72:75], v120 offset:8192
    v_mfma_f32_16x16x32_bf16 v[148:151], v[152:155], v[60:63], v[148:151]
    ds_read_b128 v[76:79], v120 offset:10240
    v_mfma_f32_16x16x32_bf16 v[140:143], v[152:155], v[128:131], v[140:143]
    ds_read_b64_tr_b16 v[160:161], v124 offset:2048
    v_dot2_f32_bf16 v170, v56, v56, v170
    ds_read_b64_tr_b16 v[162:163], v125 offset:2048
    v_dot2_f32_bf16 v168, v56, v128, v168
    ds_read_b128 v[80:83], v121 offset:8192
    v_dot2_f32_bf16 v170, v57, v57, v170
    ds_read_b128 v[84:87], v121 offset:10240
    v_dot2_f32_bf16 v168, v57, v128, v168
    ds_read_b64_tr_b16 v[164:165], v124 offset:3072
    v_dot2_f32_bf16 v170, v58, v58, v170
    ds_read_b64_tr_b16 v[166:167], v125 offset:3072
    v_dot2_f32_bf16 v168, v58, v128, v168
    v_dot2_f32_bf16 v170, v59, v59, v170
    v_dot2_f32_bf16 v168, v59, v128, v168
    v_dot2_f32_bf16 v171, v60, v60, v171
    v_dot2_f32_bf16 v169, v60, v128, v169
    v_dot2_f32_bf16 v171, v61, v61, v171
    v_dot2_f32_bf16 v169, v61, v128, v169
    v_dot2_f32_bf16 v171, v62, v62, v171
    v_dot2_f32_bf16 v169, v62, v128, v169
    v_dot2_f32_bf16 v171, v63, v63, v171
    v_dot2_f32_bf16 v169, v63, v128, v169
    v_mfma_f32_16x16x32_bf16 v[144:147], v[156:159], v[64:67], v[144:147]
    v_mfma_f32_16x16x32_bf16 v[148:151], v[156:159], v[68:71], v[148:151]
    v_mfma_f32_16x16x32_bf16 v[140:143], v[156:159], v[128:131], v[140:143]
    v_dot2_f32_bf16 v170, v64, v64, v170
    v_dot2_f32_bf16 v168, v64, v128, v168
    v_dot2_f32_bf16 v170, v65, v65, v170
    v_dot2_f32_bf16 v168, v65, v128, v168
    v_dot2_f32_bf16 v170, v66, v66, v170
    v_dot2_f32_bf16 v168, v66, v128, v168
    v_dot2_f32_bf16 v170, v67, v67, v170
    v_dot2_f32_bf16 v168, v67, v128, v168
    v_dot2_f32_bf16 v171, v68, v68, v171
    v_dot2_f32_bf16 v169, v68, v128, v169
    v_dot2_f32_bf16 v171, v69, v69, v171
    v_dot2_f32_bf16 v169, v69, v128, v169
    v_dot2_f32_bf16 v171, v70, v70, v171
    v_dot2_f32_bf16 v169, v70, v128, v169
    v_dot2_f32_bf16 v171, v71, v71, v171
    v_dot2_f32_bf16 v169, v71, v128, v169
    s_waitcnt lgkmcnt(0)
    s_barrier
    v_mfma_f32_16x16x32_bf16 v[144:147], v[160:163], v[72:75], v[144:147]
    ds_read_b128 v[56:59], v120 offset:16384
    v_mfma_f32_16x16x32_bf16 v[148:151], v[160:163], v[76:79], v[148:151]
    ds_read_b128 v[60:63], v120 offset:18432
    v_mfma_f32_16x16x32_bf16 v[140:143], v[160:163], v[128:131], v[140:143]
    ds_read_b64_tr_b16 v[152:153], v124 offset:4096
    v_dot2_f32_bf16 v170, v72, v72, v170
    ds_read_b64_tr_b16 v[154:155], v125 offset:4096
    v_dot2_f32_bf16 v168, v72, v128, v168
    ds_read_b128 v[64:67], v121 offset:16384
    v_dot2_f32_bf16 v170, v73, v73, v170
    ds_read_b128 v[68:71], v121 offset:18432
    v_dot2_f32_bf16 v168, v73, v128, v168
    ds_read_b64_tr_b16 v[156:157], v124 offset:5120
    v_dot2_f32_bf16 v170, v74, v74, v170
    ds_read_b64_tr_b16 v[158:159], v125 offset:5120
    v_dot2_f32_bf16 v168, v74, v128, v168
    v_dot2_f32_bf16 v170, v75, v75, v170
    v_dot2_f32_bf16 v168, v75, v128, v168
    v_dot2_f32_bf16 v171, v76, v76, v171
    v_dot2_f32_bf16 v169, v76, v128, v169
    v_dot2_f32_bf16 v171, v77, v77, v171
    v_dot2_f32_bf16 v169, v77, v128, v169
    v_dot2_f32_bf16 v171, v78, v78, v171
    v_dot2_f32_bf16 v169, v78, v128, v169
    v_dot2_f32_bf16 v171, v79, v79, v171
    v_dot2_f32_bf16 v169, v79, v128, v169
    v_mfma_f32_16x16x32_bf16 v[144:147], v[164:167], v[80:83], v[144:147]
    v_mfma_f32_16x16x32_bf16 v[148:151], v[164:167], v[84:87], v[148:151]
    v_mfma_f32_16x16x32_bf16 v[140:143], v[164:167], v[128:131], v[140:143]
    v_dot2_f32_bf16 v170, v80, v80, v170
    v_dot2_f32_bf16 v168, v80, v128, v168
    v_dot2_f32_bf16 v170, v81, v81, v170
    v_dot2_f32_bf16 v168, v81, v128, v168
    v_dot2_f32_bf16 v170, v82, v82, v170
    v_dot2_f32_bf16 v168, v82, v128, v168
    v_dot2_f32_bf16 v170, v83, v83, v170
    v_dot2_f32_bf16 v168, v83, v128, v168
    v_dot2_f32_bf16 v171, v84, v84, v171
    v_dot2_f32_bf16 v169, v84, v128, v169
    v_dot2_f32_bf16 v171, v85, v85, v171
    v_dot2_f32_bf16 v169, v85, v128, v169
    v_dot2_f32_bf16 v171, v86, v86, v171
    v_dot2_f32_bf16 v169, v86, v128, v169
    v_dot2_f32_bf16 v171, v87, v87, v171
    v_dot2_f32_bf16 v169, v87, v128, v169
    s_waitcnt lgkmcnt(0)
    s_barrier
    v_mfma_f32_16x16x32_bf16 v[144:147], v[152:155], v[56:59], v[144:147]
    ds_read_b128 v[72:75], v120 offset:24576
    v_mfma_f32_16x16x32_bf16 v[148:151], v[152:155], v[60:63], v[148:151]
    ds_read_b128 v[76:79], v120 offset:26624
    v_mfma_f32_16x16x32_bf16 v[140:143], v[152:155], v[128:131], v[140:143]
    ds_read_b64_tr_b16 v[160:161], v124 offset:6144
    v_dot2_f32_bf16 v170, v56, v56, v170
    ds_read_b64_tr_b16 v[162:163], v125 offset:6144
    v_dot2_f32_bf16 v168, v56, v128, v168
    ds_read_b128 v[80:83], v121 offset:24576
    v_dot2_f32_bf16 v170, v57, v57, v170
    ds_read_b128 v[84:87], v121 offset:26624
    v_dot2_f32_bf16 v168, v57, v128, v168
    ds_read_b64_tr_b16 v[164:165], v124 offset:7168
    v_dot2_f32_bf16 v170, v58, v58, v170
    ds_read_b64_tr_b16 v[166:167], v125 offset:7168
    v_dot2_f32_bf16 v168, v58, v128, v168
    v_dot2_f32_bf16 v170, v59, v59, v170
    v_dot2_f32_bf16 v168, v59, v128, v168
    v_dot2_f32_bf16 v171, v60, v60, v171
    v_dot2_f32_bf16 v169, v60, v128, v169
    v_dot2_f32_bf16 v171, v61, v61, v171
    v_dot2_f32_bf16 v169, v61, v128, v169
    v_dot2_f32_bf16 v171, v62, v62, v171
    v_dot2_f32_bf16 v169, v62, v128, v169
    v_dot2_f32_bf16 v171, v63, v63, v171
    v_dot2_f32_bf16 v169, v63, v128, v169
    v_mfma_f32_16x16x32_bf16 v[144:147], v[156:159], v[64:67], v[144:147]
    v_mfma_f32_16x16x32_bf16 v[148:151], v[156:159], v[68:71], v[148:151]
    v_mfma_f32_16x16x32_bf16 v[140:143], v[156:159], v[128:131], v[140:143]
    v_dot2_f32_bf16 v170, v64, v64, v170
    v_dot2_f32_bf16 v168, v64, v128, v168
    v_dot2_f32_bf16 v170, v65, v65, v170
    v_dot2_f32_bf16 v168, v65, v128, v168
    v_dot2_f32_bf16 v170, v66, v66, v170
    v_dot2_f32_bf16 v168, v66, v128, v168
    v_dot2_f32_bf16 v170, v67, v67, v170
    v_dot2_f32_bf16 v168, v67, v128, v168
    v_dot2_f32_bf16 v171, v68, v68, v171
    v_dot2_f32_bf16 v169, v68, v128, v169
    v_dot2_f32_bf16 v171, v69, v69, v171
    v_dot2_f32_bf16 v169, v69, v128, v169
    v_dot2_f32_bf16 v171, v70, v70, v171
    v_dot2_f32_bf16 v169, v70, v128, v169
    v_dot2_f32_bf16 v171, v71, v71, v171
    v_dot2_f32_bf16 v169, v71, v128, v169
    s_waitcnt lgkmcnt(0)
    s_barrier
    v_mfma_f32_16x16x32_bf16 v[144:147], v[160:163], v[72:75], v[144:147]
    ds_read_b128 v[56:59], v120 offset:32768
    v_mfma_f32_16x16x32_bf16 v[148:151], v[160:163], v[76:79], v[148:151]
    ds_read_b128 v[60:63], v120 offset:34816
    v_mfma_f32_16x16x32_bf16 v[140:143], v[160:163], v[128:131], v[140:143]
    ds_read_b64_tr_b16 v[152:153], v124 offset:8192
    v_dot2_f32_bf16 v170, v72, v72, v170
    ds_read_b64_tr_b16 v[154:155], v125 offset:8192
    v_dot2_f32_bf16 v168, v72, v128, v168
    ds_read_b128 v[64:67], v121 offset:32768
    v_dot2_f32_bf16 v170, v73, v73, v170
    ds_read_b128 v[68:71], v121 offset:34816
    v_dot2_f32_bf16 v168, v73, v128, v168
    ds_read_b64_tr_b16 v[156:157], v124 offset:9216
    v_dot2_f32_bf16 v170, v74, v74, v170
    ds_read_b64_tr_b16 v[158:159], v125 offset:9216
    v_dot2_f32_bf16 v168, v74, v128, v168
    v_dot2_f32_bf16 v170, v75, v75, v170
    v_dot2_f32_bf16 v168, v75, v128, v168
    v_dot2_f32_bf16 v171, v76, v76, v171
    v_dot2_f32_bf16 v169, v76, v128, v169
    v_dot2_f32_bf16 v171, v77, v77, v171
    v_dot2_f32_bf16 v169, v77, v128, v169
    v_dot2_f32_bf16 v171, v78, v78, v171
    v_dot2_f32_bf16 v169, v78, v128, v169
    v_dot2_f32_bf16 v171, v79, v79, v171
    v_dot2_f32_bf16 v169, v79, v128, v169
    v_mfma_f32_16x16x32_bf16 v[144:147], v[164:167], v[80:83], v[144:147]
    v_mfma_f32_16x16x32_bf16 v[148:151], v[164:167], v[84:87], v[148:151]
    v_mfma_f32_16x16x32_bf16 v[140:143], v[164:167], v[128:131], v[140:143]
    v_dot2_f32_bf16 v170, v80, v80, v170
    v_dot2_f32_bf16 v168, v80, v128, v168
    v_dot2_f32_bf16 v170, v81, v81, v170
    v_dot2_f32_bf16 v168, v81, v128, v168
    v_dot2_f32_bf16 v170, v82, v82, v170
    v_dot2_f32_bf16 v168, v82, v128, v168
    v_dot2_f32_bf16 v170, v83, v83, v170
    v_dot2_f32_bf16 v168, v83, v128, v168
    v_dot2_f32_bf16 v171, v84, v84, v171
    v_dot2_f32_bf16 v169, v84, v128, v169
    v_dot2_f32_bf16 v171, v85, v85, v171
    v_dot2_f32_bf16 v169, v85, v128, v169
    v_dot2_f32_bf16 v171, v86, v86, v171
    v_dot2_f32_bf16 v169, v86, v128, v169
    v_dot2_f32_bf16 v171, v87, v87, v171
    v_dot2_f32_bf16 v169, v87, v128, v169
    s_waitcnt lgkmcnt(0)
    s_barrier
    v_mfma_f32_16x16x32_bf16 v[144:147], v[152:155], v[56:59], v[144:147]
    ds_read_b128 v[72:75], v120 offset:40960
    v_mfma_f32_16x16x32_bf16 v[148:151], v[152:155], v[60:63], v[148:151]
    ds_read_b128 v[76:79], v120 offset:43008
    v_mfma_f32_16x16x32_bf16 v[140:143], v[152:155], v[128:131], v[140:143]
    ds_read_b64_tr_b16 v[160:161], v124 offset:10240
    v_dot2_f32_bf16 v170, v56, v56, v170
    ds_read_b64_tr_b16 v[162:163], v125 offset:10240
    v_dot2_f32_bf16 v168, v56, v128, v168
    ds_read_b128 v[80:83], v121 offset:40960
    v_dot2_f32_bf16 v170, v57, v57, v170
    ds_read_b128 v[84:87], v121 offset:43008
    v_dot2_f32_bf16 v168, v57, v128, v168
    ds_read_b64_tr_b16 v[164:165], v124 offset:11264
    v_dot2_f32_bf16 v170, v58, v58, v170
    ds_read_b64_tr_b16 v[166:167], v125 offset:11264
    v_dot2_f32_bf16 v168, v58, v128, v168
    v_dot2_f32_bf16 v170, v59, v59, v170
    v_dot2_f32_bf16 v168, v59, v128, v168
    v_dot2_f32_bf16 v171, v60, v60, v171
    v_dot2_f32_bf16 v169, v60, v128, v169
    v_dot2_f32_bf16 v171, v61, v61, v171
    v_dot2_f32_bf16 v169, v61, v128, v169
    v_dot2_f32_bf16 v171, v62, v62, v171
    v_dot2_f32_bf16 v169, v62, v128, v169
    v_dot2_f32_bf16 v171, v63, v63, v171
    v_dot2_f32_bf16 v169, v63, v128, v169
    v_mfma_f32_16x16x32_bf16 v[144:147], v[156:159], v[64:67], v[144:147]
    v_mfma_f32_16x16x32_bf16 v[148:151], v[156:159], v[68:71], v[148:151]
    v_mfma_f32_16x16x32_bf16 v[140:143], v[156:159], v[128:131], v[140:143]
    v_dot2_f32_bf16 v170, v64, v64, v170
    v_dot2_f32_bf16 v168, v64, v128, v168
    v_dot2_f32_bf16 v170, v65, v65, v170
    v_dot2_f32_bf16 v168, v65, v128, v168
    v_dot2_f32_bf16 v170, v66, v66, v170
    v_dot2_f32_bf16 v168, v66, v128, v168
    v_dot2_f32_bf16 v170, v67, v67, v170
    v_dot2_f32_bf16 v168, v67, v128, v168
    v_dot2_f32_bf16 v171, v68, v68, v171
    v_dot2_f32_bf16 v169, v68, v128, v169
    v_dot2_f32_bf16 v171, v69, v69, v171
    v_dot2_f32_bf16 v169, v69, v128, v169
    v_dot2_f32_bf16 v171, v70, v70, v171
    v_dot2_f32_bf16 v169, v70, v128, v169
    v_dot2_f32_bf16 v171, v71, v71, v171
    v_dot2_f32_bf16 v169, v71, v128, v169
    s_mov_b32 s56, s38
    s_mov_b32 s57, s39
    s_mov_b32 s58, 256
    s_mov_b32 s59, 0x00020000
    v_mov_b32 v2, 0
    buffer_load_dword v172, v2, s[56:59], 0 offen sc1
    s_waitcnt lgkmcnt(0)
    s_barrier
    v_mfma_f32_16x16x32_bf16 v[144:147], v[160:163], v[72:75], v[144:147]
    ds_read_b128 v[56:59], v120 offset:49152
    v_mfma_f32_16x16x32_bf16 v[148:151], v[160:163], v[76:79], v[148:151]
    ds_read_b128 v[60:63], v120 offset:51200
    v_mfma_f32_16x16x32_bf16 v[140:143], v[160:163], v[128:131], v[140:143]
    ds_read_b64_tr_b16 v[152:153], v124 offset:12288
    v_dot2_f32_bf16 v170, v72, v72, v170
    ds_read_b64_tr_b16 v[154:155], v125 offset:12288
    v_dot2_f32_bf16 v168, v72, v128, v168
    ds_read_b128 v[64:67], v121 offset:49152
    v_dot2_f32_bf16 v170, v73, v73, v170
    ds_read_b128 v[68:71], v121 offset:51200
    v_dot2_f32_bf16 v168, v73, v128, v168
    ds_read_b64_tr_b16 v[156:157], v124 offset:13312
    v_dot2_f32_bf16 v170, v74, v74, v170
    ds_read_b64_tr_b16 v[158:159], v125 offset:13312
    v_dot2_f32_bf16 v168, v74, v128, v168
    v_dot2_f32_bf16 v170, v75, v75, v170
    v_dot2_f32_bf16 v168, v75, v128, v168
    v_dot2_f32_bf16 v171, v76, v76, v171
    v_dot2_f32_bf16 v169, v76, v128, v169
    v_dot2_f32_bf16 v171, v77, v77, v171
    v_dot2_f32_bf16 v169, v77, v128, v169
    v_dot2_f32_bf16 v171, v78, v78, v171
    v_dot2_f32_bf16 v169, v78, v128, v169
    v_dot2_f32_bf16 v171, v79, v79, v171
    v_dot2_f32_bf16 v169, v79, v128, v169
    v_mfma_f32_16x16x32_bf16 v[144:147], v[164:167], v[80:83], v[144:147]
    v_mfma_f32_16x16x32_bf16 v[148:151], v[164:167], v[84:87], v[148:151]
    v_mfma_f32_16x16x32_bf16 v[140:143], v[164:167], v[128:131], v[140:143]
    v_dot2_f32_bf16 v170, v80, v80, v170
    v_dot2_f32_bf16 v168, v80, v128, v168
    v_dot2_f32_bf16 v170, v81, v81, v170
    v_dot2_f32_bf16 v168, v81, v128, v168
    v_dot2_f32_bf16 v170, v82, v82, v170
    v_dot2_f32_bf16 v168, v82, v128, v168
    v_dot2_f32_bf16 v170, v83, v83, v170
    v_dot2_f32_bf16 v168, v83, v128, v168
    v_dot2_f32_bf16 v171, v84, v84, v171
    v_dot2_f32_bf16 v169, v84, v128, v169
    v_dot2_f32_bf16 v171, v85, v85, v171
    v_dot2_f32_bf16 v169, v85, v128, v169
    v_dot2_f32_bf16 v171, v86, v86, v171
    v_dot2_f32_bf16 v169, v86, v128, v169
    v_dot2_f32_bf16 v171, v87, v87, v171
    v_dot2_f32_bf16 v169, v87, v128, v169
    s_waitcnt lgkmcnt(0)
    s_barrier
    v_mfma_f32_16x16x32_bf16 v[144:147], v[152:155], v[56:59], v[144:147]
    ds_read_b128 v[72:75], v120 offset:57344
    v_mfma_f32_16x16x32_bf16 v[148:151], v[152:155], v[60:63], v[148:151]
    ds_read_b128 v[76:79], v120 offset:59392
    v_mfma_f32_16x16x32_bf16 v[140:143], v[152:155], v[128:131], v[140:143]
    ds_read_b64_tr_b16 v[160:161], v124 offset:14336
    v_dot2_f32_bf16 v170, v56, v56, v170
    ds_read_b64_tr_b16 v[162:163], v125 offset:14336
    v_dot2_f32_bf16 v168, v56, v128, v168
    ds_read_b128 v[80:83], v121 offset:57344
    v_dot2_f32_bf16 v170, v57, v57, v170
    ds_read_b128 v[84:87], v121 offset:59392
    v_dot2_f32_bf16 v168, v57, v128, v168
    ds_read_b64_tr_b16 v[164:165], v124 offset:15360
    v_dot2_f32_bf16 v170, v58, v58, v170
    ds_read_b64_tr_b16 v[166:167], v125 offset:15360
    v_dot2_f32_bf16 v168, v58, v128, v168
    v_dot2_f32_bf16 v170, v59, v59, v170
    v_dot2_f32_bf16 v168, v59, v128, v168
    v_dot2_f32_bf16 v171, v60, v60, v171
    v_dot2_f32_bf16 v169, v60, v128, v169
    v_dot2_f32_bf16 v171, v61, v61, v171
    v_dot2_f32_bf16 v169, v61, v128, v169
    v_dot2_f32_bf16 v171, v62, v62, v171
    v_dot2_f32_bf16 v169, v62, v128, v169
    v_dot2_f32_bf16 v171, v63, v63, v171
    v_dot2_f32_bf16 v169, v63, v128, v169
    v_mfma_f32_16x16x32_bf16 v[144:147], v[156:159], v[64:67], v[144:147]
    v_mfma_f32_16x16x32_bf16 v[148:151], v[156:159], v[68:71], v[148:151]
    v_mfma_f32_16x16x32_bf16 v[140:143], v[156:159], v[128:131], v[140:143]
    v_dot2_f32_bf16 v170, v64, v64, v170
    v_dot2_f32_bf16 v168, v64, v128, v168
    v_dot2_f32_bf16 v170, v65, v65, v170
    v_dot2_f32_bf16 v168, v65, v128, v168
    v_dot2_f32_bf16 v170, v66, v66, v170
    v_dot2_f32_bf16 v168, v66, v128, v168
    v_dot2_f32_bf16 v170, v67, v67, v170
    v_dot2_f32_bf16 v168, v67, v128, v168
    v_dot2_f32_bf16 v171, v68, v68, v171
    v_dot2_f32_bf16 v169, v68, v128, v169
    v_dot2_f32_bf16 v171, v69, v69, v171
    v_dot2_f32_bf16 v169, v69, v128, v169
    v_dot2_f32_bf16 v171, v70, v70, v171
    v_dot2_f32_bf16 v169, v70, v128, v169
    v_dot2_f32_bf16 v171, v71, v71, v171
    v_dot2_f32_bf16 v169, v71, v128, v169
    s_waitcnt lgkmcnt(0)
    v_mfma_f32_16x16x32_bf16 v[144:147], v[160:163], v[72:75], v[144:147]
    v_mfma_f32_16x16x32_bf16 v[148:151], v[160:163], v[76:79], v[148:151]
    v_mfma_f32_16x16x32_bf16 v[140:143], v[160:163], v[128:131], v[140:143]
    v_dot2_f32_bf16 v170, v72, v72, v170
    v_dot2_f32_bf16 v168, v72, v128, v168
    v_dot2_f32_bf16 v170, v73, v73, v170
    v_dot2_f32_bf16 v168, v73, v128, v168
    v_dot2_f32_bf16 v170, v74, v74, v170
    v_dot2_f32_bf16 v168, v74, v128, v168
    v_dot2_f32_bf16 v170, v75, v75, v170
    v_dot2_f32_bf16 v168, v75, v128, v168
    v_dot2_f32_bf16 v171, v76, v76, v171
    v_dot2_f32_bf16 v169, v76, v128, v169
    v_dot2_f32_bf16 v171, v77, v77, v171
    v_dot2_f32_bf16 v169, v77, v128, v169
    v_dot2_f32_bf16 v171, v78, v78, v171
    v_dot2_f32_bf16 v169, v78, v128, v169
    v_dot2_f32_bf16 v171, v79, v79, v171
    v_dot2_f32_bf16 v169, v79, v128, v169
    v_mfma_f32_16x16x32_bf16 v[144:147], v[164:167], v[80:83], v[144:147]
    v_mfma_f32_16x16x32_bf16 v[148:151], v[164:167], v[84:87], v[148:151]
    v_mfma_f32_16x16x32_bf16 v[140:143], v[164:167], v[128:131], v[140:143]
    v_dot2_f32_bf16 v170, v80, v80, v170
    v_dot2_f32_bf16 v168, v80, v128, v168
    v_dot2_f32_bf16 v170, v81, v81, v170
    v_dot2_f32_bf16 v168, v81, v128, v168
    v_dot2_f32_bf16 v170, v82, v82, v170
    v_dot2_f32_bf16 v168, v82, v128, v168
    v_dot2_f32_bf16 v170, v83, v83, v170
    v_dot2_f32_bf16 v168, v83, v128, v168
    v_dot2_f32_bf16 v171, v84, v84, v171
    v_dot2_f32_bf16 v169, v84, v128, v169
    v_dot2_f32_bf16 v171, v85, v85, v171
    v_dot2_f32_bf16 v169, v85, v128, v169
    v_dot2_f32_bf16 v171, v86, v86, v171
    v_dot2_f32_bf16 v169, v86, v128, v169
    v_dot2_f32_bf16 v171, v87, v87, v171
    v_dot2_f32_bf16 v169, v87, v128, v169
    s_mov_b32 s83, 0x40000
ep_sequential_preLN__grouped_kv_mqa__mixer_gmlp__prompt_kernel_1:
    s_waitcnt vmcnt(0)
    v_readfirstlane_b32 s26, v172
    s_nop 2
    s_cmp_lg_u32 s26, 0
    s_cbranch_scc1 epd_sequential_preLN__grouped_kv_mqa__mixer_gmlp__prompt_kernel_2
    s_sleep 2
    buffer_load_dword v172, v2, s[56:59], 0 offen sc1
    s_sub_u32 s83, s83, 1
    s_cmp_lg_u32 s83, 0
    s_cbranch_scc1 ep_sequential_preLN__grouped_kv_mqa__mixer_gmlp__prompt_kernel_1
epd_sequential_preLN__grouped_kv_mqa__mixer_gmlp__prompt_kernel_2:
    s_waitcnt vmcnt(0)
    v_mov_b32 v2, v168
    s_nop 1
    v_permlane16_swap_b32 v2, v168
    v_add_f32 v168, v168, v2
    v_mov_b32 v2, v168
    s_nop 1
    v_permlane32_swap_b32 v2, v168
    v_add_f32 v168, v168, v2
    v_mov_b32 v2, v170
    s_nop 1
    v_permlane16_swap_b32 v2, v170
    v_add_f32 v170, v170, v2
    v_mov_b32 v2, v170
    s_nop 1
    v_permlane32_swap_b32 v2, v170
    v_add_f32 v170, v170, v2
    v_mul_f32 v168, 0x3b000000, v168
    v_mul_f32 v170, 0x3b000000, v170
    v_fma_f32 v170, -v168, v168, v170
    v_max_f32 v170, 0, v170
    v_add_f32 v170, s81, v170
    v_rsq_f32 v170, v170
    v_mov_b32 v2, v169
    s_nop 1
    v_permlane16_swap_b32 v2, v169
    v_add_f32 v169, v169, v2
    v_mov_b32 v2, v169
    s_nop 1
    v_permlane32_swap_b32 v2, v169
    v_add_f32 v169, v169, v2
    v_mov_b32 v2, v171
    s_nop 1
    v_permlane16_swap_b32 v2, v171
    v_add_f32 v171, v171, v2
    v_mov_b32 v2, v171
    s_nop 1
    v_permlane32_swap_b32 v2, v171
    v_add_f32 v171, v171, v2
    v_mul_f32 v169, 0x3b000000, v169
    v_mul_f32 v171, 0x3b000000, v171
    v_fma_f32 v171, -v169, v169, v171
    v_max_f32 v171, 0, v171
    v_add_f32 v171, s81, v171
    v_rsq_f32 v171, v171
    v_fma_f32 v144, -v168, v140, v144
    v_mul_f32 v144, v170, v144
    v_fma_f32 v145, -v168, v141, v145
    v_mul_f32 v145, v170, v145
    v_fma_f32 v146, -v168, v142, v146
    v_mul_f32 v146, v170, v146
    v_fma_f32 v147, -v168, v143, v147
    v_mul_f32 v147, v170, v147
    v_fma_f32 v148, -v169, v140, v148
    v_mul_f32 v148, v171, v148
    v_fma_f32 v149, -v169, v141, v149
    v_mul_f32 v149, v171, v149
    v_fma_f32 v150, -v169, v142, v150
    v_mul_f32 v150, v171, v150
    v_fma_f32 v151, -v169, v143, v151
    v_mul_f32 v151, v171, v151
    s_add_u32 s72, s40, 2293760
    s_addc_u32 s73, s41, 0
    s_mov_b32 s74, 24576
    s_mov_b32 s75, 0x00020000
    s_cmp_lg_u32 s80, 0
    s_cbranch_scc1 sequential_preLN__grouped_kv_mqa__mixer_gmlp__prompt_kernel_kvdone
    v_mul_f32 v173, v144, v144
    v_fmac_f32 v173, v145, v145
    v_fmac_f32 v173, v146, v146
    v_fmac_f32 v173, v147, v147
    v_mov_b32 v2, v173
    s_nop 1
    v_permlane16_swap_b32 v2, v173
    v_add_f32 v173, v173, v2
    v_mov_b32 v2, v173
    s_nop 1
    v_permlane32_swap_b32 v2, v173
    v_add_f32 v173, v173, v2
    v_mul_f32 v174, v148, v148
    v_fmac_f32 v174, v149, v149
    v_fmac_f32 v174, v150, v150
    v_fmac_f32 v174, v151, v151
    v_mov_b32 v2, v174
    s_nop 1
    v_permlane16_swap_b32 v2, v174
    v_add_f32 v174, v174, v2
    v_mov_b32 v2, v174
    s_nop 1
    v_permlane32_swap_b32 v2, v174
    v_add_f32 v174, v174, v2
    v_max_f32 v173, v173, v174
    s_nop 1
    v_max_f32_dpp v173, v173, v173 row_ror:1 row_mask:0xf bank_mask:0xf
    s_nop 1
    v_max_f32_dpp v173, v173, v173 row_ror:2 row_mask:0xf bank_mask:0xf
    s_nop 1
    v_max_f32_dpp v173, v173, v173 row_ror:4 row_mask:0xf bank_mask:0xf
    s_nop 1
    v_max_f32_dpp v173, v173, v173 row_ror:8 row_mask:0xf bank_mask:0xf
    v_cvt_pk_bf16_f32 v176, v144, v145
    v_cvt_pk_bf16_f32 v177, v146, v147
    v_cvt_pk_bf16_f32 v178, v148, v149
    v_cvt_pk_bf16_f32 v179, v150, v151
    s_nop 0
    v_permlane16_swap_b32 v176, v178
    v_permlane16_swap_b32 v177, v179
    s_add_u32 s56, s40, 2097152
    s_addc_u32 s57, s41, 0
    s_mov_b32 s58, 131072
    s_mov_b32 s59, 0x00020000
    s_add_u32 s60, s40, 2228224
    s_addc_u32 s61, s41, 0
    s_mov_b32 s62, 512
    s_mov_b32 s63, 0x00020000
    s_lshl_b32 s6, s87, 10
    s_cmp_eq_u32 s46, 0
    s_cbranch_scc0 sequential_preLN__grouped_kv_mqa__mixer_gmlp__prompt_kernel_vstore
    buffer_store_dwordx4 v[176:179], v6, s[56:59], s6 offen sc1
    s_branch sequential_preLN__grouped_kv_mqa__mixer_gmlp__prompt_kernel_nstore
sequential_preLN__grouped_kv_mqa__mixer_gmlp__prompt_kernel_vstore:
    s_lshl_b32 s7, s44, 10
    s_add_u32 s7, s7, 159744
    v_and_b32 v3, 31, v1
    v_lshlrev_b32 v3, 5, v3
    v_lshrrev_b32 v4, 5, v1
    v_lshl_add_u32 v3, v4, 4, v3
    v_add_u32 v3, s7, v3
    ds_write_b128 v3, v[176:179]
    v_bfe_u32 v3, v1, 2, 2
    v_lshl_add_u32 v3, v4, 2, v3
    v_lshlrev_b32 v3, 5, v3
    v_and_b32 v4, 3, v1
    v_lshl_add_u32 v3, v4, 3, v3
    v_add_u32 v3, s7, v3
    s_waitcnt lgkmcnt(0)
    ds_read_b64_tr_b16 v[180:181], v3 offset:0
    ds_read_b64_tr_b16 v[182:183], v3 offset:256
    ds_read_b64_tr_b16 v[184:185], v3 offset:512
    ds_read_b64_tr_b16 v[186:187], v3 offset:768
    v_bfe_u32 v4, v1, 4, 1
    v_cmp_eq_u32 vcc, 1, v4
    v_lshlrev_b32 v2, 9, v4
    v_lshrrev_b32 v4, 5, v1
    v_lshl_add_u32 v2, v4, 8, v2
    v_and_b32 v4, 15, v1
    v_lshl_add_u32 v2, v4, 4, v2
    v_add_u32 v2, 0x10000, v2
    s_waitcnt lgkmcnt(0)
    v_cndmask_b32 v180, v180, v184, vcc
    v_cndmask_b32 v181, v181, v185, vcc
    v_cndmask_b32 v182, v182, v186, vcc
    v_cndmask_b32 v183, v183, v187, vcc
    buffer_store_dwordx4 v[180:183], v2, s[56:59], s6 offen sc1
sequential_preLN__grouped_kv_mqa__mixer_gmlp__prompt_kernel_nstore:
    s_lshl_b32 s6, s46, 4
    s_add_u32 s6, s6, s87
    s_lshl_b32 s6, s6, 2
    v_mov_b32 v2, 0
    s_mov_b64 exec, 1
    buffer_store_dword v173, v2, s[60:63], s6 offen sc1
    s_mov_b64 exec, -1
sequential_preLN__grouped_kv_mqa__mixer_gmlp__prompt_kernel_kvdone:
    s_barrier
    ds_read_b128 v[56:59], v120 offset:0
    ds_read_b128 v[60:63], v120 offset:2048
    ds_read_b64_tr_b16 v[88:89], v122 offset:0
    ds_read_b64_tr_b16 v[90:91], v122 offset:512
    ds_read_b64_tr_b16 v[92:93], v123 offset:0
    ds_read_b64_tr_b16 v[94:95], v123 offset:512
    ds_read_b128 v[64:67], v121 offset:0
    ds_read_b128 v[68:71], v121 offset:2048
    ds_read_b64_tr_b16 v[96:97], v122 offset:4096
    ds_read_b64_tr_b16 v[98:99], v122 offset:4608
    ds_read_b64_tr_b16 v[100:101], v123 offset:4096
    ds_read_b64_tr_b16 v[102:103], v123 offset:4608
    s_waitcnt lgkmcnt(0)
    v_mfma_f32_16x16x32_bf16 v[40:43], v[88:91], v[56:59], v[40:43]
    ds_read_b128 v[72:75], v120 offset:8192
    v_mfma_f32_16x16x32_bf16 v[48:51], v[88:91], v[60:63], v[48:51]
    ds_read_b128 v[76:79], v120 offset:10240
    v_mfma_f32_16x16x32_bf16 v[44:47], v[92:95], v[56:59], v[44:47]
    ds_read_b64_tr_b16 v[104:105], v122 offset:8192
    v_mfma_f32_16x16x32_bf16 v[52:55], v[92:95], v[60:63], v[52:55]
    ds_read_b64_tr_b16 v[106:107], v122 offset:8704
    v_mfma_f32_16x16x32_bf16 v[132:135], v[88:91], v[128:131], v[132:135]
    ds_read_b64_tr_b16 v[108:109], v123 offset:8192
    v_mfma_f32_16x16x32_bf16 v[136:139], v[92:95], v[128:131], v[136:139]
    ds_read_b64_tr_b16 v[110:111], v123 offset:8704
    v_mfma_f32_16x16x32_bf16 v[40:43], v[96:99], v[64:67], v[40:43]
    ds_read_b128 v[80:83], v121 offset:8192
    v_mfma_f32_16x16x32_bf16 v[48:51], v[96:99], v[68:71], v[48:51]
    ds_read_b128 v[84:87], v121 offset:10240
    v_mfma_f32_16x16x32_bf16 v[44:47], v[100:103], v[64:67], v[44:47]
    ds_read_b64_tr_b16 v[112:113], v122 offset:12288
    v_mfma_f32_16x16x32_bf16 v[52:55], v[100:103], v[68:71], v[52:55]
    ds_read_b64_tr_b16 v[114:115], v122 offset:12800
    v_mfma_f32_16x16x32_bf16 v[132:135], v[96:99], v[128:131], v[132:135]
    ds_read_b64_tr_b16 v[116:117], v123 offset:12288
    v_mfma_f32_16x16x32_bf16 v[136:139], v[100:103], v[128:131], v[136:139]
    ds_read_b64_tr_b16 v[118:119], v123 offset:12800
    s_waitcnt lgkmcnt(0)
    v_mfma_f32_16x16x32_bf16 v[40:43], v[104:107], v[72:75], v[40:43]
    ds_read_b128 v[56:59], v120 offset:16384
    v_mfma_f32_16x16x32_bf16 v[48:51], v[104:107], v[76:79], v[48:51]
    ds_read_b128 v[60:63], v120 offset:18432
    v_mfma_f32_16x16x32_bf16 v[44:47], v[108:111], v[72:75], v[44:47]
    ds_read_b64_tr_b16 v[88:89], v122 offset:16384
    v_mfma_f32_16x16x32_bf16 v[52:55], v[108:111], v[76:79], v[52:55]
    ds_read_b64_tr_b16 v[90:91], v122 offset:16896
    v_mfma_f32_16x16x32_bf16 v[132:135], v[104:107], v[128:131], v[132:135]
    ds_read_b64_tr_b16 v[92:93], v123 offset:16384
    v_mfma_f32_16x16x32_bf16 v[136:139], v[108:111], v[128:131], v[136:139]
    ds_read_b64_tr_b16 v[94:95], v123 offset:16896
    v_mfma_f32_16x16x32_bf16 v[40:43], v[112:115], v[80:83], v[40:43]
    ds_read_b128 v[64:67], v121 offset:16384
    v_mfma_f32_16x16x32_bf16 v[48:51], v[112:115], v[84:87], v[48:51]
    ds_read_b128 v[68:71], v121 offset:18432
    v_mfma_f32_16x16x32_bf16 v[44:47], v[116:119], v[80:83], v[44:47]
    ds_read_b64_tr_b16 v[96:97], v122 offset:20480
    v_mfma_f32_16x16x32_bf16 v[52:55], v[116:119], v[84:87], v[52:55]
    ds_read_b64_tr_b16 v[98:99], v122 offset:20992
    v_mfma_f32_16x16x32_bf16 v[132:135], v[112:115], v[128:131], v[132:135]
    ds_read_b64_tr_b16 v[100:101], v123 offset:20480
    v_mfma_f32_16x16x32_bf16 v[136:139], v[116:119], v[128:131], v[136:139]
    ds_read_b64_tr_b16 v[102:103], v123 offset:20992
    s_waitcnt lgkmcnt(0)
    v_mfma_f32_16x16x32_bf16 v[40:43], v[88:91], v[56:59], v[40:43]
    ds_read_b128 v[72:75], v120 offset:24576
    v_mfma_f32_16x16x32_bf16 v[48:51], v[88:91], v[60:63], v[48:51]
    ds_read_b128 v[76:79], v120 offset:26624
    v_mfma_f32_16x16x32_bf16 v[44:47], v[92:95], v[56:59], v[44:47]
    ds_read_b64_tr_b16 v[104:105], v122 offset:24576
    v_mfma_f32_16x16x32_bf16 v[52:55], v[92:95], v[60:63], v[52:55]
    ds_read_b64_tr_b16 v[106:107], v122 offset:25088
    v_mfma_f32_16x16x32_bf16 v[132:135], v[88:91], v[128:131], v[132:135]
    ds_read_b64_tr_b16 v[108:109], v123 offset:24576
    v_mfma_f32_16x16x32_bf16 v[136:139], v[92:95], v[128:131], v[136:139]
    ds_read_b64_tr_b16 v[110:111], v123 offset:25088
    v_mfma_f32_16x16x32_bf16 v[40:43], v[96:99], v[64:67], v[40:43]
    ds_read_b128 v[80:83], v121 offset:24576
    v_mfma_f32_16x16x32_bf16 v[48:51], v[96:99], v[68:71], v[48:51]
    ds_read_b128 v[84:87], v121 offset:26624
    v_mfma_f32_16x16x32_bf16 v[44:47], v[100:103], v[64:67], v[44:47]
    ds_read_b64_tr_b16 v[112:113], v122 offset:28672
    v_mfma_f32_16x16x32_bf16 v[52:55], v[100:103], v[68:71], v[52:55]
    ds_read_b64_tr_b16 v[114:115], v122 offset:29184
    v_mfma_f32_16x16x32_bf16 v[132:135], v[96:99], v[128:131], v[132:135]
    ds_read_b64_tr_b16 v[116:117], v123 offset:28672
    v_mfma_f32_16x16x32_bf16 v[136:139], v[100:103], v[128:131], v[136:139]
    ds_read_b64_tr_b16 v[118:119], v123 offset:29184
    s_cmp_lg_u32 s80, 0
    s_cbranch_scc1 kvsig_sequential_preLN__grouped_kv_mqa__mixer_gmlp__prompt_kernel_3
    s_waitcnt vmcnt(0)
    s_mov_b64 exec, 1
    v_mov_b32 v2, 156712
    v_mov_b32 v3, 1
    ds_add_rtn_u32 v4, v2, v3
    s_waitcnt lgkmcnt(0)
    v_readfirstlane_b32 s4, v4
    s_nop 2
    s_cmp_lg_u32 s4, 1
    s_cbranch_scc1 kvsig_sequential_preLN__grouped_kv_mqa__mixer_gmlp__prompt_kernel_3
    s_lshr_b32 s5, s46, 2
    s_lshl_b32 s5, s5, 2
    s_add_u32 s4, s82, s5
    s_add_u32 s4, s4, 20480
    v_mov_b32 v2, 0
    v_mov_b32 v3, s26
    buffer_store_dword v3, v2, s[72:75], s4 offen sc1
kvsig_sequential_preLN__grouped_kv_mqa__mixer_gmlp__prompt_kernel_3:
    s_mov_b64 exec, -1
    s_waitcnt lgkmcnt(0)
    v_mfma_f32_16x16x32_bf16 v[40:43], v[104:107], v[72:75], v[40:43]
    ds_read_b128 v[56:59], v120 offset:32768
    v_mfma_f32_16x16x32_bf16 v[48:51], v[104:107], v[76:79], v[48:51]
    ds_read_b128 v[60:63], v120 offset:34816
    v_mfma_f32_16x16x32_bf16 v[44:47], v[108:111], v[72:75], v[44:47]
    ds_read_b64_tr_b16 v[88:89], v122 offset:32768
    v_mfma_f32_16x16x32_bf16 v[52:55], v[108:111], v[76:79], v[52:55]
    ds_read_b64_tr_b16 v[90:91], v122 offset:33280
    v_mfma_f32_16x16x32_bf16 v[132:135], v[104:107], v[128:131], v[132:135]
    ds_read_b64_tr_b16 v[92:93], v123 offset:32768
    v_mfma_f32_16x16x32_bf16 v[136:139], v[108:111], v[128:131], v[136:139]
    ds_read_b64_tr_b16 v[94:95], v123 offset:33280
    v_mfma_f32_16x16x32_bf16 v[40:43], v[112:115], v[80:83], v[40:43]
    ds_read_b128 v[64:67], v121 offset:32768
    v_mfma_f32_16x16x32_bf16 v[48:51], v[112:115], v[84:87], v[48:51]
    ds_read_b128 v[68:71], v121 offset:34816
    v_mfma_f32_16x16x32_bf16 v[44:47], v[116:119], v[80:83], v[44:47]
    ds_read_b64_tr_b16 v[96:97], v122 offset:36864
    v_mfma_f32_16x16x32_bf16 v[52:55], v[116:119], v[84:87], v[52:55]
    ds_read_b64_tr_b16 v[98:99], v122 offset:37376
    v_mfma_f32_16x16x32_bf16 v[132:135], v[112:115], v[128:131], v[132:135]
    ds_read_b64_tr_b16 v[100:101], v123 offset:36864
    v_mfma_f32_16x16x32_bf16 v[136:139], v[116:119], v[128:131], v[136:139]
    ds_read_b64_tr_b16 v[102:103], v123 offset:37376
    s_waitcnt lgkmcnt(0)
    v_mfma_f32_16x16x32_bf16 v[40:43], v[88:91], v[56:59], v[40:43]
    ds_read_b128 v[72:75], v120 offset:40960
    v_mfma_f32_16x16x32_bf16 v[48:51], v[88:91], v[60:63], v[48:51]
    ds_read_b128 v[76:79], v120 offset:43008
    v_mfma_f32_16x16x32_bf16 v[44:47], v[92:95], v[56:59], v[44:47]
    ds_read_b64_tr_b16 v[104:105], v122 offset:40960
    v_mfma_f32_16x16x32_bf16 v[52:55], v[92:95], v[60:63], v[52:55]
    ds_read_b64_tr_b16 v[106:107], v122 offset:41472
    v_mfma_f32_16x16x32_bf16 v[132:135], v[88:91], v[128:131], v[132:135]
    ds_read_b64_tr_b16 v[108:109], v123 offset:40960
    v_mfma_f32_16x16x32_bf16 v[136:139], v[92:95], v[128:131], v[136:139]
    ds_read_b64_tr_b16 v[110:111], v123 offset:41472
    v_mfma_f32_16x16x32_bf16 v[40:43], v[96:99], v[64:67], v[40:43]
    ds_read_b128 v[80:83], v121 offset:40960
    v_mfma_f32_16x16x32_bf16 v[48:51], v[96:99], v[68:71], v[48:51]
    ds_read_b128 v[84:87], v121 offset:43008
    v_mfma_f32_16x16x32_bf16 v[44:47], v[100:103], v[64:67], v[44:47]
    ds_read_b64_tr_b16 v[112:113], v122 offset:45056
    v_mfma_f32_16x16x32_bf16 v[52:55], v[100:103], v[68:71], v[52:55]
    ds_read_b64_tr_b16 v[114:115], v122 offset:45568
    v_mfma_f32_16x16x32_bf16 v[132:135], v[96:99], v[128:131], v[132:135]
    ds_read_b64_tr_b16 v[116:117], v123 offset:45056
    v_mfma_f32_16x16x32_bf16 v[136:139], v[100:103], v[128:131], v[136:139]
    ds_read_b64_tr_b16 v[118:119], v123 offset:45568
    s_waitcnt lgkmcnt(0)
    v_mfma_f32_16x16x32_bf16 v[40:43], v[104:107], v[72:75], v[40:43]
    ds_read_b128 v[56:59], v120 offset:49152
    v_mfma_f32_16x16x32_bf16 v[48:51], v[104:107], v[76:79], v[48:51]
    ds_read_b128 v[60:63], v120 offset:51200
    v_mfma_f32_16x16x32_bf16 v[44:47], v[108:111], v[72:75], v[44:47]
    ds_read_b64_tr_b16 v[88:89], v122 offset:49152
    v_mfma_f32_16x16x32_bf16 v[52:55], v[108:111], v[76:79], v[52:55]
    ds_read_b64_tr_b16 v[90:91], v122 offset:49664
    v_mfma_f32_16x16x32_bf16 v[132:135], v[104:107], v[128:131], v[132:135]
    ds_read_b64_tr_b16 v[92:93], v123 offset:49152
    v_mfma_f32_16x16x32_bf16 v[136:139], v[108:111], v[128:131], v[136:139]
    ds_read_b64_tr_b16 v[94:95], v123 offset:49664
    v_mfma_f32_16x16x32_bf16 v[40:43], v[112:115], v[80:83], v[40:43]
    ds_read_b128 v[64:67], v121 offset:49152
    v_mfma_f32_16x16x32_bf16 v[48:51], v[112:115], v[84:87], v[48:51]
    ds_read_b128 v[68:71], v121 offset:51200
    v_mfma_f32_16x16x32_bf16 v[44:47], v[116:119], v[80:83], v[44:47]
    ds_read_b64_tr_b16 v[96:97], v122 offset:53248
    v_mfma_f32_16x16x32_bf16 v[52:55], v[116:119], v[84:87], v[52:55]
    ds_read_b64_tr_b16 v[98:99], v122 offset:53760
    v_mfma_f32_16x16x32_bf16 v[132:135], v[112:115], v[128:131], v[132:135]
    ds_read_b64_tr_b16 v[100:101], v123 offset:53248
    v_mfma_f32_16x16x32_bf16 v[136:139], v[116:119], v[128:131], v[136:139]
    ds_read_b64_tr_b16 v[102:103], v123 offset:53760
    s_waitcnt lgkmcnt(0)
    v_mfma_f32_16x16x32_bf16 v[40:43], v[88:91], v[56:59], v[40:43]
    ds_read_b128 v[72:75], v120 offset:57344
    v_mfma_f32_16x16x32_bf16 v[48:51], v[88:91], v[60:63], v[48:51]
    ds_read_b128 v[76:79], v120 offset:59392
    v_mfma_f32_16x16x32_bf16 v[44:47], v[92:95], v[56:59], v[44:47]
    ds_read_b64_tr_b16 v[104:105], v122 offset:57344
    v_mfma_f32_16x16x32_bf16 v[52:55], v[92:95], v[60:63], v[52:55]
    ds_read_b64_tr_b16 v[106:107], v122 offset:57856
    v_mfma_f32_16x16x32_bf16 v[132:135], v[88:91], v[128:131], v[132:135]
    ds_read_b64_tr_b16 v[108:109], v123 offset:57344
    v_mfma_f32_16x16x32_bf16 v[136:139], v[92:95], v[128:131], v[136:139]
    ds_read_b64_tr_b16 v[110:111], v123 offset:57856
    v_mfma_f32_16x16x32_bf16 v[40:43], v[96:99], v[64:67], v[40:43]
    ds_read_b128 v[80:83], v121 offset:57344
    v_mfma_f32_16x16x32_bf16 v[48:51], v[96:99], v[68:71], v[48:51]
    ds_read_b128 v[84:87], v121 offset:59392
    v_mfma_f32_16x16x32_bf16 v[44:47], v[100:103], v[64:67], v[44:47]
    ds_read_b64_tr_b16 v[112:113], v122 offset:61440
    v_mfma_f32_16x16x32_bf16 v[52:55], v[100:103], v[68:71], v[52:55]
    ds_read_b64_tr_b16 v[114:115], v122 offset:61952
    v_mfma_f32_16x16x32_bf16 v[132:135], v[96:99], v[128:131], v[132:135]
    ds_read_b64_tr_b16 v[116:117], v123 offset:61440
    v_mfma_f32_16x16x32_bf16 v[136:139], v[100:103], v[128:131], v[136:139]
    ds_read_b64_tr_b16 v[118:119], v123 offset:61952
    s_waitcnt lgkmcnt(0)
    v_mfma_f32_16x16x32_bf16 v[40:43], v[104:107], v[72:75], v[40:43]
    v_mfma_f32_16x16x32_bf16 v[48:51], v[104:107], v[76:79], v[48:51]
    v_mfma_f32_16x16x32_bf16 v[44:47], v[108:111], v[72:75], v[44:47]
    v_mfma_f32_16x16x32_bf16 v[52:55], v[108:111], v[76:79], v[52:55]
    v_mfma_f32_16x16x32_bf16 v[132:135], v[104:107], v[128:131], v[132:135]
    v_mfma_f32_16x16x32_bf16 v[136:139], v[108:111], v[128:131], v[136:139]
    v_mfma_f32_16x16x32_bf16 v[40:43], v[112:115], v[80:83], v[40:43]
    v_mfma_f32_16x16x32_bf16 v[48:51], v[112:115], v[84:87], v[48:51]
    v_mfma_f32_16x16x32_bf16 v[44:47], v[116:119], v[80:83], v[44:47]
    v_mfma_f32_16x16x32_bf16 v[52:55], v[116:119], v[84:87], v[52:55]
    v_mfma_f32_16x16x32_bf16 v[132:135], v[112:115], v[128:131], v[132:135]
    v_mfma_f32_16x16x32_bf16 v[136:139], v[116:119], v[128:131], v[136:139]
    s_branch sequential_preLN__grouped_kv_mqa__mixer_gmlp__prompt_kernel_qjoin
sequential_preLN__grouped_kv_mqa__mixer_gmlp__prompt_kernel_qonly:
    s_barrier
    ds_read_b128 v[56:59], v120 offset:0
    ds_read_b128 v[60:63], v120 offset:2048
    ds_read_b64_tr_b16 v[88:89], v122 offset:0
    ds_read_b64_tr_b16 v[90:91], v122 offset:512
    ds_read_b64_tr_b16 v[92:93], v123 offset:0
    ds_read_b64_tr_b16 v[94:95], v123 offset:512
    ds_read_b128 v[64:67], v121 offset:0
    ds_read_b128 v[68:71], v121 offset:2048
    ds_read_b64_tr_b16 v[96:97], v122 offset:4096
    ds_read_b64_tr_b16 v[98:99], v122 offset:4608
    ds_read_b64_tr_b16 v[100:101], v123 offset:4096
    ds_read_b64_tr_b16 v[102:103], v123 offset:4608
    s_waitcnt lgkmcnt(0)
    s_barrier
    v_mfma_f32_16x16x32_bf16 v[40:43], v[88:91], v[56:59], v[40:43]
    ds_read_b128 v[72:75], v120 offset:8192
    v_mfma_f32_16x16x32_bf16 v[48:51], v[88:91], v[60:63], v[48:51]
    ds_read_b128 v[76:79], v120 offset:10240
    v_mfma_f32_16x16x32_bf16 v[44:47], v[92:95], v[56:59], v[44:47]
    ds_read_b64_tr_b16 v[104:105], v122 offset:8192
    v_mfma_f32_16x16x32_bf16 v[52:55], v[92:95], v[60:63], v[52:55]
    ds_read_b64_tr_b16 v[106:107], v122 offset:8704
    v_mfma_f32_16x16x32_bf16 v[132:135], v[88:91], v[128:131], v[132:135]
    ds_read_b64_tr_b16 v[108:109], v123 offset:8192
    v_mfma_f32_16x16x32_bf16 v[136:139], v[92:95], v[128:131], v[136:139]
    ds_read_b64_tr_b16 v[110:111], v123 offset:8704
    v_dot2_f32_bf16 v170, v56, v56, v170
    ds_read_b128 v[80:83], v121 offset:8192
    v_dot2_f32_bf16 v168, v56, v128, v168
    ds_read_b128 v[84:87], v121 offset:10240
    v_dot2_f32_bf16 v170, v57, v57, v170
    ds_read_b64_tr_b16 v[112:113], v122 offset:12288
    v_dot2_f32_bf16 v168, v57, v128, v168
    ds_read_b64_tr_b16 v[114:115], v122 offset:12800
    v_dot2_f32_bf16 v170, v58, v58, v170
    ds_read_b64_tr_b16 v[116:117], v123 offset:12288
    v_dot2_f32_bf16 v168, v58, v128, v168
    ds_read_b64_tr_b16 v[118:119], v123 offset:12800
    v_dot2_f32_bf16 v170, v59, v59, v170
    v_dot2_f32_bf16 v168, v59, v128, v168
    v_dot2_f32_bf16 v171, v60, v60, v171
    v_dot2_f32_bf16 v169, v60, v128, v169
    v_dot2_f32_bf16 v171, v61, v61, v171
    v_dot2_f32_bf16 v169, v61, v128, v169
    v_dot2_f32_bf16 v171, v62, v62, v171
    v_dot2_f32_bf16 v169, v62, v128, v169
    v_dot2_f32_bf16 v171, v63, v63, v171
    v_dot2_f32_bf16 v169, v63, v128, v169
    v_mfma_f32_16x16x32_bf16 v[40:43], v[96:99], v[64:67], v[40:43]
    v_mfma_f32_16x16x32_bf16 v[48:51], v[96:99], v[68:71], v[48:51]
    v_mfma_f32_16x16x32_bf16 v[44:47], v[100:103], v[64:67], v[44:47]
    v_mfma_f32_16x16x32_bf16 v[52:55], v[100:103], v[68:71], v[52:55]
    v_mfma_f32_16x16x32_bf16 v[132:135], v[96:99], v[128:131], v[132:135]
    v_mfma_f32_16x16x32_bf16 v[136:139], v[100:103], v[128:131], v[136:139]
    v_dot2_f32_bf16 v170, v64, v64, v170
    v_dot2_f32_bf16 v168, v64, v128, v168
    v_dot2_f32_bf16 v170, v65, v65, v170
    v_dot2_f32_bf16 v168, v65, v128, v168
    v_dot2_f32_bf16 v170, v66, v66, v170
    v_dot2_f32_bf16 v168, v66, v128, v168
    v_dot2_f32_bf16 v170, v67, v67, v170
    v_dot2_f32_bf16 v168, v67, v128, v168
    v_dot2_f32_bf16 v171, v68, v68, v171
    v_dot2_f32_bf16 v169, v68, v128, v169
    v_dot2_f32_bf16 v171, v69, v69, v171
    v_dot2_f32_bf16 v169, v69, v128, v169
    v_dot2_f32_bf16 v171, v70, v70, v171
    v_dot2_f32_bf16 v169, v70, v128, v169
    v_dot2_f32_bf16 v171, v71, v71, v171
    v_dot2_f32_bf16 v169, v71, v128, v169
    s_waitcnt lgkmcnt(0)
    s_barrier
    v_mfma_f32_16x16x32_bf16 v[40:43], v[104:107], v[72:75], v[40:43]
    ds_read_b128 v[56:59], v120 offset:16384
    v_mfma_f32_16x16x32_bf16 v[48:51], v[104:107], v[76:79], v[48:51]
    ds_read_b128 v[60:63], v120 offset:18432
    v_mfma_f32_16x16x32_bf16 v[44:47], v[108:111], v[72:75], v[44:47]
    ds_read_b64_tr_b16 v[88:89], v122 offset:16384
    v_mfma_f32_16x16x32_bf16 v[52:55], v[108:111], v[76:79], v[52:55]
    ds_read_b64_tr_b16 v[90:91], v122 offset:16896
    v_mfma_f32_16x16x32_bf16 v[132:135], v[104:107], v[128:131], v[132:135]
    ds_read_b64_tr_b16 v[92:93], v123 offset:16384
    v_mfma_f32_16x16x32_bf16 v[136:139], v[108:111], v[128:131], v[136:139]
    ds_read_b64_tr_b16 v[94:95], v123 offset:16896
    v_dot2_f32_bf16 v170, v72, v72, v170
    ds_read_b128 v[64:67], v121 offset:16384
    v_dot2_f32_bf16 v168, v72, v128, v168
    ds_read_b128 v[68:71], v121 offset:18432
    v_dot2_f32_bf16 v170, v73, v73, v170
    ds_read_b64_tr_b16 v[96:97], v122 offset:20480
    v_dot2_f32_bf16 v168, v73, v128, v168
    ds_read_b64_tr_b16 v[98:99], v122 offset:20992
    v_dot2_f32_bf16 v170, v74, v74, v170
    ds_read_b64_tr_b16 v[100:101], v123 offset:20480
    v_dot2_f32_bf16 v168, v74, v128, v168
    ds_read_b64_tr_b16 v[102:103], v123 offset:20992
    v_dot2_f32_bf16 v170, v75, v75, v170
    v_dot2_f32_bf16 v168, v75, v128, v168
    v_dot2_f32_bf16 v171, v76, v76, v171
    v_dot2_f32_bf16 v169, v76, v128, v169
    v_dot2_f32_bf16 v171, v77, v77, v171
    v_dot2_f32_bf16 v169, v77, v128, v169
    v_dot2_f32_bf16 v171, v78, v78, v171
    v_dot2_f32_bf16 v169, v78, v128, v169
    v_dot2_f32_bf16 v171, v79, v79, v171
    v_dot2_f32_bf16 v169, v79, v128, v169
    v_mfma_f32_16x16x32_bf16 v[40:43], v[112:115], v[80:83], v[40:43]
    v_mfma_f32_16x16x32_bf16 v[48:51], v[112:115], v[84:87], v[48:51]
    v_mfma_f32_16x16x32_bf16 v[44:47], v[116:119], v[80:83], v[44:47]
    v_mfma_f32_16x16x32_bf16 v[52:55], v[116:119], v[84:87], v[52:55]
    v_mfma_f32_16x16x32_bf16 v[132:135], v[112:115], v[128:131], v[132:135]
    v_mfma_f32_16x16x32_bf16 v[136:139], v[116:119], v[128:131], v[136:139]
    v_dot2_f32_bf16 v170, v80, v80, v170
    v_dot2_f32_bf16 v168, v80, v128, v168
    v_dot2_f32_bf16 v170, v81, v81, v170
    v_dot2_f32_bf16 v168, v81, v128, v168
    v_dot2_f32_bf16 v170, v82, v82, v170
    v_dot2_f32_bf16 v168, v82, v128, v168
    v_dot2_f32_bf16 v170, v83, v83, v170
    v_dot2_f32_bf16 v168, v83, v128, v168
    v_dot2_f32_bf16 v171, v84, v84, v171
    v_dot2_f32_bf16 v169, v84, v128, v169
    v_dot2_f32_bf16 v171, v85, v85, v171
    v_dot2_f32_bf16 v169, v85, v128, v169
    v_dot2_f32_bf16 v171, v86, v86, v171
    v_dot2_f32_bf16 v169, v86, v128, v169
    v_dot2_f32_bf16 v171, v87, v87, v171
    v_dot2_f32_bf16 v169, v87, v128, v169
    s_waitcnt lgkmcnt(0)
    s_barrier
    v_mfma_f32_16x16x32_bf16 v[40:43], v[88:91], v[56:59], v[40:43]
    ds_read_b128 v[72:75], v120 offset:24576
    v_mfma_f32_16x16x32_bf16 v[48:51], v[88:91], v[60:63], v[48:51]
    ds_read_b128 v[76:79], v120 offset:26624
    v_mfma_f32_16x16x32_bf16 v[44:47], v[92:95], v[56:59], v[44:47]
    ds_read_b64_tr_b16 v[104:105], v122 offset:24576
    v_mfma_f32_16x16x32_bf16 v[52:55], v[92:95], v[60:63], v[52:55]
    ds_read_b64_tr_b16 v[106:107], v122 offset:25088
    v_mfma_f32_16x16x32_bf16 v[132:135], v[88:91], v[128:131], v[132:135]
    ds_read_b64_tr_b16 v[108:109], v123 offset:24576
    v_mfma_f32_16x16x32_bf16 v[136:139], v[92:95], v[128:131], v[136:139]
    ds_read_b64_tr_b16 v[110:111], v123 offset:25088
    v_dot2_f32_bf16 v170, v56, v56, v170
    ds_read_b128 v[80:83], v121 offset:24576
    v_dot2_f32_bf16 v168, v56, v128, v168
    ds_read_b128 v[84:87], v121 offset:26624
    v_dot2_f32_bf16 v170, v57, v57, v170
    ds_read_b64_tr_b16 v[112:113], v122 offset:28672
    v_dot2_f32_bf16 v168, v57, v128, v168
    ds_read_b64_tr_b16 v[114:115], v122 offset:29184
    v_dot2_f32_bf16 v170, v58, v58, v170
    ds_read_b64_tr_b16 v[116:117], v123 offset:28672
    v_dot2_f32_bf16 v168, v58, v128, v168
    ds_read_b64_tr_b16 v[118:119], v123 offset:29184
    v_dot2_f32_bf16 v170, v59, v59, v170
    v_dot2_f32_bf16 v168, v59, v128, v168
    v_dot2_f32_bf16 v171, v60, v60, v171
    v_dot2_f32_bf16 v169, v60, v128, v169
    v_dot2_f32_bf16 v171, v61, v61, v171
    v_dot2_f32_bf16 v169, v61, v128, v169
    v_dot2_f32_bf16 v171, v62, v62, v171
    v_dot2_f32_bf16 v169, v62, v128, v169
    v_dot2_f32_bf16 v171, v63, v63, v171
    v_dot2_f32_bf16 v169, v63, v128, v169
    v_mfma_f32_16x16x32_bf16 v[40:43], v[96:99], v[64:67], v[40:43]
    v_mfma_f32_16x16x32_bf16 v[48:51], v[96:99], v[68:71], v[48:51]
    v_mfma_f32_16x16x32_bf16 v[44:47], v[100:103], v[64:67], v[44:47]
    v_mfma_f32_16x16x32_bf16 v[52:55], v[100:103], v[68:71], v[52:55]
    v_mfma_f32_16x16x32_bf16 v[132:135], v[96:99], v[128:131], v[132:135]
    v_mfma_f32_16x16x32_bf16 v[136:139], v[100:103], v[128:131], v[136:139]
    v_dot2_f32_bf16 v170, v64, v64, v170
    v_dot2_f32_bf16 v168, v64, v128, v168
    v_dot2_f32_bf16 v170, v65, v65, v170
    v_dot2_f32_bf16 v168, v65, v128, v168
    v_dot2_f32_bf16 v170, v66, v66, v170
    v_dot2_f32_bf16 v168, v66, v128, v168
    v_dot2_f32_bf16 v170, v67, v67, v170
    v_dot2_f32_bf16 v168, v67, v128, v168
    v_dot2_f32_bf16 v171, v68, v68, v171
    v_dot2_f32_bf16 v169, v68, v128, v169
    v_dot2_f32_bf16 v171, v69, v69, v171
    v_dot2_f32_bf16 v169, v69, v128, v169
    v_dot2_f32_bf16 v171, v70, v70, v171
    v_dot2_f32_bf16 v169, v70, v128, v169
    v_dot2_f32_bf16 v171, v71, v71, v171
    v_dot2_f32_bf16 v169, v71, v128, v169
    s_waitcnt lgkmcnt(0)
    s_barrier
    v_mfma_f32_16x16x32_bf16 v[40:43], v[104:107], v[72:75], v[40:43]
    ds_read_b128 v[56:59], v120 offset:32768
    v_mfma_f32_16x16x32_bf16 v[48:51], v[104:107], v[76:79], v[48:51]
    ds_read_b128 v[60:63], v120 offset:34816
    v_mfma_f32_16x16x32_bf16 v[44:47], v[108:111], v[72:75], v[44:47]
    ds_read_b64_tr_b16 v[88:89], v122 offset:32768
    v_mfma_f32_16x16x32_bf16 v[52:55], v[108:111], v[76:79], v[52:55]
    ds_read_b64_tr_b16 v[90:91], v122 offset:33280
    v_mfma_f32_16x16x32_bf16 v[132:135], v[104:107], v[128:131], v[132:135]
    ds_read_b64_tr_b16 v[92:93], v123 offset:32768
    v_mfma_f32_16x16x32_bf16 v[136:139], v[108:111], v[128:131], v[136:139]
    ds_read_b64_tr_b16 v[94:95], v123 offset:33280
    v_dot2_f32_bf16 v170, v72, v72, v170
    ds_read_b128 v[64:67], v121 offset:32768
    v_dot2_f32_bf16 v168, v72, v128, v168
    ds_read_b128 v[68:71], v121 offset:34816
    v_dot2_f32_bf16 v170, v73, v73, v170
    ds_read_b64_tr_b16 v[96:97], v122 offset:36864
    v_dot2_f32_bf16 v168, v73, v128, v168
    ds_read_b64_tr_b16 v[98:99], v122 offset:37376
    v_dot2_f32_bf16 v170, v74, v74, v170
    ds_read_b64_tr_b16 v[100:101], v123 offset:36864
    v_dot2_f32_bf16 v168, v74, v128, v168
    ds_read_b64_tr_b16 v[102:103], v123 offset:37376
    v_dot2_f32_bf16 v170, v75, v75, v170
    v_dot2_f32_bf16 v168, v75, v128, v168
    v_dot2_f32_bf16 v171, v76, v76, v171
    v_dot2_f32_bf16 v169, v76, v128, v169
    v_dot2_f32_bf16 v171, v77, v77, v171
    v_dot2_f32_bf16 v169, v77, v128, v169
    v_dot2_f32_bf16 v171, v78, v78, v171
    v_dot2_f32_bf16 v169, v78, v128, v169
    v_dot2_f32_bf16 v171, v79, v79, v171
    v_dot2_f32_bf16 v169, v79, v128, v169
    v_mfma_f32_16x16x32_bf16 v[40:43], v[112:115], v[80:83], v[40:43]
    v_mfma_f32_16x16x32_bf16 v[48:51], v[112:115], v[84:87], v[48:51]
    v_mfma_f32_16x16x32_bf16 v[44:47], v[116:119], v[80:83], v[44:47]
    v_mfma_f32_16x16x32_bf16 v[52:55], v[116:119], v[84:87], v[52:55]
    v_mfma_f32_16x16x32_bf16 v[132:135], v[112:115], v[128:131], v[132:135]
    v_mfma_f32_16x16x32_bf16 v[136:139], v[116:119], v[128:131], v[136:139]
    v_dot2_f32_bf16 v170, v80, v80, v170
    v_dot2_f32_bf16 v168, v80, v128, v168
    v_dot2_f32_bf16 v170, v81, v81, v170
    v_dot2_f32_bf16 v168, v81, v128, v168
    v_dot2_f32_bf16 v170, v82, v82, v170
    v_dot2_f32_bf16 v168, v82, v128, v168
    v_dot2_f32_bf16 v170, v83, v83, v170
    v_dot2_f32_bf16 v168, v83, v128, v168
    v_dot2_f32_bf16 v171, v84, v84, v171
    v_dot2_f32_bf16 v169, v84, v128, v169
    v_dot2_f32_bf16 v171, v85, v85, v171
    v_dot2_f32_bf16 v169, v85, v128, v169
    v_dot2_f32_bf16 v171, v86, v86, v171
    v_dot2_f32_bf16 v169, v86, v128, v169
    v_dot2_f32_bf16 v171, v87, v87, v171
    v_dot2_f32_bf16 v169, v87, v128, v169
    s_waitcnt lgkmcnt(0)
    s_barrier
    v_mfma_f32_16x16x32_bf16 v[40:43], v[88:91], v[56:59], v[40:43]
    ds_read_b128 v[72:75], v120 offset:40960
    v_mfma_f32_16x16x32_bf16 v[48:51], v[88:91], v[60:63], v[48:51]
    ds_read_b128 v[76:79], v120 offset:43008
    v_mfma_f32_16x16x32_bf16 v[44:47], v[92:95], v[56:59], v[44:47]
    ds_read_b64_tr_b16 v[104:105], v122 offset:40960
    v_mfma_f32_16x16x32_bf16 v[52:55], v[92:95], v[60:63], v[52:55]
    ds_read_b64_tr_b16 v[106:107], v122 offset:41472
    v_mfma_f32_16x16x32_bf16 v[132:135], v[88:91], v[128:131], v[132:135]
    ds_read_b64_tr_b16 v[108:109], v123 offset:40960
    v_mfma_f32_16x16x32_bf16 v[136:139], v[92:95], v[128:131], v[136:139]
    ds_read_b64_tr_b16 v[110:111], v123 offset:41472
    v_dot2_f32_bf16 v170, v56, v56, v170
    ds_read_b128 v[80:83], v121 offset:40960
    v_dot2_f32_bf16 v168, v56, v128, v168
    ds_read_b128 v[84:87], v121 offset:43008
    v_dot2_f32_bf16 v170, v57, v57, v170
    ds_read_b64_tr_b16 v[112:113], v122 offset:45056
    v_dot2_f32_bf16 v168, v57, v128, v168
    ds_read_b64_tr_b16 v[114:115], v122 offset:45568
    v_dot2_f32_bf16 v170, v58, v58, v170
    ds_read_b64_tr_b16 v[116:117], v123 offset:45056
    v_dot2_f32_bf16 v168, v58, v128, v168
    ds_read_b64_tr_b16 v[118:119], v123 offset:45568
    v_dot2_f32_bf16 v170, v59, v59, v170
    v_dot2_f32_bf16 v168, v59, v128, v168
    v_dot2_f32_bf16 v171, v60, v60, v171
    v_dot2_f32_bf16 v169, v60, v128, v169
    v_dot2_f32_bf16 v171, v61, v61, v171
    v_dot2_f32_bf16 v169, v61, v128, v169
    v_dot2_f32_bf16 v171, v62, v62, v171
    v_dot2_f32_bf16 v169, v62, v128, v169
    v_dot2_f32_bf16 v171, v63, v63, v171
    v_dot2_f32_bf16 v169, v63, v128, v169
    v_mfma_f32_16x16x32_bf16 v[40:43], v[96:99], v[64:67], v[40:43]
    v_mfma_f32_16x16x32_bf16 v[48:51], v[96:99], v[68:71], v[48:51]
    v_mfma_f32_16x16x32_bf16 v[44:47], v[100:103], v[64:67], v[44:47]
    v_mfma_f32_16x16x32_bf16 v[52:55], v[100:103], v[68:71], v[52:55]
    v_mfma_f32_16x16x32_bf16 v[132:135], v[96:99], v[128:131], v[132:135]
    v_mfma_f32_16x16x32_bf16 v[136:139], v[100:103], v[128:131], v[136:139]
    v_dot2_f32_bf16 v170, v64, v64, v170
    v_dot2_f32_bf16 v168, v64, v128, v168
    v_dot2_f32_bf16 v170, v65, v65, v170
    v_dot2_f32_bf16 v168, v65, v128, v168
    v_dot2_f32_bf16 v170, v66, v66, v170
    v_dot2_f32_bf16 v168, v66, v128, v168
    v_dot2_f32_bf16 v170, v67, v67, v170
    v_dot2_f32_bf16 v168, v67, v128, v168
    v_dot2_f32_bf16 v171, v68, v68, v171
    v_dot2_f32_bf16 v169, v68, v128, v169
    v_dot2_f32_bf16 v171, v69, v69, v171
    v_dot2_f32_bf16 v169, v69, v128, v169
    v_dot2_f32_bf16 v171, v70, v70, v171
    v_dot2_f32_bf16 v169, v70, v128, v169
    v_dot2_f32_bf16 v171, v71, v71, v171
    v_dot2_f32_bf16 v169, v71, v128, v169
    s_mov_b32 s56, s38
    s_mov_b32 s57, s39
    s_mov_b32 s58, 256
    s_mov_b32 s59, 0x00020000
    v_mov_b32 v2, 0
    buffer_load_dword v172, v2, s[56:59], 0 offen sc1
    s_waitcnt lgkmcnt(0)
    s_barrier
    v_mfma_f32_16x16x32_bf16 v[40:43], v[104:107], v[72:75], v[40:43]
    ds_read_b128 v[56:59], v120 offset:49152
    v_mfma_f32_16x16x32_bf16 v[48:51], v[104:107], v[76:79], v[48:51]
    ds_read_b128 v[60:63], v120 offset:51200
    v_mfma_f32_16x16x32_bf16 v[44:47], v[108:111], v[72:75], v[44:47]
    ds_read_b64_tr_b16 v[88:89], v122 offset:49152
    v_mfma_f32_16x16x32_bf16 v[52:55], v[108:111], v[76:79], v[52:55]
    ds_read_b64_tr_b16 v[90:91], v122 offset:49664
    v_mfma_f32_16x16x32_bf16 v[132:135], v[104:107], v[128:131], v[132:135]
    ds_read_b64_tr_b16 v[92:93], v123 offset:49152
    v_mfma_f32_16x16x32_bf16 v[136:139], v[108:111], v[128:131], v[136:139]
    ds_read_b64_tr_b16 v[94:95], v123 offset:49664
    v_dot2_f32_bf16 v170, v72, v72, v170
    ds_read_b128 v[64:67], v121 offset:49152
    v_dot2_f32_bf16 v168, v72, v128, v168
    ds_read_b128 v[68:71], v121 offset:51200
    v_dot2_f32_bf16 v170, v73, v73, v170
    ds_read_b64_tr_b16 v[96:97], v122 offset:53248
    v_dot2_f32_bf16 v168, v73, v128, v168
    ds_read_b64_tr_b16 v[98:99], v122 offset:53760
    v_dot2_f32_bf16 v170, v74, v74, v170
    ds_read_b64_tr_b16 v[100:101], v123 offset:53248
    v_dot2_f32_bf16 v168, v74, v128, v168
    ds_read_b64_tr_b16 v[102:103], v123 offset:53760
    v_dot2_f32_bf16 v170, v75, v75, v170
    v_dot2_f32_bf16 v168, v75, v128, v168
    v_dot2_f32_bf16 v171, v76, v76, v171
    v_dot2_f32_bf16 v169, v76, v128, v169
    v_dot2_f32_bf16 v171, v77, v77, v171
    v_dot2_f32_bf16 v169, v77, v128, v169
    v_dot2_f32_bf16 v171, v78, v78, v171
    v_dot2_f32_bf16 v169, v78, v128, v169
    v_dot2_f32_bf16 v171, v79, v79, v171
    v_dot2_f32_bf16 v169, v79, v128, v169
    v_mfma_f32_16x16x32_bf16 v[40:43], v[112:115], v[80:83], v[40:43]
    v_mfma_f32_16x16x32_bf16 v[48:51], v[112:115], v[84:87], v[48:51]
    v_mfma_f32_16x16x32_bf16 v[44:47], v[116:119], v[80:83], v[44:47]
    v_mfma_f32_16x16x32_bf16 v[52:55], v[116:119], v[84:87], v[52:55]
    v_mfma_f32_16x16x32_bf16 v[132:135], v[112:115], v[128:131], v[132:135]
    v_mfma_f32_16x16x32_bf16 v[136:139], v[116:119], v[128:131], v[136:139]
    v_dot2_f32_bf16 v170, v80, v80, v170
    v_dot2_f32_bf16 v168, v80, v128, v168
    v_dot2_f32_bf16 v170, v81, v81, v170
    v_dot2_f32_bf16 v168, v81, v128, v168
    v_dot2_f32_bf16 v170, v82, v82, v170
    v_dot2_f32_bf16 v168, v82, v128, v168
    v_dot2_f32_bf16 v170, v83, v83, v170
    v_dot2_f32_bf16 v168, v83, v128, v168
    v_dot2_f32_bf16 v171, v84, v84, v171
    v_dot2_f32_bf16 v169, v84, v128, v169
    v_dot2_f32_bf16 v171, v85, v85, v171
    v_dot2_f32_bf16 v169, v85, v128, v169
    v_dot2_f32_bf16 v171, v86, v86, v171
    v_dot2_f32_bf16 v169, v86, v128, v169
    v_dot2_f32_bf16 v171, v87, v87, v171
    v_dot2_f32_bf16 v169, v87, v128, v169
    s_waitcnt lgkmcnt(0)
    s_barrier
    v_mfma_f32_16x16x32_bf16 v[40:43], v[88:91], v[56:59], v[40:43]
    ds_read_b128 v[72:75], v120 offset:57344
    v_mfma_f32_16x16x32_bf16 v[48:51], v[88:91], v[60:63], v[48:51]
    ds_read_b128 v[76:79], v120 offset:59392
    v_mfma_f32_16x16x32_bf16 v[44:47], v[92:95], v[56:59], v[44:47]
    ds_read_b64_tr_b16 v[104:105], v122 offset:57344
    v_mfma_f32_16x16x32_bf16 v[52:55], v[92:95], v[60:63], v[52:55]
    ds_read_b64_tr_b16 v[106:107], v122 offset:57856
    v_mfma_f32_16x16x32_bf16 v[132:135], v[88:91], v[128:131], v[132:135]
    ds_read_b64_tr_b16 v[108:109], v123 offset:57344
    v_mfma_f32_16x16x32_bf16 v[136:139], v[92:95], v[128:131], v[136:139]
    ds_read_b64_tr_b16 v[110:111], v123 offset:57856
    v_dot2_f32_bf16 v170, v56, v56, v170
    ds_read_b128 v[80:83], v121 offset:57344
    v_dot2_f32_bf16 v168, v56, v128, v168
    ds_read_b128 v[84:87], v121 offset:59392
    v_dot2_f32_bf16 v170, v57, v57, v170
    ds_read_b64_tr_b16 v[112:113], v122 offset:61440
    v_dot2_f32_bf16 v168, v57, v128, v168
    ds_read_b64_tr_b16 v[114:115], v122 offset:61952
    v_dot2_f32_bf16 v170, v58, v58, v170
    ds_read_b64_tr_b16 v[116:117], v123 offset:61440
    v_dot2_f32_bf16 v168, v58, v128, v168
    ds_read_b64_tr_b16 v[118:119], v123 offset:61952
    v_dot2_f32_bf16 v170, v59, v59, v170
    v_dot2_f32_bf16 v168, v59, v128, v168
    v_dot2_f32_bf16 v171, v60, v60, v171
    v_dot2_f32_bf16 v169, v60, v128, v169
    v_dot2_f32_bf16 v171, v61, v61, v171
    v_dot2_f32_bf16 v169, v61, v128, v169
    v_dot2_f32_bf16 v171, v62, v62, v171
    v_dot2_f32_bf16 v169, v62, v128, v169
    v_dot2_f32_bf16 v171, v63, v63, v171
    v_dot2_f32_bf16 v169, v63, v128, v169
    v_mfma_f32_16x16x32_bf16 v[40:43], v[96:99], v[64:67], v[40:43]
    v_mfma_f32_16x16x32_bf16 v[48:51], v[96:99], v[68:71], v[48:51]
    v_mfma_f32_16x16x32_bf16 v[44:47], v[100:103], v[64:67], v[44:47]
    v_mfma_f32_16x16x32_bf16 v[52:55], v[100:103], v[68:71], v[52:55]
    v_mfma_f32_16x16x32_bf16 v[132:135], v[96:99], v[128:131], v[132:135]
    v_mfma_f32_16x16x32_bf16 v[136:139], v[100:103], v[128:131], v[136:139]
    v_dot2_f32_bf16 v170, v64, v64, v170
    v_dot2_f32_bf16 v168, v64, v128, v168
    v_dot2_f32_bf16 v170, v65, v65, v170
    v_dot2_f32_bf16 v168, v65, v128, v168
    v_dot2_f32_bf16 v170, v66, v66, v170
    v_dot2_f32_bf16 v168, v66, v128, v168
    v_dot2_f32_bf16 v170, v67, v67, v170
    v_dot2_f32_bf16 v168, v67, v128, v168
    v_dot2_f32_bf16 v171, v68, v68, v171
    v_dot2_f32_bf16 v169, v68, v128, v169
    v_dot2_f32_bf16 v171, v69, v69, v171
    v_dot2_f32_bf16 v169, v69, v128, v169
    v_dot2_f32_bf16 v171, v70, v70, v171
    v_dot2_f32_bf16 v169, v70, v128, v169
    v_dot2_f32_bf16 v171, v71, v71, v171
    v_dot2_f32_bf16 v169, v71, v128, v169
    s_waitcnt lgkmcnt(0)
    v_mfma_f32_16x16x32_bf16 v[40:43], v[104:107], v[72:75], v[40:43]
    v_mfma_f32_16x16x32_bf16 v[48:51], v[104:107], v[76:79], v[48:51]
    v_mfma_f32_16x16x32_bf16 v[44:47], v[108:111], v[72:75], v[44:47]
    v_mfma_f32_16x16x32_bf16 v[52:55], v[108:111], v[76:79], v[52:55]
    v_mfma_f32_16x16x32_bf16 v[132:135], v[104:107], v[128:131], v[132:135]
    v_mfma_f32_16x16x32_bf16 v[136:139], v[108:111], v[128:131], v[136:139]
    v_dot2_f32_bf16 v170, v72, v72, v170
    v_dot2_f32_bf16 v168, v72, v128, v168
    v_dot2_f32_bf16 v170, v73, v73, v170
    v_dot2_f32_bf16 v168, v73, v128, v168
    v_dot2_f32_bf16 v170, v74, v74, v170
    v_dot2_f32_bf16 v168, v74, v128, v168
    v_dot2_f32_bf16 v170, v75, v75, v170
    v_dot2_f32_bf16 v168, v75, v128, v168
    v_dot2_f32_bf16 v171, v76, v76, v171
    v_dot2_f32_bf16 v169, v76, v128, v169
    v_dot2_f32_bf16 v171, v77, v77, v171
    v_dot2_f32_bf16 v169, v77, v128, v169
    v_dot2_f32_bf16 v171, v78, v78, v171
    v_dot2_f32_bf16 v169, v78, v128, v169
    v_dot2_f32_bf16 v171, v79, v79, v171
    v_dot2_f32_bf16 v169, v79, v128, v169
    v_mfma_f32_16x16x32_bf16 v[40:43], v[112:115], v[80:83], v[40:43]
    v_mfma_f32_16x16x32_bf16 v[48:51], v[112:115], v[84:87], v[48:51]
    v_mfma_f32_16x16x32_bf16 v[44:47], v[116:119], v[80:83], v[44:47]
    v_mfma_f32_16x16x32_bf16 v[52:55], v[116:119], v[84:87], v[52:55]
    v_mfma_f32_16x16x32_bf16 v[132:135], v[112:115], v[128:131], v[132:135]
    v_mfma_f32_16x16x32_bf16 v[136:139], v[116:119], v[128:131], v[136:139]
    v_dot2_f32_bf16 v170, v80, v80, v170
    v_dot2_f32_bf16 v168, v80, v128, v168
    v_dot2_f32_bf16 v170, v81, v81, v170
    v_dot2_f32_bf16 v168, v81, v128, v168
    v_dot2_f32_bf16 v170, v82, v82, v170
    v_dot2_f32_bf16 v168, v82, v128, v168
    v_dot2_f32_bf16 v170, v83, v83, v170
    v_dot2_f32_bf16 v168, v83, v128, v168
    v_dot2_f32_bf16 v171, v84, v84, v171
    v_dot2_f32_bf16 v169, v84, v128, v169
    v_dot2_f32_bf16 v171, v85, v85, v171
    v_dot2_f32_bf16 v169, v85, v128, v169
    v_dot2_f32_bf16 v171, v86, v86, v171
    v_dot2_f32_bf16 v169, v86, v128, v169
    v_dot2_f32_bf16 v171, v87, v87, v171
    v_dot2_f32_bf16 v169, v87, v128, v169
    s_mov_b32 s83, 0x40000
ep_sequential_preLN__grouped_kv_mqa__mixer_gmlp__prompt_kernel_4:
    s_waitcnt vmcnt(0)
    v_readfirstlane_b32 s26, v172
    s_nop 2
    s_cmp_lg_u32 s26, 0
    s_cbranch_scc1 epd_sequential_preLN__grouped_kv_mqa__mixer_gmlp__prompt_kernel_5
    s_sleep 2
    buffer_load_dword v172, v2, s[56:59], 0 offen sc1
    s_sub_u32 s83, s83, 1
    s_cmp_lg_u32 s83, 0
    s_cbranch_scc1 ep_sequential_preLN__grouped_kv_mqa__mixer_gmlp__prompt_kernel_4
epd_sequential_preLN__grouped_kv_mqa__mixer_gmlp__prompt_kernel_5:
    s_waitcnt vmcnt(0)
    v_mov_b32 v2, v168
    s_nop 1
    v_permlane16_swap_b32 v2, v168
    v_add_f32 v168, v168, v2
    v_mov_b32 v2, v168
    s_nop 1
    v_permlane32_swap_b32 v2, v168
    v_add_f32 v168, v168, v2
    v_mov_b32 v2, v170
    s_nop 1
    v_permlane16_swap_b32 v2, v170
    v_add_f32 v170, v170, v2
    v_mov_b32 v2, v170
    s_nop 1
    v_permlane32_swap_b32 v2, v170
    v_add_f32 v170, v170, v2
    v_mul_f32 v168, 0x3b000000, v168
    v_mul_f32 v170, 0x3b000000, v170
    v_fma_f32 v170, -v168, v168, v170
    v_max_f32 v170, 0, v170
    v_add_f32 v170, s81, v170
    v_rsq_f32 v170, v170
    v_mov_b32 v2, v169
    s_nop 1
    v_permlane16_swap_b32 v2, v169
    v_add_f32 v169, v169, v2
    v_mov_b32 v2, v169
    s_nop 1
    v_permlane32_swap_b32 v2, v169
    v_add_f32 v169, v169, v2
    v_mov_b32 v2, v171
    s_nop 1
    v_permlane16_swap_b32 v2, v171
    v_add_f32 v171, v171, v2
    v_mov_b32 v2, v171
    s_nop 1
    v_permlane32_swap_b32 v2, v171
    v_add_f32 v171, v171, v2
    v_mul_f32 v169, 0x3b000000, v169
    v_mul_f32 v171, 0x3b000000, v171
    v_fma_f32 v171, -v169, v169, v171
    v_max_f32 v171, 0, v171
    v_add_f32 v171, s81, v171
    v_rsq_f32 v171, v171
    s_add_u32 s72, s40, 2293760
    s_addc_u32 s73, s41, 0
    s_mov_b32 s74, 24576
    s_mov_b32 s75, 0x00020000
sequential_preLN__grouped_kv_mqa__mixer_gmlp__prompt_kernel_qjoin:
    s_barrier
    s_mov_b32 s4, 0x3eb8aa3b
    v_mul_f32 v170, s4, v170
    v_mul_f32 v171, s4, v171
    v_fma_f32 v40, -v168, v132, v40
    v_mul_f32 v40, v170, v40
    v_fma_f32 v41, -v168, v133, v41
    v_mul_f32 v41, v170, v41
    v_fma_f32 v42, -v168, v134, v42
    v_mul_f32 v42, v170, v42
    v_fma_f32 v43, -v168, v135, v43
    v_mul_f32 v43, v170, v43
    v_fma_f32 v44, -v168, v136, v44
    v_mul_f32 v44, v170, v44
    v_fma_f32 v45, -v168, v137, v45
    v_mul_f32 v45, v170, v45
    v_fma_f32 v46, -v168, v138, v46
    v_mul_f32 v46, v170, v46
    v_fma_f32 v47, -v168, v139, v47
    v_mul_f32 v47, v170, v47
    v_fma_f32 v48, -v169, v132, v48
    v_mul_f32 v48, v171, v48
    v_fma_f32 v49, -v169, v133, v49
    v_mul_f32 v49, v171, v49
    v_fma_f32 v50, -v169, v134, v50
    v_mul_f32 v50, v171, v50
    v_fma_f32 v51, -v169, v135, v51
    v_mul_f32 v51, v171, v51
    v_fma_f32 v52, -v169, v136, v52
    v_mul_f32 v52, v171, v52
    v_fma_f32 v53, -v169, v137, v53
    v_mul_f32 v53, v171, v53
    v_fma_f32 v54, -v169, v138, v54
    v_mul_f32 v54, v171, v54
    v_fma_f32 v55, -v169, v139, v55
    v_mul_f32 v55, v171, v55
    v_cvt_pk_bf16_f32 v32, v40, v41
    v_cvt_pk_bf16_f32 v33, v42, v43
    v_cvt_pk_bf16_f32 v34, v48, v49
    v_cvt_pk_bf16_f32 v35, v50, v51
    s_nop 0
    v_permlane16_swap_b32 v32, v34
    v_permlane16_swap_b32 v33, v35
    v_cvt_pk_bf16_f32 v36, v44, v45
    v_cvt_pk_bf16_f32 v37, v46, v47
    v_cvt_pk_bf16_f32 v38, v52, v53
    v_cvt_pk_bf16_f32 v39, v54, v55
    s_nop 0
    v_permlane16_swap_b32 v36, v38
    v_permlane16_swap_b32 v37, v39
    v_and_b32 v72, 0x2c, v0
    v_cmp_eq_u32 vcc, 0, v72
    v_mov_b32 v73, 0x3f803f80
    s_nop 0
    v_cndmask_b32 v73, 0, v73, vcc
    v_lshlrev_b32 v74, 2, v0
    v_add_u32 v74, 131072, v74
    ds_write_b32 v74, v73 offset:0
    ds_write_b32 v74, v73 offset:1024
    ds_write_b32 v74, v73 offset:2048
    ds_write_b32 v74, v73 offset:3072
    ds_write_b32 v74, v73 offset:4096
    ds_write_b32 v74, v73 offset:5120
    ds_write_b32 v74, v73 offset:6144
    ds_write_b32 v74, v73 offset:7168
    ds_write_b32 v74, v73 offset:8192
    ds_write_b32 v74, v73 offset:9216
    ds_write_b32 v74, v73 offset:10240
    ds_write_b32 v74, v73 offset:11264
    ds_write_b32 v74, v73 offset:12288
    ds_write_b32 v74, v73 offset:13312
    ds_write_b32 v74, v73 offset:14336
    ds_write_b32 v74, v73 offset:15360
    ds_write_b32 v74, v73 offset:16384
    v_mov_b32 v176, v6
    v_and_b32 v88, 15, v1
    v_lshrrev_b32 v89, 5, v1
    v_lshlrev_b32 v90, 4, v88
    v_lshl_add_u32 v90, v89, 8, v90
    v_add_u32 v90, 65536, v90
    v_add_u32 v92, 4, v88
    v_and_b32 v92, 8, v92
    v_lshlrev_b32 v91, 3, v92
    v_and_b32 v92, 11, v88
    v_cmp_ne_u32 vcc, 0, v92
    v_mov_b32 v92, 16
    s_nop 0
    v_cndmask_b32 v92, 0, v92, vcc
    v_add_u32 v91, v91, v92
    v_add_u32 v91, 131072, v91
    v_bfe_u32 v92, v1, 4, 1
    v_cmp_eq_u32 vcc, 0, v92
    s_nop 1
    v_cndmask_b32 v177, v91, v90, vcc
    v_mov_b32 v178, 16384
    v_cndmask_b32 v178, 0, v178, vcc
    v_mov_b32 v120, 0
    v_mov_b32 v40, 0
    v_mov_b32 v136, 0
    v_mov_b32 v56, 0
    v_mov_b32 v121, 0
    v_mov_b32 v41, 0
    v_mov_b32 v137, 0
    v_mov_b32 v57, 0
    v_mov_b32 v122, 0
    v_mov_b32 v42, 0
    v_mov_b32 v138, 0
    v_mov_b32 v58, 0
    v_mov_b32 v123, 0
    v_mov_b32 v43, 0
    v_mov_b32 v139, 0
    v_mov_b32 v59, 0
    v_mov_b32 v124, 0
    v_mov_b32 v44, 0
    v_mov_b32 v140, 0
    v_mov_b32 v60, 0
    v_mov_b32 v125, 0
    v_mov_b32 v45, 0
    v_mov_b32 v141, 0
    v_mov_b32 v61, 0
    v_mov_b32 v126, 0
    v_mov_b32 v46, 0
    v_mov_b32 v142, 0
    v_mov_b32 v62, 0
    v_mov_b32 v127, 0
    v_mov_b32 v47, 0
    v_mov_b32 v143, 0
    v_mov_b32 v63, 0
    v_mov_b32 v128, 0
    v_mov_b32 v48, 0
    v_mov_b32 v144, 0
    v_mov_b32 v64, 0
    v_mov_b32 v129, 0
    v_mov_b32 v49, 0
    v_mov_b32 v145, 0
    v_mov_b32 v65, 0
    v_mov_b32 v130, 0
    v_mov_b32 v50, 0
    v_mov_b32 v146, 0
    v_mov_b32 v66, 0
    v_mov_b32 v131, 0
    v_mov_b32 v51, 0
    v_mov_b32 v147, 0
    v_mov_b32 v67, 0
    v_mov_b32 v132, 0
    v_mov_b32 v52, 0
    v_mov_b32 v148, 0
    v_mov_b32 v68, 0
    v_mov_b32 v133, 0
    v_mov_b32 v53, 0
    v_mov_b32 v149, 0
    v_mov_b32 v69, 0
    v_mov_b32 v134, 0
    v_mov_b32 v54, 0
    v_mov_b32 v150, 0
    v_mov_b32 v70, 0
    v_mov_b32 v135, 0
    v_mov_b32 v55, 0
    v_mov_b32 v151, 0
    v_mov_b32 v71, 0
    v_mov_b32 v112, 0
    v_mov_b32 v168, 0
    v_mov_b32 v113, 0
    v_mov_b32 v169, 0
    v_mov_b32 v114, 0
    v_mov_b32 v170, 0
    v_mov_b32 v115, 0
    v_mov_b32 v171, 0
    v_mov_b32 v116, 0
    v_mov_b32 v172, 0
    v_mov_b32 v117, 0
    v_mov_b32 v173, 0
    v_mov_b32 v118, 0
    v_mov_b32 v174, 0
    v_mov_b32 v119, 0
    v_mov_b32 v175, 0
    s_waitcnt lgkmcnt(0)
    s_lshl_b32 s5, s79, 5
    s_add_u32 s5, s5, s47
    v_and_b32 v2, 15, v1
    v_add_u32 v2, s5, v2
    s_mov_b32 s6, 1024
    v_mul_lo_u32 v2, v2, s6
    v_bfe_u32 v3, v1, 4, 1
    v_lshl_add_u32 v2, v3, 5, v2
    v_lshrrev_b32 v3, 5, v1
    v_lshl_add_u32 v179, v3, 4, v2
    v_add_u32 v180, 16384, v179
    s_cmp_lg_u32 s44, 0
    s_cbranch_scc1 rel_sequential_preLN__grouped_kv_mqa__mixer_gmlp__prompt_kernel_6
    v_lshlrev_b32 v2, 7, v1
    s_mov_b32 s4, 20480
    s_mov_b64 exec, 0xffffffff
    s_mov_b32 s83, 0x40000
pollk_sequential_preLN__grouped_kv_mqa__mixer_gmlp__prompt_kernel_7:
    buffer_load_dwordx2 v[4:5], v2, s[72:75], s4 offen sc1
    s_waitcnt vmcnt(0)
    v_cmp_ne_u32 vcc, s26, v4
    v_cmp_ne_u32 s[12:13], s26, v5
    s_nop 2
    s_or_b64 vcc, vcc, s[12:13]
    s_cmp_eq_u64 vcc, 0
    s_cbranch_scc1 pollkd_sequential_preLN__grouped_kv_mqa__mixer_gmlp__prompt_kernel_8
    s_sleep 1
    s_sub_u32 s83, s83, 1
    s_cmp_lg_u32 s83, 0
    s_cbranch_scc1 pollk_sequential_preLN__grouped_kv_mqa__mixer_gmlp__prompt_kernel_7
pollkd_sequential_preLN__grouped_kv_mqa__mixer_gmlp__prompt_kernel_8:
    s_mov_b64 exec, -1
rel_sequential_preLN__grouped_kv_mqa__mixer_gmlp__prompt_kernel_6:
    s_barrier
    s_add_u32 s60, s40, 2228224
    s_addc_u32 s61, s41, 0
    s_mov_b32 s62, 512
    s_mov_b32 s63, 0x00020000
    v_lshlrev_b32 v2, 2, v1
    buffer_load_dword v4, v2, s[60:63], 0 offen sc1
    buffer_load_dword v5, v2, s[60:63], 0 offen offset:256 sc1
    s_add_u32 s64, s40, 3145728
    s_addc_u32 s65, s41, 0
    s_mov_b32 s66, 2097152
    s_mov_b32 s67, 0x00020000
    s_waitcnt vmcnt(0)
    v_mov_b32 v72, 0
    v_dot2_f32_bf16 v72, v32, v32, v72
    v_dot2_f32_bf16 v72, v33, v33, v72
    v_dot2_f32_bf16 v72, v34, v34, v72
    v_dot2_f32_bf16 v72, v35, v35, v72
    v_mov_b32 v73, 0
    v_dot2_f32_bf16 v73, v36, v36, v73
    v_dot2_f32_bf16 v73, v37, v37, v73
    v_dot2_f32_bf16 v73, v38, v38, v73
    v_dot2_f32_bf16 v73, v39, v39, v73
    s_nop 2
    v_max_f32 v72, v72, v73
    v_mov_b32 v73, v72
    s_nop 1
    v_permlane32_swap_b32 v73, v72
    v_add_f32 v72, v72, v73
    v_max_f32_dpp v4, v4, v4 row_ror:1 row_mask:0xf bank_mask:0xf
    s_nop 1
    v_max_f32_dpp v4, v4, v4 row_ror:2 row_mask:0xf bank_mask:0xf
    s_nop 1
    v_max_f32_dpp v4, v4, v4 row_ror:4 row_mask:0xf bank_mask:0xf
    s_nop 1
    v_max_f32_dpp v4, v4, v4 row_ror:8 row_mask:0xf bank_mask:0xf
    v_mov_b32 v73, v4
    s_nop 1
    v_permlane16_swap_b32 v73, v4
    v_max_f32 v4, v4, v73
    v_mov_b32 v73, v4
    s_nop 1
    v_permlane32_swap_b32 v73, v4
    v_max_f32 v4, v4, v73
    v_max_f32_dpp v5, v5, v5 row_ror:1 row_mask:0xf bank_mask:0xf
    s_nop 1
    v_max_f32_dpp v5, v5, v5 row_ror:2 row_mask:0xf bank_mask:0xf
    s_nop 1
    v_max_f32_dpp v5, v5, v5 row_ror:4 row_mask:0xf bank_mask:0xf
    s_nop 1
    v_max_f32_dpp v5, v5, v5 row_ror:8 row_mask:0xf bank_mask:0xf
    v_mov_b32 v73, v5
    s_nop 1
    v_permlane16_swap_b32 v73, v5
    v_max_f32 v5, v5, v73
    v_mov_b32 v73, v5
    s_nop 1
    v_permlane32_swap_b32 v73, v5
    v_max_f32 v5, v5, v73
    v_mul_f32 v72, v72, v4
    v_mov_b32 v73, 0x44c80000
    v_cmp_nle_f32 vcc, v72, v73
    v_mov_b32 v73, 0x71800000
    v_cmp_nle_f32 s[12:13], v5, v73
    s_nop 2
    s_or_b64 vcc, vcc, s[12:13]
    s_mov_b32 s86, 0
    s_waitcnt lgkmcnt(0)
    s_barrier
    s_cmp_eq_u64 vcc, 0
    s_cbranch_scc1 sequential_preLN__grouped_kv_mqa__mixer_gmlp__prompt_kernel_fast
    v_mov_b32 v2, 156704
    v_mov_b32 v3, 1
    ds_write_b32 v2, v3
    s_waitcnt lgkmcnt(0)
    s_barrier
    s_barrier
    s_barrier
    s_mov_b32 s86, 1
    v_mov_b32 v2, 0xff800000
    v_mov_b32 v3, 0xff800000
    v_mov_b32 v4, v176
    s_mov_b32 s85, 0
sequential_preLN__grouped_kv_mqa__mixer_gmlp__prompt_kernel_maxloop:
    ds_read_b128 v[152:155], v4
    v_add_u32 v4, 1024, v4
    s_waitcnt lgkmcnt(0)
    v_mfma_f32_32x32x16_bf16 v[72:87], v[152:155], v[32:35], 0
    v_mfma_f32_32x32x16_bf16 v[88:103], v[152:155], v[36:39], 0
    s_nop 10
    v_max3_f32 v2, v72, v73, v2
    v_max3_f32 v2, v74, v75, v2
    v_max3_f32 v2, v76, v77, v2
    v_max3_f32 v2, v78, v79, v2
    v_max3_f32 v2, v80, v81, v2
    v_max3_f32 v2, v82, v83, v2
    v_max3_f32 v2, v84, v85, v2
    v_max3_f32 v2, v86, v87, v2
    v_max3_f32 v3, v88, v89, v3
    v_max3_f32 v3, v90, v91, v3
    v_max3_f32 v3, v92, v93, v3
    v_max3_f32 v3, v94, v95, v3
    v_max3_f32 v3, v96, v97, v3
    v_max3_f32 v3, v98, v99, v3
    v_max3_f32 v3, v100, v101, v3
    v_max3_f32 v3, v102, v103, v3
    s_add_u32 s85, s85, 1
    s_cmp_lt_u32 s85, 64
    s_cbranch_scc1 sequential_preLN__grouped_kv_mqa__mixer_gmlp__prompt_kernel_maxloop
    v_mov_b32 v4, v2
    s_nop 1
    v_permlane32_swap_b32 v4, v2
    v_max_f32 v2, v2, v4
    v_sub_f32 v40, 0, v2
    v_sub_f32 v41, 0, v2
    v_sub_f32 v42, 0, v2
    v_sub_f32 v43, 0, v2
    v_sub_f32 v44, 0, v2
    v_sub_f32 v45, 0, v2
    v_sub_f32 v46, 0, v2
    v_sub_f32 v47, 0, v2
    v_sub_f32 v48, 0, v2
    v_sub_f32 v49, 0, v2
    v_sub_f32 v50, 0, v2
    v_sub_f32 v51, 0, v2
    v_sub_f32 v52, 0, v2
    v_sub_f32 v53, 0, v2
    v_sub_f32 v54, 0, v2
    v_sub_f32 v55, 0, v2
    v_mov_b32 v4, v3
    s_nop 1
    v_permlane32_swap_b32 v4, v3
    v_max_f32 v3, v3, v4
    v_sub_f32 v56, 0, v3
    v_sub_f32 v57, 0, v3
    v_sub_f32 v58, 0, v3
    v_sub_f32 v59, 0, v3
    v_sub_f32 v60, 0, v3
    v_sub_f32 v61, 0, v3
    v_sub_f32 v62, 0, v3
    v_sub_f32 v63, 0, v3
    v_sub_f32 v64, 0, v3
    v_sub_f32 v65, 0, v3
    v_sub_f32 v66, 0, v3
    v_sub_f32 v67, 0, v3
    v_sub_f32 v68, 0, v3
    v_sub_f32 v69, 0, v3
    v_sub_f32 v70, 0, v3
    v_sub_f32 v71, 0, v3
sequential_preLN__grouped_kv_mqa__mixer_gmlp__prompt_kernel_fast:
    ds_read_b128 v[152:155], v176
    s_waitcnt lgkmcnt(0)
    v_mfma_f32_32x32x16_bf16 v[72:87], v[152:155], v[32:35], v[40:55]
    s_mov_b32 s85, 4
    s_nop 15
    .p2align 6
sequential_preLN__grouped_kv_mqa__mixer_gmlp__prompt_kernel_aloop:
    v_mfma_f32_32x32x16_bf16 v[88:103], v[152:155], v[36:39], v[56:71]
    ds_read_b128 v[156:159], v176 offset:1024
    v_exp_f32 v72, v72
    v_exp_f32 v73, v73
    v_exp_f32 v74, v74
    v_exp_f32 v75, v75
    v_exp_f32 v76, v76
    v_exp_f32 v77, v77
    v_mfma_f32_32x32x16_bf16 v[136:151], v[168:171], v[112:115], v[136:151]
    ds_read_b128 v[160:163], v177 offset:0
    v_exp_f32 v78, v78
    v_exp_f32 v79, v79
    v_exp_f32 v80, v80
    v_exp_f32 v81, v81
    v_exp_f32 v82, v82
    v_mfma_f32_32x32x16_bf16 v[136:151], v[172:175], v[116:119], v[136:151]
    ds_read_b128 v[164:167], v177 offset:512
    v_exp_f32 v83, v83
    v_exp_f32 v84, v84
    v_exp_f32 v85, v85
    v_exp_f32 v86, v86
    v_exp_f32 v87, v87
    v_cvt_pk_bf16_f32 v104, v72, v73
    v_cvt_pk_bf16_f32 v105, v74, v75
    v_cvt_pk_bf16_f32 v106, v76, v77
    v_cvt_pk_bf16_f32 v107, v78, v79
    v_cvt_pk_bf16_f32 v108, v80, v81
    v_cvt_pk_bf16_f32 v109, v82, v83
    v_cvt_pk_bf16_f32 v110, v84, v85
    v_cvt_pk_bf16_f32 v111, v86, v87
    s_waitcnt lgkmcnt(0)
    v_mfma_f32_32x32x16_bf16 v[72:87], v[156:159], v[32:35], v[40:55]
    v_exp_f32 v88, v88
    v_exp_f32 v89, v89
    v_exp_f32 v90, v90
    v_exp_f32 v91, v91
    v_exp_f32 v92, v92
    v_exp_f32 v93, v93
    v_mfma_f32_32x32x16_bf16 v[120:135], v[160:163], v[104:107], v[120:135]
    v_exp_f32 v94, v94
    v_exp_f32 v95, v95
    v_exp_f32 v96, v96
    v_exp_f32 v97, v97
    v_exp_f32 v98, v98
    v_mfma_f32_32x32x16_bf16 v[120:135], v[164:167], v[108:111], v[120:135]
    v_exp_f32 v99, v99
    v_exp_f32 v100, v100
    v_exp_f32 v101, v101
    v_exp_f32 v102, v102
    v_exp_f32 v103, v103
    v_cvt_pk_bf16_f32 v112, v88, v89
    v_cvt_pk_bf16_f32 v113, v90, v91
    v_cvt_pk_bf16_f32 v114, v92, v93
    v_cvt_pk_bf16_f32 v115, v94, v95
    v_cvt_pk_bf16_f32 v116, v96, v97
    v_cvt_pk_bf16_f32 v117, v98, v99
    v_cvt_pk_bf16_f32 v118, v100, v101
    v_cvt_pk_bf16_f32 v119, v102, v103
    v_mfma_f32_32x32x16_bf16 v[88:103], v[156:159], v[36:39], v[56:71]
    ds_read_b128 v[152:155], v176 offset:2048
    v_exp_f32 v72, v72
    v_exp_f32 v73, v73
    v_exp_f32 v74, v74
    v_exp_f32 v75, v75
    v_exp_f32 v76, v76
    v_exp_f32 v77, v77
    v_mfma_f32_32x32x16_bf16 v[136:151], v[160:163], v[112:115], v[136:151]
    ds_read_b128 v[168:171], v177 offset:1024
    v_exp_f32 v78, v78
    v_exp_f32 v79, v79
    v_exp_f32 v80, v80
    v_exp_f32 v81, v81
    v_exp_f32 v82, v82
    v_mfma_f32_32x32x16_bf16 v[136:151], v[164:167], v[116:119], v[136:151]
    ds_read_b128 v[172:175], v177 offset:1536
    v_exp_f32 v83, v83
    v_exp_f32 v84, v84
    v_exp_f32 v85, v85
    v_exp_f32 v86, v86
    v_exp_f32 v87, v87
    v_cvt_pk_bf16_f32 v104, v72, v73
    v_cvt_pk_bf16_f32 v105, v74, v75
    v_cvt_pk_bf16_f32 v106, v76, v77
    v_cvt_pk_bf16_f32 v107, v78, v79
    v_cvt_pk_bf16_f32 v108, v80, v81
    v_cvt_pk_bf16_f32 v109, v82, v83
    v_cvt_pk_bf16_f32 v110, v84, v85
    v_cvt_pk_bf16_f32 v111, v86, v87
    s_waitcnt lgkmcnt(0)
    v_mfma_f32_32x32x16_bf16 v[72:87], v[152:155], v[32:35], v[40:55]
    v_exp_f32 v88, v88
    v_exp_f32 v89, v89
    v_exp_f32 v90, v90
    v_exp_f32 v91, v91
    v_exp_f32 v92, v92
    v_exp_f32 v93, v93
    v_mfma_f32_32x32x16_bf16 v[120:135], v[168:171], v[104:107], v[120:135]
    v_exp_f32 v94, v94
    v_exp_f32 v95, v95
    v_exp_f32 v96, v96
    v_exp_f32 v97, v97
    v_exp_f32 v98, v98
    v_mfma_f32_32x32x16_bf16 v[120:135], v[172:175], v[108:111], v[120:135]
    v_exp_f32 v99, v99
    v_exp_f32 v100, v100
    v_exp_f32 v101, v101
    v_exp_f32 v102, v102
    v_exp_f32 v103, v103
    v_cvt_pk_bf16_f32 v112, v88, v89
    v_cvt_pk_bf16_f32 v113, v90, v91
    v_cvt_pk_bf16_f32 v114, v92, v93
    v_cvt_pk_bf16_f32 v115, v94, v95
    v_cvt_pk_bf16_f32 v116, v96, v97
    v_cvt_pk_bf16_f32 v117, v98, v99
    v_cvt_pk_bf16_f32 v118, v100, v101
    v_cvt_pk_bf16_f32 v119, v102, v103
    v_mfma_f32_32x32x16_bf16 v[88:103], v[152:155], v[36:39], v[56:71]
    ds_read_b128 v[156:159], v176 offset:3072
    v_exp_f32 v72, v72
    v_exp_f32 v73, v73
    v_exp_f32 v74, v74
    v_exp_f32 v75, v75
    v_exp_f32 v76, v76
    v_exp_f32 v77, v77
    v_mfma_f32_32x32x16_bf16 v[136:151], v[168:171], v[112:115], v[136:151]
    ds_read_b128 v[160:163], v177 offset:2048
    v_exp_f32 v78, v78
    v_exp_f32 v79, v79
    v_exp_f32 v80, v80
    v_exp_f32 v81, v81
    v_exp_f32 v82, v82
    v_mfma_f32_32x32x16_bf16 v[136:151], v[172:175], v[116:119], v[136:151]
    ds_read_b128 v[164:167], v177 offset:2560
    v_exp_f32 v83, v83
    v_exp_f32 v84, v84
    v_exp_f32 v85, v85
    v_exp_f32 v86, v86
    v_exp_f32 v87, v87
    v_cvt_pk_bf16_f32 v104, v72, v73
    v_cvt_pk_bf16_f32 v105, v74, v75
    v_cvt_pk_bf16_f32 v106, v76, v77
    v_cvt_pk_bf16_f32 v107, v78, v79
    v_cvt_pk_bf16_f32 v108, v80, v81
    v_cvt_pk_bf16_f32 v109, v82, v83
    v_cvt_pk_bf16_f32 v110, v84, v85
    v_cvt_pk_bf16_f32 v111, v86, v87
    s_waitcnt lgkmcnt(0)
    v_mfma_f32_32x32x16_bf16 v[72:87], v[156:159], v[32:35], v[40:55]
    v_exp_f32 v88, v88
    v_exp_f32 v89, v89
    v_exp_f32 v90, v90
    v_exp_f32 v91, v91
    v_exp_f32 v92, v92
    v_exp_f32 v93, v93
    v_mfma_f32_32x32x16_bf16 v[120:135], v[160:163], v[104:107], v[120:135]
    v_exp_f32 v94, v94
    v_exp_f32 v95, v95
    v_exp_f32 v96, v96
    v_exp_f32 v97, v97
    v_exp_f32 v98, v98
    v_mfma_f32_32x32x16_bf16 v[120:135], v[164:167], v[108:111], v[120:135]
    v_exp_f32 v99, v99
    v_exp_f32 v100, v100
    v_exp_f32 v101, v101
    v_exp_f32 v102, v102
    v_exp_f32 v103, v103
    v_cvt_pk_bf16_f32 v112, v88, v89
    v_cvt_pk_bf16_f32 v113, v90, v91
    v_cvt_pk_bf16_f32 v114, v92, v93
    v_cvt_pk_bf16_f32 v115, v94, v95
    v_cvt_pk_bf16_f32 v116, v96, v97
    v_cvt_pk_bf16_f32 v117, v98, v99
    v_cvt_pk_bf16_f32 v118, v100, v101
    v_cvt_pk_bf16_f32 v119, v102, v103
    v_mfma_f32_32x32x16_bf16 v[88:103], v[156:159], v[36:39], v[56:71]
    ds_read_b128 v[152:155], v176 offset:4096
    v_exp_f32 v72, v72
    v_exp_f32 v73, v73
    v_exp_f32 v74, v74
    v_exp_f32 v75, v75
    v_exp_f32 v76, v76
    v_exp_f32 v77, v77
    v_mfma_f32_32x32x16_bf16 v[136:151], v[160:163], v[112:115], v[136:151]
    ds_read_b128 v[168:171], v177 offset:3072
    v_exp_f32 v78, v78
    v_exp_f32 v79, v79
    v_exp_f32 v80, v80
    v_exp_f32 v81, v81
    v_exp_f32 v82, v82
    v_mfma_f32_32x32x16_bf16 v[136:151], v[164:167], v[116:119], v[136:151]
    ds_read_b128 v[172:175], v177 offset:3584
    v_exp_f32 v83, v83
    v_exp_f32 v84, v84
    v_exp_f32 v85, v85
    v_exp_f32 v86, v86
    v_exp_f32 v87, v87
    v_cvt_pk_bf16_f32 v104, v72, v73
    v_cvt_pk_bf16_f32 v105, v74, v75
    v_cvt_pk_bf16_f32 v106, v76, v77
    v_cvt_pk_bf16_f32 v107, v78, v79
    v_cvt_pk_bf16_f32 v108, v80, v81
    v_cvt_pk_bf16_f32 v109, v82, v83
    v_cvt_pk_bf16_f32 v110, v84, v85
    v_cvt_pk_bf16_f32 v111, v86, v87
    s_waitcnt lgkmcnt(0)
    v_mfma_f32_32x32x16_bf16 v[72:87], v[152:155], v[32:35], v[40:55]
    v_exp_f32 v88, v88
    v_exp_f32 v89, v89
    v_exp_f32 v90, v90
    v_exp_f32 v91, v91
    v_exp_f32 v92, v92
    v_exp_f32 v93, v93
    v_mfma_f32_32x32x16_bf16 v[120:135], v[168:171], v[104:107], v[120:135]
    v_exp_f32 v94, v94
    v_exp_f32 v95, v95
    v_exp_f32 v96, v96
    v_exp_f32 v97, v97
    v_exp_f32 v98, v98
    v_mfma_f32_32x32x16_bf16 v[120:135], v[172:175], v[108:111], v[120:135]
    v_exp_f32 v99, v99
    v_exp_f32 v100, v100
    v_exp_f32 v101, v101
    v_exp_f32 v102, v102
    v_exp_f32 v103, v103
    v_cvt_pk_bf16_f32 v112, v88, v89
    v_cvt_pk_bf16_f32 v113, v90, v91
    v_cvt_pk_bf16_f32 v114, v92, v93
    v_cvt_pk_bf16_f32 v115, v94, v95
    v_cvt_pk_bf16_f32 v116, v96, v97
    v_cvt_pk_bf16_f32 v117, v98, v99
    v_cvt_pk_bf16_f32 v118, v100, v101
    v_cvt_pk_bf16_f32 v119, v102, v103
    v_mfma_f32_32x32x16_bf16 v[88:103], v[152:155], v[36:39], v[56:71]
    ds_read_b128 v[156:159], v176 offset:5120
    v_exp_f32 v72, v72
    v_exp_f32 v73, v73
    v_exp_f32 v74, v74
    v_exp_f32 v75, v75
    v_exp_f32 v76, v76
    v_exp_f32 v77, v77
    v_mfma_f32_32x32x16_bf16 v[136:151], v[168:171], v[112:115], v[136:151]
    ds_read_b128 v[160:163], v177 offset:4096
    v_exp_f32 v78, v78
    v_exp_f32 v79, v79
    v_exp_f32 v80, v80
    v_exp_f32 v81, v81
    v_exp_f32 v82, v82
    v_mfma_f32_32x32x16_bf16 v[136:151], v[172:175], v[116:119], v[136:151]
    ds_read_b128 v[164:167], v177 offset:4608
    v_exp_f32 v83, v83
    v_exp_f32 v84, v84
    v_exp_f32 v85, v85
    v_exp_f32 v86, v86
    v_exp_f32 v87, v87
    v_cvt_pk_bf16_f32 v104, v72, v73
    v_cvt_pk_bf16_f32 v105, v74, v75
    v_cvt_pk_bf16_f32 v106, v76, v77
    v_cvt_pk_bf16_f32 v107, v78, v79
    v_cvt_pk_bf16_f32 v108, v80, v81
    v_cvt_pk_bf16_f32 v109, v82, v83
    v_cvt_pk_bf16_f32 v110, v84, v85
    v_cvt_pk_bf16_f32 v111, v86, v87
    s_waitcnt lgkmcnt(0)
    v_mfma_f32_32x32x16_bf16 v[72:87], v[156:159], v[32:35], v[40:55]
    v_exp_f32 v88, v88
    v_exp_f32 v89, v89
    v_exp_f32 v90, v90
    v_exp_f32 v91, v91
    v_exp_f32 v92, v92
    v_exp_f32 v93, v93
    v_mfma_f32_32x32x16_bf16 v[120:135], v[160:163], v[104:107], v[120:135]
    v_exp_f32 v94, v94
    v_exp_f32 v95, v95
    v_exp_f32 v96, v96
    v_exp_f32 v97, v97
    v_exp_f32 v98, v98
    v_mfma_f32_32x32x16_bf16 v[120:135], v[164:167], v[108:111], v[120:135]
    v_exp_f32 v99, v99
    v_exp_f32 v100, v100
    v_exp_f32 v101, v101
    v_exp_f32 v102, v102
    v_exp_f32 v103, v103
    v_cvt_pk_bf16_f32 v112, v88, v89
    v_cvt_pk_bf16_f32 v113, v90, v91
    v_cvt_pk_bf16_f32 v114, v92, v93
    v_cvt_pk_bf16_f32 v115, v94, v95
    v_cvt_pk_bf16_f32 v116, v96, v97
    v_cvt_pk_bf16_f32 v117, v98, v99
    v_cvt_pk_bf16_f32 v118, v100, v101
    v_cvt_pk_bf16_f32 v119, v102, v103
    v_mfma_f32_32x32x16_bf16 v[88:103], v[156:159], v[36:39], v[56:71]
    ds_read_b128 v[152:155], v176 offset:6144
    v_exp_f32 v72, v72
    v_exp_f32 v73, v73
    v_exp_f32 v74, v74
    v_exp_f32 v75, v75
    v_exp_f32 v76, v76
    v_exp_f32 v77, v77
    v_mfma_f32_32x32x16_bf16 v[136:151], v[160:163], v[112:115], v[136:151]
    ds_read_b128 v[168:171], v177 offset:5120
    v_exp_f32 v78, v78
    v_exp_f32 v79, v79
    v_exp_f32 v80, v80
    v_exp_f32 v81, v81
    v_exp_f32 v82, v82
    v_mfma_f32_32x32x16_bf16 v[136:151], v[164:167], v[116:119], v[136:151]
    ds_read_b128 v[172:175], v177 offset:5632
    v_exp_f32 v83, v83
    v_exp_f32 v84, v84
    v_exp_f32 v85, v85
    v_exp_f32 v86, v86
    v_exp_f32 v87, v87
    v_cvt_pk_bf16_f32 v104, v72, v73
    v_cvt_pk_bf16_f32 v105, v74, v75
    v_cvt_pk_bf16_f32 v106, v76, v77
    v_cvt_pk_bf16_f32 v107, v78, v79
    v_cvt_pk_bf16_f32 v108, v80, v81
    v_cvt_pk_bf16_f32 v109, v82, v83
    v_cvt_pk_bf16_f32 v110, v84, v85
    v_cvt_pk_bf16_f32 v111, v86, v87
    s_waitcnt lgkmcnt(0)
    v_mfma_f32_32x32x16_bf16 v[72:87], v[152:155], v[32:35], v[40:55]
    v_exp_f32 v88, v88
    v_exp_f32 v89, v89
    v_exp_f32 v90, v90
    v_exp_f32 v91, v91
    v_exp_f32 v92, v92
    v_exp_f32 v93, v93
    v_mfma_f32_32x32x16_bf16 v[120:135], v[168:171], v[104:107], v[120:135]
    v_exp_f32 v94, v94
    v_exp_f32 v95, v95
    v_exp_f32 v96, v96
    v_exp_f32 v97, v97
    v_exp_f32 v98, v98
    v_mfma_f32_32x32x16_bf16 v[120:135], v[172:175], v[108:111], v[120:135]
    v_exp_f32 v99, v99
    v_exp_f32 v100, v100
    v_exp_f32 v101, v101
    v_exp_f32 v102, v102
    v_exp_f32 v103, v103
    v_cvt_pk_bf16_f32 v112, v88, v89
    v_cvt_pk_bf16_f32 v113, v90, v91
    v_cvt_pk_bf16_f32 v114, v92, v93
    v_cvt_pk_bf16_f32 v115, v94, v95
    v_cvt_pk_bf16_f32 v116, v96, v97
    v_cvt_pk_bf16_f32 v117, v98, v99
    v_cvt_pk_bf16_f32 v118, v100, v101
    v_cvt_pk_bf16_f32 v119, v102, v103
    v_mfma_f32_32x32x16_bf16 v[88:103], v[152:155], v[36:39], v[56:71]
    ds_read_b128 v[156:159], v176 offset:7168
    v_exp_f32 v72, v72
    v_exp_f32 v73, v73
    v_exp_f32 v74, v74
    v_exp_f32 v75, v75
    v_exp_f32 v76, v76
    v_exp_f32 v77, v77
    v_mfma_f32_32x32x16_bf16 v[136:151], v[168:171], v[112:115], v[136:151]
    ds_read_b128 v[160:163], v177 offset:6144
    v_exp_f32 v78, v78
    v_exp_f32 v79, v79
    v_exp_f32 v80, v80
    v_exp_f32 v81, v81
    v_exp_f32 v82, v82
    v_mfma_f32_32x32x16_bf16 v[136:151], v[172:175], v[116:119], v[136:151]
    ds_read_b128 v[164:167], v177 offset:6656
    v_exp_f32 v83, v83
    v_exp_f32 v84, v84
    v_exp_f32 v85, v85
    v_exp_f32 v86, v86
    v_exp_f32 v87, v87
    v_cvt_pk_bf16_f32 v104, v72, v73
    v_cvt_pk_bf16_f32 v105, v74, v75
    v_cvt_pk_bf16_f32 v106, v76, v77
    v_cvt_pk_bf16_f32 v107, v78, v79
    v_cvt_pk_bf16_f32 v108, v80, v81
    v_cvt_pk_bf16_f32 v109, v82, v83
    v_cvt_pk_bf16_f32 v110, v84, v85
    v_cvt_pk_bf16_f32 v111, v86, v87
    s_waitcnt lgkmcnt(0)
    v_mfma_f32_32x32x16_bf16 v[72:87], v[156:159], v[32:35], v[40:55]
    v_exp_f32 v88, v88
    v_exp_f32 v89, v89
    v_exp_f32 v90, v90
    v_exp_f32 v91, v91
    v_exp_f32 v92, v92
    v_exp_f32 v93, v93
    v_mfma_f32_32x32x16_bf16 v[120:135], v[160:163], v[104:107], v[120:135]
    v_exp_f32 v94, v94
    v_exp_f32 v95, v95
    v_exp_f32 v96, v96
    v_exp_f32 v97, v97
    v_exp_f32 v98, v98
    v_mfma_f32_32x32x16_bf16 v[120:135], v[164:167], v[108:111], v[120:135]
    v_exp_f32 v99, v99
    v_exp_f32 v100, v100
    v_exp_f32 v101, v101
    v_exp_f32 v102, v102
    v_exp_f32 v103, v103
    v_cvt_pk_bf16_f32 v112, v88, v89
    v_cvt_pk_bf16_f32 v113, v90, v91
    v_cvt_pk_bf16_f32 v114, v92, v93
    v_cvt_pk_bf16_f32 v115, v94, v95
    v_cvt_pk_bf16_f32 v116, v96, v97
    v_cvt_pk_bf16_f32 v117, v98, v99
    v_cvt_pk_bf16_f32 v118, v100, v101
    v_cvt_pk_bf16_f32 v119, v102, v103
    v_mfma_f32_32x32x16_bf16 v[88:103], v[156:159], v[36:39], v[56:71]
    ds_read_b128 v[152:155], v176 offset:8192
    v_exp_f32 v72, v72
    v_exp_f32 v73, v73
    v_exp_f32 v74, v74
    v_exp_f32 v75, v75
    v_exp_f32 v76, v76
    v_exp_f32 v77, v77
    v_mfma_f32_32x32x16_bf16 v[136:151], v[160:163], v[112:115], v[136:151]
    ds_read_b128 v[168:171], v177 offset:7168
    v_exp_f32 v78, v78
    v_exp_f32 v79, v79
    v_exp_f32 v80, v80
    v_exp_f32 v81, v81
    v_exp_f32 v82, v82
    v_mfma_f32_32x32x16_bf16 v[136:151], v[164:167], v[116:119], v[136:151]
    ds_read_b128 v[172:175], v177 offset:7680
    v_exp_f32 v83, v83
    v_exp_f32 v84, v84
    v_exp_f32 v85, v85
    v_exp_f32 v86, v86
    v_exp_f32 v87, v87
    v_cvt_pk_bf16_f32 v104, v72, v73
    v_cvt_pk_bf16_f32 v105, v74, v75
    v_cvt_pk_bf16_f32 v106, v76, v77
    v_cvt_pk_bf16_f32 v107, v78, v79
    v_cvt_pk_bf16_f32 v108, v80, v81
    v_cvt_pk_bf16_f32 v109, v82, v83
    v_cvt_pk_bf16_f32 v110, v84, v85
    v_cvt_pk_bf16_f32 v111, v86, v87
    s_waitcnt lgkmcnt(0)
    v_mfma_f32_32x32x16_bf16 v[72:87], v[152:155], v[32:35], v[40:55]
    v_exp_f32 v88, v88
    v_exp_f32 v89, v89
    v_exp_f32 v90, v90
    v_exp_f32 v91, v91
    v_exp_f32 v92, v92
    v_exp_f32 v93, v93
    v_mfma_f32_32x32x16_bf16 v[120:135], v[168:171], v[104:107], v[120:135]
    v_exp_f32 v94, v94
    v_exp_f32 v95, v95
    v_exp_f32 v96, v96
    v_exp_f32 v97, v97
    v_exp_f32 v98, v98
    v_mfma_f32_32x32x16_bf16 v[120:135], v[172:175], v[108:111], v[120:135]
    v_exp_f32 v99, v99
    v_exp_f32 v100, v100
    v_exp_f32 v101, v101
    v_exp_f32 v102, v102
    v_exp_f32 v103, v103
    v_cvt_pk_bf16_f32 v112, v88, v89
    v_cvt_pk_bf16_f32 v113, v90, v91
    v_cvt_pk_bf16_f32 v114, v92, v93
    v_cvt_pk_bf16_f32 v115, v94, v95
    v_cvt_pk_bf16_f32 v116, v96, v97
    v_cvt_pk_bf16_f32 v117, v98, v99
    v_cvt_pk_bf16_f32 v118, v100, v101
    v_cvt_pk_bf16_f32 v119, v102, v103
    v_mfma_f32_32x32x16_bf16 v[88:103], v[152:155], v[36:39], v[56:71]
    ds_read_b128 v[156:159], v176 offset:9216
    v_exp_f32 v72, v72
    v_exp_f32 v73, v73
    v_exp_f32 v74, v74
    v_exp_f32 v75, v75
    v_exp_f32 v76, v76
    v_exp_f32 v77, v77
    v_mfma_f32_32x32x16_bf16 v[136:151], v[168:171], v[112:115], v[136:151]
    ds_read_b128 v[160:163], v177 offset:8192
    v_exp_f32 v78, v78
    v_exp_f32 v79, v79
    v_exp_f32 v80, v80
    v_exp_f32 v81, v81
    v_exp_f32 v82, v82
    v_mfma_f32_32x32x16_bf16 v[136:151], v[172:175], v[116:119], v[136:151]
    ds_read_b128 v[164:167], v177 offset:8704
    v_exp_f32 v83, v83
    v_exp_f32 v84, v84
    v_exp_f32 v85, v85
    v_exp_f32 v86, v86
    v_exp_f32 v87, v87
    v_cvt_pk_bf16_f32 v104, v72, v73
    v_cvt_pk_bf16_f32 v105, v74, v75
    v_cvt_pk_bf16_f32 v106, v76, v77
    v_cvt_pk_bf16_f32 v107, v78, v79
    v_cvt_pk_bf16_f32 v108, v80, v81
    v_cvt_pk_bf16_f32 v109, v82, v83
    v_cvt_pk_bf16_f32 v110, v84, v85
    v_cvt_pk_bf16_f32 v111, v86, v87
    s_waitcnt lgkmcnt(0)
    v_mfma_f32_32x32x16_bf16 v[72:87], v[156:159], v[32:35], v[40:55]
    v_exp_f32 v88, v88
    v_exp_f32 v89, v89
    v_exp_f32 v90, v90
    v_exp_f32 v91, v91
    v_exp_f32 v92, v92
    v_exp_f32 v93, v93
    v_mfma_f32_32x32x16_bf16 v[120:135], v[160:163], v[104:107], v[120:135]
    v_exp_f32 v94, v94
    v_exp_f32 v95, v95
    v_exp_f32 v96, v96
    v_exp_f32 v97, v97
    v_exp_f32 v98, v98
    v_mfma_f32_32x32x16_bf16 v[120:135], v[164:167], v[108:111], v[120:135]
    v_exp_f32 v99, v99
    v_exp_f32 v100, v100
    v_exp_f32 v101, v101
    v_exp_f32 v102, v102
    v_exp_f32 v103, v103
    v_cvt_pk_bf16_f32 v112, v88, v89
    v_cvt_pk_bf16_f32 v113, v90, v91
    v_cvt_pk_bf16_f32 v114, v92, v93
    v_cvt_pk_bf16_f32 v115, v94, v95
    v_cvt_pk_bf16_f32 v116, v96, v97
    v_cvt_pk_bf16_f32 v117, v98, v99
    v_cvt_pk_bf16_f32 v118, v100, v101
    v_cvt_pk_bf16_f32 v119, v102, v103
    v_mfma_f32_32x32x16_bf16 v[88:103], v[156:159], v[36:39], v[56:71]
    ds_read_b128 v[152:155], v176 offset:10240
    v_exp_f32 v72, v72
    v_exp_f32 v73, v73
    v_exp_f32 v74, v74
    v_exp_f32 v75, v75
    v_exp_f32 v76, v76
    v_exp_f32 v77, v77
    v_mfma_f32_32x32x16_bf16 v[136:151], v[160:163], v[112:115], v[136:151]
    ds_read_b128 v[168:171], v177 offset:9216
    v_exp_f32 v78, v78
    v_exp_f32 v79, v79
    v_exp_f32 v80, v80
    v_exp_f32 v81, v81
    v_exp_f32 v82, v82
    v_mfma_f32_32x32x16_bf16 v[136:151], v[164:167], v[116:119], v[136:151]
    ds_read_b128 v[172:175], v177 offset:9728
    v_exp_f32 v83, v83
    v_exp_f32 v84, v84
    v_exp_f32 v85, v85
    v_exp_f32 v86, v86
    v_exp_f32 v87, v87
    v_cvt_pk_bf16_f32 v104, v72, v73
    v_cvt_pk_bf16_f32 v105, v74, v75
    v_cvt_pk_bf16_f32 v106, v76, v77
    v_cvt_pk_bf16_f32 v107, v78, v79
    v_cvt_pk_bf16_f32 v108, v80, v81
    v_cvt_pk_bf16_f32 v109, v82, v83
    v_cvt_pk_bf16_f32 v110, v84, v85
    v_cvt_pk_bf16_f32 v111, v86, v87
    s_waitcnt lgkmcnt(0)
    v_mfma_f32_32x32x16_bf16 v[72:87], v[152:155], v[32:35], v[40:55]
    v_exp_f32 v88, v88
    v_exp_f32 v89, v89
    v_exp_f32 v90, v90
    v_exp_f32 v91, v91
    v_exp_f32 v92, v92
    v_exp_f32 v93, v93
    v_mfma_f32_32x32x16_bf16 v[120:135], v[168:171], v[104:107], v[120:135]
    v_exp_f32 v94, v94
    v_exp_f32 v95, v95
    v_exp_f32 v96, v96
    v_exp_f32 v97, v97
    v_exp_f32 v98, v98
    v_mfma_f32_32x32x16_bf16 v[120:135], v[172:175], v[108:111], v[120:135]
    v_exp_f32 v99, v99
    v_exp_f32 v100, v100
    v_exp_f32 v101, v101
    v_exp_f32 v102, v102
    v_exp_f32 v103, v103
    v_cvt_pk_bf16_f32 v112, v88, v89
    v_cvt_pk_bf16_f32 v113, v90, v91
    v_cvt_pk_bf16_f32 v114, v92, v93
    v_cvt_pk_bf16_f32 v115, v94, v95
    v_cvt_pk_bf16_f32 v116, v96, v97
    v_cvt_pk_bf16_f32 v117, v98, v99
    v_cvt_pk_bf16_f32 v118, v100, v101
    v_cvt_pk_bf16_f32 v119, v102, v103
    v_mfma_f32_32x32x16_bf16 v[88:103], v[152:155], v[36:39], v[56:71]
    ds_read_b128 v[156:159], v176 offset:11264
    v_exp_f32 v72, v72
    v_exp_f32 v73, v73
    v_exp_f32 v74, v74
    v_exp_f32 v75, v75
    v_exp_f32 v76, v76
    v_exp_f32 v77, v77
    v_mfma_f32_32x32x16_bf16 v[136:151], v[168:171], v[112:115], v[136:151]
    ds_read_b128 v[160:163], v177 offset:10240
    v_exp_f32 v78, v78
    v_exp_f32 v79, v79
    v_exp_f32 v80, v80
    v_exp_f32 v81, v81
    v_exp_f32 v82, v82
    v_mfma_f32_32x32x16_bf16 v[136:151], v[172:175], v[116:119], v[136:151]
    ds_read_b128 v[164:167], v177 offset:10752
    v_exp_f32 v83, v83
    v_exp_f32 v84, v84
    v_exp_f32 v85, v85
    v_exp_f32 v86, v86
    v_exp_f32 v87, v87
    v_cvt_pk_bf16_f32 v104, v72, v73
    v_cvt_pk_bf16_f32 v105, v74, v75
    v_cvt_pk_bf16_f32 v106, v76, v77
    v_cvt_pk_bf16_f32 v107, v78, v79
    v_cvt_pk_bf16_f32 v108, v80, v81
    v_cvt_pk_bf16_f32 v109, v82, v83
    v_cvt_pk_bf16_f32 v110, v84, v85
    v_cvt_pk_bf16_f32 v111, v86, v87
    s_waitcnt lgkmcnt(0)
    v_mfma_f32_32x32x16_bf16 v[72:87], v[156:159], v[32:35], v[40:55]
    v_exp_f32 v88, v88
    v_exp_f32 v89, v89
    v_exp_f32 v90, v90
    v_exp_f32 v91, v91
    v_exp_f32 v92, v92
    v_exp_f32 v93, v93
    v_mfma_f32_32x32x16_bf16 v[120:135], v[160:163], v[104:107], v[120:135]
    v_exp_f32 v94, v94
    v_exp_f32 v95, v95
    v_exp_f32 v96, v96
    v_exp_f32 v97, v97
    v_exp_f32 v98, v98
    v_mfma_f32_32x32x16_bf16 v[120:135], v[164:167], v[108:111], v[120:135]
    v_exp_f32 v99, v99
    v_exp_f32 v100, v100
    v_exp_f32 v101, v101
    v_exp_f32 v102, v102
    v_exp_f32 v103, v103
    v_cvt_pk_bf16_f32 v112, v88, v89
    v_cvt_pk_bf16_f32 v113, v90, v91
    v_cvt_pk_bf16_f32 v114, v92, v93
    v_cvt_pk_bf16_f32 v115, v94, v95
    v_cvt_pk_bf16_f32 v116, v96, v97
    v_cvt_pk_bf16_f32 v117, v98, v99
    v_cvt_pk_bf16_f32 v118, v100, v101
    v_cvt_pk_bf16_f32 v119, v102, v103
    v_mfma_f32_32x32x16_bf16 v[88:103], v[156:159], v[36:39], v[56:71]
    ds_read_b128 v[152:155], v176 offset:12288
    v_exp_f32 v72, v72
    v_exp_f32 v73, v73
    v_exp_f32 v74, v74
    v_exp_f32 v75, v75
    v_exp_f32 v76, v76
    v_exp_f32 v77, v77
    v_mfma_f32_32x32x16_bf16 v[136:151], v[160:163], v[112:115], v[136:151]
    ds_read_b128 v[168:171], v177 offset:11264
    v_exp_f32 v78, v78
    v_exp_f32 v79, v79
    v_exp_f32 v80, v80
    v_exp_f32 v81, v81
    v_exp_f32 v82, v82
    v_mfma_f32_32x32x16_bf16 v[136:151], v[164:167], v[116:119], v[136:151]
    ds_read_b128 v[172:175], v177 offset:11776
    v_exp_f32 v83, v83
    v_exp_f32 v84, v84
    v_exp_f32 v85, v85
    v_exp_f32 v86, v86
    v_exp_f32 v87, v87
    v_cvt_pk_bf16_f32 v104, v72, v73
    v_cvt_pk_bf16_f32 v105, v74, v75
    v_cvt_pk_bf16_f32 v106, v76, v77
    v_cvt_pk_bf16_f32 v107, v78, v79
    v_cvt_pk_bf16_f32 v108, v80, v81
    v_cvt_pk_bf16_f32 v109, v82, v83
    v_cvt_pk_bf16_f32 v110, v84, v85
    v_cvt_pk_bf16_f32 v111, v86, v87
    s_waitcnt lgkmcnt(0)
    v_mfma_f32_32x32x16_bf16 v[72:87], v[152:155], v[32:35], v[40:55]
    v_exp_f32 v88, v88
    v_exp_f32 v89, v89
    v_exp_f32 v90, v90
    v_exp_f32 v91, v91
    v_exp_f32 v92, v92
    v_exp_f32 v93, v93
    v_mfma_f32_32x32x16_bf16 v[120:135], v[168:171], v[104:107], v[120:135]
    v_exp_f32 v94, v94
    v_exp_f32 v95, v95
    v_exp_f32 v96, v96
    v_exp_f32 v97, v97
    v_exp_f32 v98, v98
    v_mfma_f32_32x32x16_bf16 v[120:135], v[172:175], v[108:111], v[120:135]
    v_exp_f32 v99, v99
    v_exp_f32 v100, v100
    v_exp_f32 v101, v101
    v_exp_f32 v102, v102
    v_exp_f32 v103, v103
    v_cvt_pk_bf16_f32 v112, v88, v89
    v_cvt_pk_bf16_f32 v113, v90, v91
    v_cvt_pk_bf16_f32 v114, v92, v93
    v_cvt_pk_bf16_f32 v115, v94, v95
    v_cvt_pk_bf16_f32 v116, v96, v97
    v_cvt_pk_bf16_f32 v117, v98, v99
    v_cvt_pk_bf16_f32 v118, v100, v101
    v_cvt_pk_bf16_f32 v119, v102, v103
    v_mfma_f32_32x32x16_bf16 v[88:103], v[152:155], v[36:39], v[56:71]
    ds_read_b128 v[156:159], v176 offset:13312
    v_exp_f32 v72, v72
    v_exp_f32 v73, v73
    v_exp_f32 v74, v74
    v_exp_f32 v75, v75
    v_exp_f32 v76, v76
    v_exp_f32 v77, v77
    v_mfma_f32_32x32x16_bf16 v[136:151], v[168:171], v[112:115], v[136:151]
    ds_read_b128 v[160:163], v177 offset:12288
    v_exp_f32 v78, v78
    v_exp_f32 v79, v79
    v_exp_f32 v80, v80
    v_exp_f32 v81, v81
    v_exp_f32 v82, v82
    v_mfma_f32_32x32x16_bf16 v[136:151], v[172:175], v[116:119], v[136:151]
    ds_read_b128 v[164:167], v177 offset:12800
    v_exp_f32 v83, v83
    v_exp_f32 v84, v84
    v_exp_f32 v85, v85
    v_exp_f32 v86, v86
    v_exp_f32 v87, v87
    v_cvt_pk_bf16_f32 v104, v72, v73
    v_cvt_pk_bf16_f32 v105, v74, v75
    v_cvt_pk_bf16_f32 v106, v76, v77
    v_cvt_pk_bf16_f32 v107, v78, v79
    v_cvt_pk_bf16_f32 v108, v80, v81
    v_cvt_pk_bf16_f32 v109, v82, v83
    v_cvt_pk_bf16_f32 v110, v84, v85
    v_cvt_pk_bf16_f32 v111, v86, v87
    s_waitcnt lgkmcnt(0)
    v_mfma_f32_32x32x16_bf16 v[72:87], v[156:159], v[32:35], v[40:55]
    v_exp_f32 v88, v88
    v_exp_f32 v89, v89
    v_exp_f32 v90, v90
    v_exp_f32 v91, v91
    v_exp_f32 v92, v92
    v_exp_f32 v93, v93
    v_mfma_f32_32x32x16_bf16 v[120:135], v[160:163], v[104:107], v[120:135]
    v_exp_f32 v94, v94
    v_exp_f32 v95, v95
    v_exp_f32 v96, v96
    v_exp_f32 v97, v97
    v_exp_f32 v98, v98
    v_mfma_f32_32x32x16_bf16 v[120:135], v[164:167], v[108:111], v[120:135]
    v_exp_f32 v99, v99
    v_exp_f32 v100, v100
    v_exp_f32 v101, v101
    v_exp_f32 v102, v102
    v_exp_f32 v103, v103
    v_cvt_pk_bf16_f32 v112, v88, v89
    v_cvt_pk_bf16_f32 v113, v90, v91
    v_cvt_pk_bf16_f32 v114, v92, v93
    v_cvt_pk_bf16_f32 v115, v94, v95
    v_cvt_pk_bf16_f32 v116, v96, v97
    v_cvt_pk_bf16_f32 v117, v98, v99
    v_cvt_pk_bf16_f32 v118, v100, v101
    v_cvt_pk_bf16_f32 v119, v102, v103
    v_mfma_f32_32x32x16_bf16 v[88:103], v[156:159], v[36:39], v[56:71]
    ds_read_b128 v[152:155], v176 offset:14336
    v_exp_f32 v72, v72
    v_exp_f32 v73, v73
    v_exp_f32 v74, v74
    v_exp_f32 v75, v75
    v_exp_f32 v76, v76
    v_exp_f32 v77, v77
    v_mfma_f32_32x32x16_bf16 v[136:151], v[160:163], v[112:115], v[136:151]
    ds_read_b128 v[168:171], v177 offset:13312
    v_exp_f32 v78, v78
    v_exp_f32 v79, v79
    v_exp_f32 v80, v80
    v_exp_f32 v81, v81
    v_exp_f32 v82, v82
    v_mfma_f32_32x32x16_bf16 v[136:151], v[164:167], v[116:119], v[136:151]
    ds_read_b128 v[172:175], v177 offset:13824
    v_exp_f32 v83, v83
    v_exp_f32 v84, v84
    v_exp_f32 v85, v85
    v_exp_f32 v86, v86
    v_exp_f32 v87, v87
    v_cvt_pk_bf16_f32 v104, v72, v73
    v_cvt_pk_bf16_f32 v105, v74, v75
    v_cvt_pk_bf16_f32 v106, v76, v77
    v_cvt_pk_bf16_f32 v107, v78, v79
    v_cvt_pk_bf16_f32 v108, v80, v81
    v_cvt_pk_bf16_f32 v109, v82, v83
    v_cvt_pk_bf16_f32 v110, v84, v85
    v_cvt_pk_bf16_f32 v111, v86, v87
    s_waitcnt lgkmcnt(0)
    v_mfma_f32_32x32x16_bf16 v[72:87], v[152:155], v[32:35], v[40:55]
    v_exp_f32 v88, v88
    v_exp_f32 v89, v89
    v_exp_f32 v90, v90
    v_exp_f32 v91, v91
    v_exp_f32 v92, v92
    v_exp_f32 v93, v93
    v_mfma_f32_32x32x16_bf16 v[120:135], v[168:171], v[104:107], v[120:135]
    v_exp_f32 v94, v94
    v_exp_f32 v95, v95
    v_exp_f32 v96, v96
    v_exp_f32 v97, v97
    v_exp_f32 v98, v98
    v_mfma_f32_32x32x16_bf16 v[120:135], v[172:175], v[108:111], v[120:135]
    v_exp_f32 v99, v99
    v_exp_f32 v100, v100
    v_exp_f32 v101, v101
    v_exp_f32 v102, v102
    v_exp_f32 v103, v103
    v_cvt_pk_bf16_f32 v112, v88, v89
    v_cvt_pk_bf16_f32 v113, v90, v91
    v_cvt_pk_bf16_f32 v114, v92, v93
    v_cvt_pk_bf16_f32 v115, v94, v95
    v_cvt_pk_bf16_f32 v116, v96, v97
    v_cvt_pk_bf16_f32 v117, v98, v99
    v_cvt_pk_bf16_f32 v118, v100, v101
    v_cvt_pk_bf16_f32 v119, v102, v103
    v_mfma_f32_32x32x16_bf16 v[88:103], v[152:155], v[36:39], v[56:71]
    ds_read_b128 v[156:159], v176 offset:15360
    v_exp_f32 v72, v72
    v_exp_f32 v73, v73
    v_exp_f32 v74, v74
    v_exp_f32 v75, v75
    v_exp_f32 v76, v76
    v_exp_f32 v77, v77
    v_mfma_f32_32x32x16_bf16 v[136:151], v[168:171], v[112:115], v[136:151]
    ds_read_b128 v[160:163], v177 offset:14336
    v_exp_f32 v78, v78
    v_exp_f32 v79, v79
    v_exp_f32 v80, v80
    v_exp_f32 v81, v81
    v_exp_f32 v82, v82
    v_mfma_f32_32x32x16_bf16 v[136:151], v[172:175], v[116:119], v[136:151]
    ds_read_b128 v[164:167], v177 offset:14848
    v_exp_f32 v83, v83
    v_exp_f32 v84, v84
    v_exp_f32 v85, v85
    v_exp_f32 v86, v86
    v_exp_f32 v87, v87
    v_cvt_pk_bf16_f32 v104, v72, v73
    v_cvt_pk_bf16_f32 v105, v74, v75
    v_cvt_pk_bf16_f32 v106, v76, v77
    v_cvt_pk_bf16_f32 v107, v78, v79
    v_cvt_pk_bf16_f32 v108, v80, v81
    v_cvt_pk_bf16_f32 v109, v82, v83
    v_cvt_pk_bf16_f32 v110, v84, v85
    v_cvt_pk_bf16_f32 v111, v86, v87
    s_waitcnt lgkmcnt(0)
    v_mfma_f32_32x32x16_bf16 v[72:87], v[156:159], v[32:35], v[40:55]
    v_exp_f32 v88, v88
    v_exp_f32 v89, v89
    v_exp_f32 v90, v90
    v_exp_f32 v91, v91
    v_exp_f32 v92, v92
    v_exp_f32 v93, v93
    v_mfma_f32_32x32x16_bf16 v[120:135], v[160:163], v[104:107], v[120:135]
    v_exp_f32 v94, v94
    v_exp_f32 v95, v95
    v_exp_f32 v96, v96
    v_exp_f32 v97, v97
    v_exp_f32 v98, v98
    v_mfma_f32_32x32x16_bf16 v[120:135], v[164:167], v[108:111], v[120:135]
    v_exp_f32 v99, v99
    v_exp_f32 v100, v100
    v_exp_f32 v101, v101
    v_exp_f32 v102, v102
    v_exp_f32 v103, v103
    v_cvt_pk_bf16_f32 v112, v88, v89
    v_cvt_pk_bf16_f32 v113, v90, v91
    v_cvt_pk_bf16_f32 v114, v92, v93
    v_cvt_pk_bf16_f32 v115, v94, v95
    v_cvt_pk_bf16_f32 v116, v96, v97
    v_cvt_pk_bf16_f32 v117, v98, v99
    v_cvt_pk_bf16_f32 v118, v100, v101
    v_cvt_pk_bf16_f32 v119, v102, v103
    v_mfma_f32_32x32x16_bf16 v[88:103], v[156:159], v[36:39], v[56:71]
    ds_read_b128 v[152:155], v176 offset:16384
    v_exp_f32 v72, v72
    v_exp_f32 v73, v73
    v_exp_f32 v74, v74
    v_exp_f32 v75, v75
    v_exp_f32 v76, v76
    v_exp_f32 v77, v77
    v_mfma_f32_32x32x16_bf16 v[136:151], v[160:163], v[112:115], v[136:151]
    ds_read_b128 v[168:171], v177 offset:15360
    v_exp_f32 v78, v78
    v_exp_f32 v79, v79
    v_exp_f32 v80, v80
    v_exp_f32 v81, v81
    v_exp_f32 v82, v82
    v_mfma_f32_32x32x16_bf16 v[136:151], v[164:167], v[116:119], v[136:151]
    ds_read_b128 v[172:175], v177 offset:15872
    v_exp_f32 v83, v83
    v_exp_f32 v84, v84
    v_exp_f32 v85, v85
    v_exp_f32 v86, v86
    v_exp_f32 v87, v87
    v_cvt_pk_bf16_f32 v104, v72, v73
    v_cvt_pk_bf16_f32 v105, v74, v75
    v_cvt_pk_bf16_f32 v106, v76, v77
    v_cvt_pk_bf16_f32 v107, v78, v79
    v_cvt_pk_bf16_f32 v108, v80, v81
    v_cvt_pk_bf16_f32 v109, v82, v83
    v_cvt_pk_bf16_f32 v110, v84, v85
    v_cvt_pk_bf16_f32 v111, v86, v87
    s_waitcnt lgkmcnt(0)
    v_mfma_f32_32x32x16_bf16 v[72:87], v[152:155], v[32:35], v[40:55]
    v_exp_f32 v88, v88
    v_exp_f32 v89, v89
    v_exp_f32 v90, v90
    v_exp_f32 v91, v91
    v_exp_f32 v92, v92
    v_exp_f32 v93, v93
    v_mfma_f32_32x32x16_bf16 v[120:135], v[168:171], v[104:107], v[120:135]
    v_exp_f32 v94, v94
    v_exp_f32 v95, v95
    v_exp_f32 v96, v96
    v_exp_f32 v97, v97
    v_exp_f32 v98, v98
    v_mfma_f32_32x32x16_bf16 v[120:135], v[172:175], v[108:111], v[120:135]
    v_exp_f32 v99, v99
    v_exp_f32 v100, v100
    v_exp_f32 v101, v101
    v_exp_f32 v102, v102
    v_exp_f32 v103, v103
    v_cvt_pk_bf16_f32 v112, v88, v89
    v_cvt_pk_bf16_f32 v113, v90, v91
    v_cvt_pk_bf16_f32 v114, v92, v93
    v_cvt_pk_bf16_f32 v115, v94, v95
    v_cvt_pk_bf16_f32 v116, v96, v97
    v_cvt_pk_bf16_f32 v117, v98, v99
    v_cvt_pk_bf16_f32 v118, v100, v101
    v_cvt_pk_bf16_f32 v119, v102, v103
    v_add_u32 v176, 16384, v176
    v_add_u32 v177, v178, v177
    s_sub_u32 s85, s85, 1
    s_cmp_eq_u32 s85, 0
    s_cbranch_scc1 sequential_preLN__grouped_kv_mqa__mixer_gmlp__prompt_kernel_aend
    s_cmp_lg_u32 s86, 0
    s_cbranch_scc1 sequential_preLN__grouped_kv_mqa__mixer_gmlp__prompt_kernel_aloop
    s_barrier
    s_branch sequential_preLN__grouped_kv_mqa__mixer_gmlp__prompt_kernel_aloop
sequential_preLN__grouped_kv_mqa__mixer_gmlp__prompt_kernel_aend:
    v_mfma_f32_32x32x16_bf16 v[136:151], v[168:171], v[112:115], v[136:151]
    v_mfma_f32_32x32x16_bf16 v[136:151], v[172:175], v[116:119], v[136:151]
    s_lshl_b32 s7, s84, 5
    v_rcp_f32 v4, v128
    s_nop 0
    v_mul_f32 v120, v4, v120
    v_mul_f32 v121, v4, v121
    v_mul_f32 v122, v4, v122
    v_mul_f32 v123, v4, v123
    v_mul_f32 v124, v4, v124
    v_mul_f32 v125, v4, v125
    v_mul_f32 v126, v4, v126
    v_mul_f32 v127, v4, v127
    v_cvt_pk_bf16_f32 v104, v120, v121
    v_cvt_pk_bf16_f32 v105, v122, v123
    v_cvt_pk_bf16_f32 v106, v124, v125
    v_cvt_pk_bf16_f32 v107, v126, v127
    s_nop 0
    v_permlane32_swap_b32 v104, v106
    v_permlane32_swap_b32 v105, v107
    v_rcp_f32 v4, v144
    s_nop 0
    v_mul_f32 v136, v4, v136
    v_mul_f32 v137, v4, v137
    v_mul_f32 v138, v4, v138
    v_mul_f32 v139, v4, v139
    v_mul_f32 v140, v4, v140
    v_mul_f32 v141, v4, v141
    v_mul_f32 v142, v4, v142
    v_mul_f32 v143, v4, v143
    v_cvt_pk_bf16_f32 v112, v136, v137
    v_cvt_pk_bf16_f32 v113, v138, v139
    v_cvt_pk_bf16_f32 v114, v140, v141
    v_cvt_pk_bf16_f32 v115, v142, v143
    s_nop 0
    v_permlane32_swap_b32 v112, v114
    v_permlane32_swap_b32 v113, v115
    s_nop 0
    v_permlane16_swap_b32 v104, v112
    v_permlane16_swap_b32 v105, v113
    v_permlane16_swap_b32 v106, v114
    v_permlane16_swap_b32 v107, v115
    buffer_store_dwordx4 v[104:107], v179, s[64:67], s7 offen offset:0 sc1
    buffer_store_dwordx4 v[112:115], v180, s[64:67], s7 offen offset:0 sc1
    s_waitcnt vmcnt(0)
    s_mov_b64 exec, 1
    v_mov_b32 v2, 156672
    v_mov_b32 v3, 1
    ds_add_rtn_u32 v4, v2, v3
    s_waitcnt lgkmcnt(0)
    v_readfirstlane_b32 s4, v4
    s_nop 2
    s_cmp_lg_u32 s4, 3
    s_cbranch_scc1 sig_sequential_preLN__grouped_kv_mqa__mixer_gmlp__prompt_kernel_9
    s_lshl_b32 s4, s46, 2
    s_add_u32 s4, s4, s82
    s_add_u32 s4, s4, 0
    v_mov_b32 v2, 0
    v_mov_b32 v3, s26
    buffer_store_dword v3, v2, s[72:75], s4 offen sc1
sig_sequential_preLN__grouped_kv_mqa__mixer_gmlp__prompt_kernel_9:
    s_mov_b64 exec, -1
    v_and_b32 v2, 15, v1
    v_lshrrev_b32 v3, 4, v1
    v_lshrrev_b32 v4, 1, v2
    s_lshl_b32 s5, s79, 12
    v_add_u32 v5, 0, v3
    v_xor_b32 v5, v5, v4
    v_lshlrev_b32 v5, 4, v5
    v_lshl_add_u32 v5, v2, 7, v5
    v_add_u32 v5, s5, v5
    v_add_u32 v144, 0, v5
    v_add_u32 v146, 65536, v5
    v_add_u32 v5, 4, v3
    v_xor_b32 v5, v5, v4
    v_lshlrev_b32 v5, 4, v5
    v_lshl_add_u32 v5, v2, 7, v5
    v_add_u32 v5, s5, v5
    v_add_u32 v145, 0, v5
    v_add_u32 v147, 65536, v5
    v_lshrrev_b32 v4, 2, v2
    v_and_b32 v2, 3, v2
    v_lshl_add_u32 v5, v3, 3, v4
    v_lshlrev_b32 v5, 7, v5
    v_lshl_add_u32 v5, v2, 3, v5
    v_and_b32 v3, 1, v3
    v_lshrrev_b32 v4, 1, v4
    v_lshl_or_b32 v4, v3, 1, v4
    s_mul_i32 s5, s80, 2
    v_mov_b32 v2, s5
    v_xor_b32 v2, v2, v4
    v_lshl_add_u32 v2, v2, 5, v5
    v_add_u32 v148, 0, v2
    v_add_u32 v150, 65536, v2
    v_mov_b32 v2, s5
    v_add_u32 v2, 1, v2
    v_xor_b32 v2, v2, v4
    v_lshl_add_u32 v2, v2, 5, v5
    v_add_u32 v149, 0, v2
    v_add_u32 v151, 65536, v2
    v_mov_b32 v32, 0
    v_mov_b32 v33, 0
    v_mov_b32 v34, 0
    v_mov_b32 v35, 0
    v_mov_b32 v36, 0
    v_mov_b32 v37, 0
    v_mov_b32 v38, 0
    v_mov_b32 v39, 0
    v_mov_b32 v40, 0
    v_mov_b32 v41, 0
    v_mov_b32 v42, 0
    v_mov_b32 v43, 0
    v_mov_b32 v44, 0
    v_mov_b32 v45, 0
    v_mov_b32 v46, 0
    v_mov_b32 v47, 0
    s_lshl_b32 s5, s79, 5
    s_add_u32 s5, s5, s47
    v_and_b32 v2, 15, v1
    v_add_u32 v2, s5, v2
    v_lshlrev_b32 v2, 10, v2
    v_lshrrev_b32 v3, 4, v1
    v_lshl_add_u32 v160, v3, 3, v2
    s_lshl_b32 s22, s46, 7
    s_lshl_b32 s6, s80, 6
    s_add_u32 s22, s22, s6
    s_add_u32 s23, s22, 16384
    s_mov_b32 s56, s16
    s_mov_b32 s57, s17
    s_mov_b32 s58, 2097152
    s_mov_b32 s59, 0x00020000
    buffer_load_dwordx2 v[152:153], v160, s[56:59], s22 offen offset:0
    buffer_load_dwordx2 v[154:155], v160, s[56:59], s22 offen offset:32
    buffer_load_dwordx2 v[156:157], v160, s[56:59], s23 offen offset:0
    buffer_load_dwordx2 v[158:159], v160, s[56:59], s23 offen offset:32
    s_add_u32 s60, s40, 5242880
    s_addc_u32 s61, s41, 0
    s_mov_b32 s62, 2097152
    s_mov_b32 s63, 0x00020000
    s_add_u32 s64, s40, 7340032
    s_addc_u32 s65, s41, 0
    s_mov_b32 s66, 262144
    s_mov_b32 s67, 0x00020000
    s_lshl_b32 s5, s79, 5
    s_add_u32 s5, s5, s47
    v_and_b32 v2, 15, v1
    v_add_u32 v2, s5, v2
    s_mov_b32 s6, 1024
    v_mul_lo_u32 v2, v2, s6
    v_bfe_u32 v3, v1, 4, 1
    v_lshl_add_u32 v2, v3, 5, v2
    v_lshrrev_b32 v3, 5, v1
    v_lshl_add_u32 v161, v3, 4, v2
    v_add_u32 v162, 16384, v161
    v_lshlrev_b32 v163, 3, v1
    s_cmp_lg_u32 s44, 0
    s_cbranch_scc1 rel_sequential_preLN__grouped_kv_mqa__mixer_gmlp__prompt_kernel_10
    s_add_u32 s4, s82, 0
    v_lshlrev_b32 v2, 2, v1
    s_mov_b64 exec, 255
    s_mov_b32 s83, 0x40000
poll_sequential_preLN__grouped_kv_mqa__mixer_gmlp__prompt_kernel_11:
    buffer_load_dword v3, v2, s[72:75], s4 offen sc1
    s_waitcnt vmcnt(0)
    v_cmp_ne_u32 vcc, s26, v3
    s_nop 2
    s_cmp_eq_u64 vcc, 0
    s_cbranch_scc1 polld_sequential_preLN__grouped_kv_mqa__mixer_gmlp__prompt_kernel_12
    s_sleep 0
    s_sub_u32 s83, s83, 1
    s_cmp_lg_u32 s83, 0
    s_cbranch_scc1 poll_sequential_preLN__grouped_kv_mqa__mixer_gmlp__prompt_kernel_11
polld_sequential_preLN__grouped_kv_mqa__mixer_gmlp__prompt_kernel_12:
    s_mov_b64 exec, -1
rel_sequential_preLN__grouped_kv_mqa__mixer_gmlp__prompt_kernel_10:
    s_barrier
    s_barrier
    ds_read_b128 v[48:51], v144 offset:32768
    ds_read_b128 v[52:55], v144 offset:34816
    ds_read_b64_tr_b16 v[80:81], v148 offset:0
    ds_read_b64_tr_b16 v[82:83], v148 offset:512
    ds_read_b64_tr_b16 v[84:85], v149 offset:0
    ds_read_b64_tr_b16 v[86:87], v149 offset:512
    ds_read_b128 v[56:59], v145 offset:32768
    ds_read_b128 v[60:63], v145 offset:34816
    ds_read_b64_tr_b16 v[96:97], v148 offset:4096
    ds_read_b64_tr_b16 v[98:99], v148 offset:4608
    ds_read_b64_tr_b16 v[100:101], v149 offset:4096
    ds_read_b64_tr_b16 v[102:103], v149 offset:4608
    s_waitcnt lgkmcnt(0)
    s_barrier
    v_mfma_f32_16x16x32_bf16 v[32:35], v[80:83], v[48:51], v[32:35]
    ds_read_b128 v[64:67], v144 offset:40960
    ds_read_b128 v[68:71], v144 offset:43008
    v_mfma_f32_16x16x32_bf16 v[40:43], v[80:83], v[52:55], v[40:43]
    ds_read_b64_tr_b16 v[112:113], v148 offset:8192
    ds_read_b64_tr_b16 v[114:115], v148 offset:8704
    v_mfma_f32_16x16x32_bf16 v[36:39], v[84:87], v[48:51], v[36:39]
    ds_read_b64_tr_b16 v[116:117], v149 offset:8192
    ds_read_b64_tr_b16 v[118:119], v149 offset:8704
    v_mfma_f32_16x16x32_bf16 v[44:47], v[84:87], v[52:55], v[44:47]
    ds_read_b128 v[72:75], v145 offset:40960
    ds_read_b128 v[76:79], v145 offset:43008
    v_mfma_f32_16x16x32_bf16 v[32:35], v[96:99], v[56:59], v[32:35]
    ds_read_b64_tr_b16 v[128:129], v148 offset:12288
    ds_read_b64_tr_b16 v[130:131], v148 offset:12800
    v_mfma_f32_16x16x32_bf16 v[40:43], v[96:99], v[60:63], v[40:43]
    ds_read_b64_tr_b16 v[132:133], v149 offset:12288
    ds_read_b64_tr_b16 v[134:135], v149 offset:12800
    v_mfma_f32_16x16x32_bf16 v[36:39], v[100:103], v[56:59], v[36:39]
    v_mfma_f32_16x16x32_bf16 v[44:47], v[100:103], v[60:63], v[44:47]
    s_waitcnt lgkmcnt(0)
    s_barrier
    v_mfma_f32_16x16x32_bf16 v[32:35], v[112:115], v[64:67], v[32:35]
    ds_read_b128 v[48:51], v144 offset:49152
    ds_read_b128 v[52:55], v144 offset:51200
    v_mfma_f32_16x16x32_bf16 v[40:43], v[112:115], v[68:71], v[40:43]
    ds_read_b64_tr_b16 v[80:81], v148 offset:16384
    ds_read_b64_tr_b16 v[82:83], v148 offset:16896
    v_mfma_f32_16x16x32_bf16 v[36:39], v[116:119], v[64:67], v[36:39]
    ds_read_b64_tr_b16 v[84:85], v149 offset:16384
    ds_read_b64_tr_b16 v[86:87], v149 offset:16896
    v_mfma_f32_16x16x32_bf16 v[44:47], v[116:119], v[68:71], v[44:47]
    ds_read_b128 v[56:59], v145 offset:49152
    ds_read_b128 v[60:63], v145 offset:51200
    v_mfma_f32_16x16x32_bf16 v[32:35], v[128:131], v[72:75], v[32:35]
    ds_read_b64_tr_b16 v[96:97], v148 offset:20480
    ds_read_b64_tr_b16 v[98:99], v148 offset:20992
    v_mfma_f32_16x16x32_bf16 v[40:43], v[128:131], v[76:79], v[40:43]
    ds_read_b64_tr_b16 v[100:101], v149 offset:20480
    ds_read_b64_tr_b16 v[102:103], v149 offset:20992
    v_mfma_f32_16x16x32_bf16 v[36:39], v[132:135], v[72:75], v[36:39]
    v_mfma_f32_16x16x32_bf16 v[44:47], v[132:135], v[76:79], v[44:47]
    s_waitcnt lgkmcnt(0)
    s_barrier
    v_mfma_f32_16x16x32_bf16 v[32:35], v[80:83], v[48:51], v[32:35]
    ds_read_b128 v[64:67], v144 offset:57344
    ds_read_b128 v[68:71], v144 offset:59392
    v_mfma_f32_16x16x32_bf16 v[40:43], v[80:83], v[52:55], v[40:43]
    ds_read_b64_tr_b16 v[112:113], v148 offset:24576
    ds_read_b64_tr_b16 v[114:115], v148 offset:25088
    v_mfma_f32_16x16x32_bf16 v[36:39], v[84:87], v[48:51], v[36:39]
    ds_read_b64_tr_b16 v[116:117], v149 offset:24576
    ds_read_b64_tr_b16 v[118:119], v149 offset:25088
    v_mfma_f32_16x16x32_bf16 v[44:47], v[84:87], v[52:55], v[44:47]
    ds_read_b128 v[72:75], v145 offset:57344
    ds_read_b128 v[76:79], v145 offset:59392
    v_mfma_f32_16x16x32_bf16 v[32:35], v[96:99], v[56:59], v[32:35]
    ds_read_b64_tr_b16 v[128:129], v148 offset:28672
    ds_read_b64_tr_b16 v[130:131], v148 offset:29184
    v_mfma_f32_16x16x32_bf16 v[40:43], v[96:99], v[60:63], v[40:43]
    ds_read_b64_tr_b16 v[132:133], v149 offset:28672
    ds_read_b64_tr_b16 v[134:135], v149 offset:29184
    v_mfma_f32_16x16x32_bf16 v[36:39], v[100:103], v[56:59], v[36:39]
    v_mfma_f32_16x16x32_bf16 v[44:47], v[100:103], v[60:63], v[44:47]
    s_waitcnt lgkmcnt(0)
    s_barrier
    v_mfma_f32_16x16x32_bf16 v[32:35], v[112:115], v[64:67], v[32:35]
    ds_read_b128 v[48:51], v146 offset:32768
    ds_read_b128 v[52:55], v146 offset:34816
    v_mfma_f32_16x16x32_bf16 v[40:43], v[112:115], v[68:71], v[40:43]
    ds_read_b64_tr_b16 v[80:81], v150 offset:0
    ds_read_b64_tr_b16 v[82:83], v150 offset:512
    v_mfma_f32_16x16x32_bf16 v[36:39], v[116:119], v[64:67], v[36:39]
    ds_read_b64_tr_b16 v[84:85], v151 offset:0
    ds_read_b64_tr_b16 v[86:87], v151 offset:512
    v_mfma_f32_16x16x32_bf16 v[44:47], v[116:119], v[68:71], v[44:47]
    ds_read_b128 v[56:59], v147 offset:32768
    ds_read_b128 v[60:63], v147 offset:34816
    v_mfma_f32_16x16x32_bf16 v[32:35], v[128:131], v[72:75], v[32:35]
    ds_read_b64_tr_b16 v[96:97], v150 offset:4096
    ds_read_b64_tr_b16 v[98:99], v150 offset:4608
    v_mfma_f32_16x16x32_bf16 v[40:43], v[128:131], v[76:79], v[40:43]
    ds_read_b64_tr_b16 v[100:101], v151 offset:4096
    ds_read_b64_tr_b16 v[102:103], v151 offset:4608
    v_mfma_f32_16x16x32_bf16 v[36:39], v[132:135], v[72:75], v[36:39]
    v_mfma_f32_16x16x32_bf16 v[44:47], v[132:135], v[76:79], v[44:47]
    s_waitcnt lgkmcnt(0)
    s_barrier
    v_mfma_f32_16x16x32_bf16 v[32:35], v[80:83], v[48:51], v[32:35]
    ds_read_b128 v[64:67], v146 offset:40960
    ds_read_b128 v[68:71], v146 offset:43008
    v_mfma_f32_16x16x32_bf16 v[40:43], v[80:83], v[52:55], v[40:43]
    ds_read_b64_tr_b16 v[112:113], v150 offset:8192
    ds_read_b64_tr_b16 v[114:115], v150 offset:8704
    v_mfma_f32_16x16x32_bf16 v[36:39], v[84:87], v[48:51], v[36:39]
    ds_read_b64_tr_b16 v[116:117], v151 offset:8192
    ds_read_b64_tr_b16 v[118:119], v151 offset:8704
    v_mfma_f32_16x16x32_bf16 v[44:47], v[84:87], v[52:55], v[44:47]
    ds_read_b128 v[72:75], v147 offset:40960
    ds_read_b128 v[76:79], v147 offset:43008
    v_mfma_f32_16x16x32_bf16 v[32:35], v[96:99], v[56:59], v[32:35]
    ds_read_b64_tr_b16 v[128:129], v150 offset:12288
    ds_read_b64_tr_b16 v[130:131], v150 offset:12800
    v_mfma_f32_16x16x32_bf16 v[40:43], v[96:99], v[60:63], v[40:43]
    ds_read_b64_tr_b16 v[132:133], v151 offset:12288
    ds_read_b64_tr_b16 v[134:135], v151 offset:12800
    v_mfma_f32_16x16x32_bf16 v[36:39], v[100:103], v[56:59], v[36:39]
    v_mfma_f32_16x16x32_bf16 v[44:47], v[100:103], v[60:63], v[44:47]
    s_waitcnt lgkmcnt(0)
    s_barrier
    v_mfma_f32_16x16x32_bf16 v[32:35], v[112:115], v[64:67], v[32:35]
    ds_read_b128 v[48:51], v146 offset:49152
    ds_read_b128 v[52:55], v146 offset:51200
    v_mfma_f32_16x16x32_bf16 v[40:43], v[112:115], v[68:71], v[40:43]
    ds_read_b64_tr_b16 v[80:81], v150 offset:16384
    ds_read_b64_tr_b16 v[82:83], v150 offset:16896
    v_mfma_f32_16x16x32_bf16 v[36:39], v[116:119], v[64:67], v[36:39]
    ds_read_b64_tr_b16 v[84:85], v151 offset:16384
    ds_read_b64_tr_b16 v[86:87], v151 offset:16896
    v_mfma_f32_16x16x32_bf16 v[44:47], v[116:119], v[68:71], v[44:47]
    ds_read_b128 v[56:59], v147 offset:49152
    ds_read_b128 v[60:63], v147 offset:51200
    v_mfma_f32_16x16x32_bf16 v[32:35], v[128:131], v[72:75], v[32:35]
    ds_read_b64_tr_b16 v[96:97], v150 offset:20480
    ds_read_b64_tr_b16 v[98:99], v150 offset:20992
    v_mfma_f32_16x16x32_bf16 v[40:43], v[128:131], v[76:79], v[40:43]
    ds_read_b64_tr_b16 v[100:101], v151 offset:20480
    ds_read_b64_tr_b16 v[102:103], v151 offset:20992
    v_mfma_f32_16x16x32_bf16 v[36:39], v[132:135], v[72:75], v[36:39]
    v_mfma_f32_16x16x32_bf16 v[44:47], v[132:135], v[76:79], v[44:47]
    s_waitcnt lgkmcnt(0)
    s_barrier
    v_mfma_f32_16x16x32_bf16 v[32:35], v[80:83], v[48:51], v[32:35]
    ds_read_b128 v[64:67], v146 offset:57344
    ds_read_b128 v[68:71], v146 offset:59392
    v_mfma_f32_16x16x32_bf16 v[40:43], v[80:83], v[52:55], v[40:43]
    ds_read_b64_tr_b16 v[112:113], v150 offset:24576
    ds_read_b64_tr_b16 v[114:115], v150 offset:25088
    v_mfma_f32_16x16x32_bf16 v[36:39], v[84:87], v[48:51], v[36:39]
    ds_read_b64_tr_b16 v[116:117], v151 offset:24576
    ds_read_b64_tr_b16 v[118:119], v151 offset:25088
    v_mfma_f32_16x16x32_bf16 v[44:47], v[84:87], v[52:55], v[44:47]
    ds_read_b128 v[72:75], v147 offset:57344
    ds_read_b128 v[76:79], v147 offset:59392
    v_mfma_f32_16x16x32_bf16 v[32:35], v[96:99], v[56:59], v[32:35]
    ds_read_b64_tr_b16 v[128:129], v150 offset:28672
    ds_read_b64_tr_b16 v[130:131], v150 offset:29184
    v_mfma_f32_16x16x32_bf16 v[40:43], v[96:99], v[60:63], v[40:43]
    ds_read_b64_tr_b16 v[132:133], v151 offset:28672
    ds_read_b64_tr_b16 v[134:135], v151 offset:29184
    v_mfma_f32_16x16x32_bf16 v[36:39], v[100:103], v[56:59], v[36:39]
    v_mfma_f32_16x16x32_bf16 v[44:47], v[100:103], v[60:63], v[44:47]
    s_waitcnt lgkmcnt(0)
    v_mfma_f32_16x16x32_bf16 v[32:35], v[112:115], v[64:67], v[32:35]
    v_mfma_f32_16x16x32_bf16 v[40:43], v[112:115], v[68:71], v[40:43]
    v_mfma_f32_16x16x32_bf16 v[36:39], v[116:119], v[64:67], v[36:39]
    v_mfma_f32_16x16x32_bf16 v[44:47], v[116:119], v[68:71], v[44:47]
    v_mfma_f32_16x16x32_bf16 v[32:35], v[128:131], v[72:75], v[32:35]
    v_mfma_f32_16x16x32_bf16 v[40:43], v[128:131], v[76:79], v[40:43]
    v_mfma_f32_16x16x32_bf16 v[36:39], v[132:135], v[72:75], v[36:39]
    v_mfma_f32_16x16x32_bf16 v[44:47], v[132:135], v[76:79], v[44:47]
    s_barrier
    s_waitcnt vmcnt(0)
    v_lshlrev_b32 v2, 16, v152
    v_and_b32 v3, 0xffff0000, v152
    s_nop 0
    v_add_f32 v32, v32, v2
    v_add_f32 v33, v33, v3
    v_cvt_pk_bf16_f32 v8, v32, v33
    v_lshlrev_b32 v2, 16, v153
    v_and_b32 v3, 0xffff0000, v153
    v_add_f32 v34, v34, v2
    v_add_f32 v35, v35, v3
    v_cvt_pk_bf16_f32 v9, v34, v35
    v_lshlrev_b32 v2, 16, v154
    v_and_b32 v3, 0xffff0000, v154
    v_add_f32 v36, v36, v2
    v_add_f32 v37, v37, v3
    v_cvt_pk_bf16_f32 v10, v36, v37
    v_lshlrev_b32 v2, 16, v155
    v_and_b32 v3, 0xffff0000, v155
    v_add_f32 v38, v38, v2
    v_add_f32 v39, v39, v3
    v_cvt_pk_bf16_f32 v11, v38, v39
    v_lshlrev_b32 v2, 16, v156
    v_and_b32 v3, 0xffff0000, v156
    v_add_f32 v40, v40, v2
    v_add_f32 v41, v41, v3
    v_cvt_pk_bf16_f32 v12, v40, v41
    v_lshlrev_b32 v2, 16, v157
    v_and_b32 v3, 0xffff0000, v157
    v_add_f32 v42, v42, v2
    v_add_f32 v43, v43, v3
    v_cvt_pk_bf16_f32 v13, v42, v43
    v_lshlrev_b32 v2, 16, v158
    v_and_b32 v3, 0xffff0000, v158
    v_add_f32 v44, v44, v2
    v_add_f32 v45, v45, v3
    v_cvt_pk_bf16_f32 v14, v44, v45
    v_lshlrev_b32 v2, 16, v159
    v_and_b32 v3, 0xffff0000, v159
    v_add_f32 v46, v46, v2
    v_add_f32 v47, v47, v3
    v_cvt_pk_bf16_f32 v15, v46, v47
    v_cvt_pk_bf16_f32 v164, v32, v33
    v_cvt_pk_bf16_f32 v165, v34, v35
    v_cvt_pk_bf16_f32 v166, v40, v41
    v_cvt_pk_bf16_f32 v167, v42, v43
    s_nop 0
    v_permlane16_swap_b32 v164, v166
    v_permlane16_swap_b32 v165, v167
    v_cvt_pk_bf16_f32 v168, v36, v37
    v_cvt_pk_bf16_f32 v169, v38, v39
    v_cvt_pk_bf16_f32 v170, v44, v45
    v_cvt_pk_bf16_f32 v171, v46, v47
    s_nop 0
    v_permlane16_swap_b32 v168, v170
    v_permlane16_swap_b32 v169, v171
    s_nop 0
    v_permlane16_swap_b32 v164, v168
    v_permlane16_swap_b32 v165, v169
    v_permlane16_swap_b32 v166, v170
    v_permlane16_swap_b32 v167, v171
    buffer_store_dwordx4 v[164:167], v161, s[60:63], s22 offen offset:0 sc1
    buffer_store_dwordx4 v[168:171], v162, s[60:63], s22 offen offset:0 sc1
    v_pk_mul_f32 v[186:187], v[32:33], v[32:33]
    v_mov_b32 v184, v32
    v_mov_b32 v185, v33
    v_pk_add_f32 v[184:185], v[184:185], v[34:35]
    v_pk_fma_f32 v[186:187], v[34:35], v[34:35], v[186:187]
    v_pk_add_f32 v[184:185], v[184:185], v[36:37]
    v_pk_fma_f32 v[186:187], v[36:37], v[36:37], v[186:187]
    v_pk_add_f32 v[184:185], v[184:185], v[38:39]
    v_pk_fma_f32 v[186:187], v[38:39], v[38:39], v[186:187]
    v_add_f32 v180, v184, v185
    v_add_f32 v181, v186, v187
    v_pk_mul_f32 v[190:191], v[40:41], v[40:41]
    v_mov_b32 v188, v40
    v_mov_b32 v189, v41
    v_pk_add_f32 v[188:189], v[188:189], v[42:43]
    v_pk_fma_f32 v[190:191], v[42:43], v[42:43], v[190:191]
    v_pk_add_f32 v[188:189], v[188:189], v[44:45]
    v_pk_fma_f32 v[190:191], v[44:45], v[44:45], v[190:191]
    v_pk_add_f32 v[188:189], v[188:189], v[46:47]
    v_pk_fma_f32 v[190:191], v[46:47], v[46:47], v[190:191]
    v_add_f32 v182, v188, v189
    v_add_f32 v183, v190, v191
    v_mov_b32 v2, v180
    s_nop 1
    v_permlane16_swap_b32 v2, v180
    v_add_f32 v180, v180, v2
    v_mov_b32 v2, v180
    s_nop 1
    v_permlane32_swap_b32 v2, v180
    v_add_f32 v180, v180, v2
    v_mov_b32 v3, v181
    s_nop 1
    v_permlane16_swap_b32 v3, v181
    v_add_f32 v181, v181, v3
    v_mov_b32 v3, v181
    s_nop 1
    v_permlane32_swap_b32 v3, v181
    v_add_f32 v181, v181, v3
    v_mov_b32 v2, v182
    s_nop 1
    v_permlane16_swap_b32 v2, v182
    v_add_f32 v182, v182, v2
    v_mov_b32 v2, v182
    s_nop 1
    v_permlane32_swap_b32 v2, v182
    v_add_f32 v182, v182, v2
    v_mov_b32 v3, v183
    s_nop 1
    v_permlane16_swap_b32 v3, v183
    v_add_f32 v183, v183, v3
    v_mov_b32 v3, v183
    s_nop 1
    v_permlane32_swap_b32 v3, v183
    v_add_f32 v183, v183, v3
    v_cmp_gt_u32 vcc, 16, v1
    s_nop 1
    v_cndmask_b32 v180, v182, v180, vcc
    v_cndmask_b32 v181, v183, v181, vcc
    s_lshl_b32 s5, s45, 4
    s_lshl_b32 s6, s46, 1
    s_add_u32 s5, s5, s6
    s_add_u32 s5, s5, s80
    s_lshl_b32 s5, s5, 9
    s_lshl_b32 s6, s79, 8
    s_add_u32 s5, s5, s6
    s_mov_b64 exec, 0xffffffff
    buffer_store_dwordx2 v[180:181], v163, s[64:67], s5 offen sc1
    s_mov_b64 exec, -1
    s_waitcnt vmcnt(0)
    s_mov_b64 exec, 1
    v_mov_b32 v2, 156676
    v_mov_b32 v3, 1
    ds_add_rtn_u32 v4, v2, v3
    s_waitcnt lgkmcnt(0)
    v_readfirstlane_b32 s4, v4
    s_nop 2
    s_cmp_lg_u32 s4, 3
    s_cbranch_scc1 sig_sequential_preLN__grouped_kv_mqa__mixer_gmlp__prompt_kernel_13
    s_lshl_b32 s4, s46, 2
    s_add_u32 s4, s4, s82
    s_add_u32 s4, s4, 4096
    v_mov_b32 v2, 0
    v_mov_b32 v3, s26
    buffer_store_dword v3, v2, s[72:75], s4 offen sc1
sig_sequential_preLN__grouped_kv_mqa__mixer_gmlp__prompt_kernel_13:
    s_mov_b64 exec, -1
    s_cmp_eq_u32 s77, 7
    s_cbranch_scc1 sequential_preLN__grouped_kv_mqa__mixer_gmlp__prompt_kernel_c6
    v_and_b32 v2, 15, v1
    v_lshrrev_b32 v3, 4, v1
    v_lshrrev_b32 v4, 1, v2
    s_mov_b32 s5, 0
    v_add_u32 v5, 0, v3
    v_xor_b32 v5, v5, v4
    v_lshlrev_b32 v5, 4, v5
    v_lshl_add_u32 v5, v2, 7, v5
    v_add_u32 v5, s5, v5
    v_add_u32 v144, 0, v5
    v_add_u32 v5, 4, v3
    v_xor_b32 v5, v5, v4
    v_lshlrev_b32 v5, 4, v5
    v_lshl_add_u32 v5, v2, 7, v5
    v_add_u32 v5, s5, v5
    v_add_u32 v145, 0, v5
    v_lshrrev_b32 v4, 2, v2
    v_and_b32 v2, 3, v2
    v_lshl_add_u32 v5, v3, 3, v4
    v_lshlrev_b32 v5, 8, v5
    v_lshl_add_u32 v5, v2, 3, v5
    v_and_b32 v3, 1, v3
    v_lshl_or_b32 v4, v3, 2, v4
    s_mul_i32 s5, s44, 2
    v_mov_b32 v2, s5
    v_xor_b32 v2, v2, v4
    v_lshl_add_u32 v2, v2, 5, v5
    v_add_u32 v146, 65536, v2
    v_add_u32 v148, 131072, v2
    v_mov_b32 v2, s5
    v_add_u32 v2, 1, v2
    v_xor_b32 v2, v2, v4
    v_lshl_add_u32 v2, v2, 5, v5
    v_add_u32 v147, 65536, v2
    v_add_u32 v149, 131072, v2
    v_mov_b32 v168, 0x3f803f80
    v_mov_b32 v169, 0x3f803f80
    v_mov_b32 v170, 0x3f803f80
    v_mov_b32 v171, 0x3f803f80
    v_mov_b32 v32, 0
    v_mov_b32 v33, 0
    v_mov_b32 v34, 0
    v_mov_b32 v35, 0
    v_mov_b32 v36, 0
    v_mov_b32 v37, 0
    v_mov_b32 v38, 0
    v_mov_b32 v39, 0
    v_mov_b32 v40, 0
    v_mov_b32 v41, 0
    v_mov_b32 v42, 0
    v_mov_b32 v43, 0
    v_mov_b32 v44, 0
    v_mov_b32 v45, 0
    v_mov_b32 v46, 0
    v_mov_b32 v47, 0
    v_mov_b32 v48, 0
    v_mov_b32 v49, 0
    v_mov_b32 v50, 0
    v_mov_b32 v51, 0
    v_mov_b32 v52, 0
    v_mov_b32 v53, 0
    v_mov_b32 v54, 0
    v_mov_b32 v55, 0
    v_mov_b32 v56, 0
    v_mov_b32 v57, 0
    v_mov_b32 v58, 0
    v_mov_b32 v59, 0
    v_mov_b32 v60, 0
    v_mov_b32 v61, 0
    v_mov_b32 v62, 0
    v_mov_b32 v63, 0
    v_mov_b32 v64, 0
    v_mov_b32 v65, 0
    v_mov_b32 v66, 0
    v_mov_b32 v67, 0
    v_mov_b32 v68, 0
    v_mov_b32 v69, 0
    v_mov_b32 v70, 0
    v_mov_b32 v71, 0
    v_mov_b32 v72, 0
    v_mov_b32 v73, 0
    v_mov_b32 v74, 0
    v_mov_b32 v75, 0
    v_mov_b32 v76, 0
    v_mov_b32 v77, 0
    v_mov_b32 v78, 0
    v_mov_b32 v79, 0
    v_mov_b32 v80, 0
    v_mov_b32 v81, 0
    v_mov_b32 v82, 0
    v_mov_b32 v83, 0
    v_mov_b32 v84, 0
    v_mov_b32 v85, 0
    v_mov_b32 v86, 0
    v_mov_b32 v87, 0
    v_mov_b32 v88, 0
    v_mov_b32 v89, 0
    v_mov_b32 v90, 0
    v_mov_b32 v91, 0
    v_mov_b32 v92, 0
    v_mov_b32 v93, 0
    v_mov_b32 v94, 0
    v_mov_b32 v95, 0
    v_mov_b32 v152, 0
    v_mov_b32 v153, 0
    v_mov_b32 v154, 0
    v_mov_b32 v155, 0
    v_mov_b32 v156, 0
    v_mov_b32 v157, 0
    v_mov_b32 v158, 0
    v_mov_b32 v159, 0
    v_mov_b32 v160, 0
    v_mov_b32 v161, 0
    v_mov_b32 v162, 0
    v_mov_b32 v163, 0
    v_mov_b32 v164, 0
    v_mov_b32 v165, 0
    v_mov_b32 v166, 0
    v_mov_b32 v167, 0
    v_mov_b32 v212, 0xc0135761
    v_mov_b32 v213, 0xbdd2d3e8
    v_and_b32 v3, 15, v1
    v_lshrrev_b32 v2, 4, v1
    v_lshlrev_b32 v2, 11, v2
    v_lshl_add_u32 v230, v3, 3, v2
    s_lshl_b32 s20, s76, 13
    s_cmp_lg_u32 s44, 0
    s_cbranch_scc1 rel_sequential_preLN__grouped_kv_mqa__mixer_gmlp__prompt_kernel_14
    s_add_u32 s4, s88, 4096
    v_lshlrev_b32 v2, 2, v1
    s_mov_b64 exec, 255
    s_mov_b32 s83, 0x40000
poll_sequential_preLN__grouped_kv_mqa__mixer_gmlp__prompt_kernel_15:
    buffer_load_dword v3, v2, s[72:75], s4 offen sc1
    s_waitcnt vmcnt(0)
    v_cmp_ne_u32 vcc, s26, v3
    s_nop 2
    s_cmp_eq_u64 vcc, 0
    s_cbranch_scc1 polld_sequential_preLN__grouped_kv_mqa__mixer_gmlp__prompt_kernel_16
    s_sleep 0
    s_sub_u32 s83, s83, 1
    s_cmp_lg_u32 s83, 0
    s_cbranch_scc1 poll_sequential_preLN__grouped_kv_mqa__mixer_gmlp__prompt_kernel_15
polld_sequential_preLN__grouped_kv_mqa__mixer_gmlp__prompt_kernel_16:
    s_mov_b64 exec, -1
rel_sequential_preLN__grouped_kv_mqa__mixer_gmlp__prompt_kernel_14:
    s_barrier
    buffer_load_dwordx2 v[172:173], v230, s[64:67], s20 offen offset:0 sc1
    buffer_load_dwordx2 v[174:175], v230, s[64:67], s20 offen offset:512 sc1
    buffer_load_dwordx2 v[176:177], v230, s[64:67], s20 offen offset:1024 sc1
    buffer_load_dwordx2 v[178:179], v230, s[64:67], s20 offen offset:1536 sc1
    buffer_load_dwordx2 v[180:181], v230, s[64:67], s20 offen offset:128 sc1
    buffer_load_dwordx2 v[182:183], v230, s[64:67], s20 offen offset:640 sc1
    buffer_load_dwordx2 v[184:185], v230, s[64:67], s20 offen offset:1152 sc1
    buffer_load_dwordx2 v[186:187], v230, s[64:67], s20 offen offset:1664 sc1
    buffer_load_dwordx2 v[188:189], v230, s[64:67], s20 offen offset:256 sc1
    buffer_load_dwordx2 v[190:191], v230, s[64:67], s20 offen offset:768 sc1
    buffer_load_dwordx2 v[192:193], v230, s[64:67], s20 offen offset:1280 sc1
    buffer_load_dwordx2 v[194:195], v230, s[64:67], s20 offen offset:1792 sc1
    buffer_load_dwordx2 v[196:197], v230, s[64:67], s20 offen offset:384 sc1
    buffer_load_dwordx2 v[198:199], v230, s[64:67], s20 offen offset:896 sc1
    buffer_load_dwordx2 v[200:201], v230, s[64:67], s20 offen offset:1408 sc1
    buffer_load_dwordx2 v[202:203], v230, s[64:67], s20 offen offset:1920 sc1
    s_add_u32 s56, s40, 2359296
    s_addc_u32 s57, s41, 0
    s_mov_b32 s58, 114688
    s_mov_b32 s59, 0x00020000
    s_add_u32 s60, s40, 16777216
    s_addc_u32 s61, s41, 0
    s_mov_b32 s62, 3670016
    s_mov_b32 s63, 0x00020000
    s_waitcnt vmcnt(0)
    v_add_f32 v204, v172, v174
    v_add_f32 v205, v173, v175
    v_add_f32 v204, v204, v176
    v_add_f32 v205, v205, v177
    v_add_f32 v204, v204, v178
    v_add_f32 v205, v205, v179
    v_mov_b32 v2, v204
    s_nop 1
    v_permlane16_swap_b32 v2, v204
    v_add_f32 v204, v204, v2
    v_mov_b32 v2, v204
    s_nop 1
    v_permlane32_swap_b32 v2, v204
    v_add_f32 v204, v204, v2
    v_mov_b32 v3, v205
    s_nop 1
    v_permlane16_swap_b32 v3, v205
    v_add_f32 v205, v205, v3
    v_mov_b32 v3, v205
    s_nop 1
    v_permlane32_swap_b32 v3, v205
    v_add_f32 v205, v205, v3
    v_mul_f32 v204, 0x3b000000, v204
    v_mul_f32 v205, 0x3b000000, v205
    v_fma_f32 v205, -v204, v204, v205
    v_max_f32 v205, 0, v205
    v_add_f32 v205, s81, v205
    v_rsq_f32 v205, v205
    v_add_f32 v206, v180, v182
    v_add_f32 v207, v181, v183
    v_add_f32 v206, v206, v184
    v_add_f32 v207, v207, v185
    v_add_f32 v206, v206, v186
    v_add_f32 v207, v207, v187
    v_mov_b32 v2, v206
    s_nop 1
    v_permlane16_swap_b32 v2, v206
    v_add_f32 v206, v206, v2
    v_mov_b32 v2, v206
    s_nop 1
    v_permlane32_swap_b32 v2, v206
    v_add_f32 v206, v206, v2
    v_mov_b32 v3, v207
    s_nop 1
    v_permlane16_swap_b32 v3, v207
    v_add_f32 v207, v207, v3
    v_mov_b32 v3, v207
    s_nop 1
    v_permlane32_swap_b32 v3, v207
    v_add_f32 v207, v207, v3
    v_mul_f32 v206, 0x3b000000, v206
    v_mul_f32 v207, 0x3b000000, v207
    v_fma_f32 v207, -v206, v206, v207
    v_max_f32 v207, 0, v207
    v_add_f32 v207, s81, v207
    v_rsq_f32 v207, v207
    v_add_f32 v208, v188, v190
    v_add_f32 v209, v189, v191
    v_add_f32 v208, v208, v192
    v_add_f32 v209, v209, v193
    v_add_f32 v208, v208, v194
    v_add_f32 v209, v209, v195
    v_mov_b32 v2, v208
    s_nop 1
    v_permlane16_swap_b32 v2, v208
    v_add_f32 v208, v208, v2
    v_mov_b32 v2, v208
    s_nop 1
    v_permlane32_swap_b32 v2, v208
    v_add_f32 v208, v208, v2
    v_mov_b32 v3, v209
    s_nop 1
    v_permlane16_swap_b32 v3, v209
    v_add_f32 v209, v209, v3
    v_mov_b32 v3, v209
    s_nop 1
    v_permlane32_swap_b32 v3, v209
    v_add_f32 v209, v209, v3
    v_mul_f32 v208, 0x3b000000, v208
    v_mul_f32 v209, 0x3b000000, v209
    v_fma_f32 v209, -v208, v208, v209
    v_max_f32 v209, 0, v209
    v_add_f32 v209, s81, v209
    v_rsq_f32 v209, v209
    v_add_f32 v210, v196, v198
    v_add_f32 v211, v197, v199
    v_add_f32 v210, v210, v200
    v_add_f32 v211, v211, v201
    v_add_f32 v210, v210, v202
    v_add_f32 v211, v211, v203
    v_mov_b32 v2, v210
    s_nop 1
    v_permlane16_swap_b32 v2, v210
    v_add_f32 v210, v210, v2
    v_mov_b32 v2, v210
    s_nop 1
    v_permlane32_swap_b32 v2, v210
    v_add_f32 v210, v210, v2
    v_mov_b32 v3, v211
    s_nop 1
    v_permlane16_swap_b32 v3, v211
    v_add_f32 v211, v211, v3
    v_mov_b32 v3, v211
    s_nop 1
    v_permlane32_swap_b32 v3, v211
    v_add_f32 v211, v211, v3
    v_mul_f32 v210, 0x3b000000, v210
    v_mul_f32 v211, 0x3b000000, v211
    v_fma_f32 v211, -v210, v210, v211
    v_max_f32 v211, 0, v211
    v_add_f32 v211, s81, v211
    v_rsq_f32 v211, v211
    s_barrier
    ds_read_b128 v[96:99], v144 offset:0
    ds_read_b128 v[100:103], v144 offset:2048
    ds_read_b128 v[104:107], v144 offset:4096
    ds_read_b128 v[108:111], v144 offset:6144
    ds_read_b64_tr_b16 v[128:129], v148 offset:0
    ds_read_b64_tr_b16 v[130:131], v148 offset:1024
    ds_read_b64_tr_b16 v[132:133], v149 offset:0
    ds_read_b64_tr_b16 v[134:135], v149 offset:1024
    s_waitcnt lgkmcnt(0)
    v_mfma_f32_16x16x32_bf16 v[32:35], v[128:131], v[96:99], v[32:35]
    ds_read_b128 v[112:115], v145 offset:0
    v_mfma_f32_16x16x32_bf16 v[40:43], v[128:131], v[100:103], v[40:43]
    ds_read_b128 v[116:119], v145 offset:2048
    v_mfma_f32_16x16x32_bf16 v[48:51], v[128:131], v[104:107], v[48:51]
    ds_read_b128 v[120:123], v145 offset:4096
    v_mfma_f32_16x16x32_bf16 v[56:59], v[128:131], v[108:111], v[56:59]
    ds_read_b128 v[124:127], v145 offset:6144
    v_mfma_f32_16x16x32_bf16 v[36:39], v[132:135], v[96:99], v[36:39]
    ds_read_b64_tr_b16 v[136:137], v148 offset:8192
    v_mfma_f32_16x16x32_bf16 v[44:47], v[132:135], v[100:103], v[44:47]
    ds_read_b64_tr_b16 v[138:139], v148 offset:9216
    v_mfma_f32_16x16x32_bf16 v[52:55], v[132:135], v[104:107], v[52:55]
    ds_read_b64_tr_b16 v[140:141], v149 offset:8192
    v_mfma_f32_16x16x32_bf16 v[60:63], v[132:135], v[108:111], v[60:63]
    ds_read_b64_tr_b16 v[142:143], v149 offset:9216
    v_mfma_f32_16x16x32_bf16 v[152:155], v[128:131], v[168:171], v[152:155]
    v_mfma_f32_16x16x32_bf16 v[156:159], v[132:135], v[168:171], v[156:159]
    s_waitcnt lgkmcnt(0)
    s_barrier
    v_mfma_f32_16x16x32_bf16 v[32:35], v[136:139], v[112:115], v[32:35]
    ds_read_b128 v[96:99], v144 offset:8192
    v_mfma_f32_16x16x32_bf16 v[40:43], v[136:139], v[116:119], v[40:43]
    ds_read_b128 v[100:103], v144 offset:10240
    v_mfma_f32_16x16x32_bf16 v[48:51], v[136:139], v[120:123], v[48:51]
    ds_read_b128 v[104:107], v144 offset:12288
    v_mfma_f32_16x16x32_bf16 v[56:59], v[136:139], v[124:127], v[56:59]
    ds_read_b128 v[108:111], v144 offset:14336
    v_mfma_f32_16x16x32_bf16 v[36:39], v[140:143], v[112:115], v[36:39]
    ds_read_b64_tr_b16 v[128:129], v146 offset:0
    v_mfma_f32_16x16x32_bf16 v[44:47], v[140:143], v[116:119], v[44:47]
    ds_read_b64_tr_b16 v[130:131], v146 offset:1024
    v_mfma_f32_16x16x32_bf16 v[52:55], v[140:143], v[120:123], v[52:55]
    ds_read_b64_tr_b16 v[132:133], v147 offset:0
    v_mfma_f32_16x16x32_bf16 v[60:63], v[140:143], v[124:127], v[60:63]
    ds_read_b64_tr_b16 v[134:135], v147 offset:1024
    v_mfma_f32_16x16x32_bf16 v[152:155], v[136:139], v[168:171], v[152:155]
    v_mfma_f32_16x16x32_bf16 v[156:159], v[140:143], v[168:171], v[156:159]
    s_waitcnt lgkmcnt(0)
    v_mfma_f32_16x16x32_bf16 v[32:35], v[128:131], v[96:99], v[32:35]
    ds_read_b128 v[112:115], v145 offset:8192
    v_mfma_f32_16x16x32_bf16 v[40:43], v[128:131], v[100:103], v[40:43]
    ds_read_b128 v[116:119], v145 offset:10240
    v_mfma_f32_16x16x32_bf16 v[48:51], v[128:131], v[104:107], v[48:51]
    ds_read_b128 v[120:123], v145 offset:12288
    v_mfma_f32_16x16x32_bf16 v[56:59], v[128:131], v[108:111], v[56:59]
    ds_read_b128 v[124:127], v145 offset:14336
    v_mfma_f32_16x16x32_bf16 v[36:39], v[132:135], v[96:99], v[36:39]
    ds_read_b64_tr_b16 v[136:137], v146 offset:8192
    v_mfma_f32_16x16x32_bf16 v[44:47], v[132:135], v[100:103], v[44:47]
    ds_read_b64_tr_b16 v[138:139], v146 offset:9216
    v_mfma_f32_16x16x32_bf16 v[52:55], v[132:135], v[104:107], v[52:55]
    ds_read_b64_tr_b16 v[140:141], v147 offset:8192
    v_mfma_f32_16x16x32_bf16 v[60:63], v[132:135], v[108:111], v[60:63]
    ds_read_b64_tr_b16 v[142:143], v147 offset:9216
    v_mfma_f32_16x16x32_bf16 v[152:155], v[128:131], v[168:171], v[152:155]
    v_mfma_f32_16x16x32_bf16 v[156:159], v[132:135], v[168:171], v[156:159]
    s_waitcnt lgkmcnt(0)
    s_barrier
    v_mfma_f32_16x16x32_bf16 v[32:35], v[136:139], v[112:115], v[32:35]
    ds_read_b128 v[96:99], v144 offset:16384
    v_mfma_f32_16x16x32_bf16 v[40:43], v[136:139], v[116:119], v[40:43]
    ds_read_b128 v[100:103], v144 offset:18432
    v_mfma_f32_16x16x32_bf16 v[48:51], v[136:139], v[120:123], v[48:51]
    ds_read_b128 v[104:107], v144 offset:20480
    v_mfma_f32_16x16x32_bf16 v[56:59], v[136:139], v[124:127], v[56:59]
    ds_read_b128 v[108:111], v144 offset:22528
    v_mfma_f32_16x16x32_bf16 v[36:39], v[140:143], v[112:115], v[36:39]
    ds_read_b64_tr_b16 v[128:129], v146 offset:16384
    v_mfma_f32_16x16x32_bf16 v[44:47], v[140:143], v[116:119], v[44:47]
    ds_read_b64_tr_b16 v[130:131], v146 offset:17408
    v_mfma_f32_16x16x32_bf16 v[52:55], v[140:143], v[120:123], v[52:55]
    ds_read_b64_tr_b16 v[132:133], v147 offset:16384
    v_mfma_f32_16x16x32_bf16 v[60:63], v[140:143], v[124:127], v[60:63]
    ds_read_b64_tr_b16 v[134:135], v147 offset:17408
    v_mfma_f32_16x16x32_bf16 v[152:155], v[136:139], v[168:171], v[152:155]
    v_mfma_f32_16x16x32_bf16 v[156:159], v[140:143], v[168:171], v[156:159]
    s_waitcnt lgkmcnt(0)
    v_mfma_f32_16x16x32_bf16 v[32:35], v[128:131], v[96:99], v[32:35]
    ds_read_b128 v[112:115], v145 offset:16384
    v_mfma_f32_16x16x32_bf16 v[40:43], v[128:131], v[100:103], v[40:43]
    ds_read_b128 v[116:119], v145 offset:18432
    v_mfma_f32_16x16x32_bf16 v[48:51], v[128:131], v[104:107], v[48:51]
    ds_read_b128 v[120:123], v145 offset:20480
    v_mfma_f32_16x16x32_bf16 v[56:59], v[128:131], v[108:111], v[56:59]
    ds_read_b128 v[124:127], v145 offset:22528
    v_mfma_f32_16x16x32_bf16 v[36:39], v[132:135], v[96:99], v[36:39]
    ds_read_b64_tr_b16 v[136:137], v146 offset:24576
    v_mfma_f32_16x16x32_bf16 v[44:47], v[132:135], v[100:103], v[44:47]
    ds_read_b64_tr_b16 v[138:139], v146 offset:25600
    v_mfma_f32_16x16x32_bf16 v[52:55], v[132:135], v[104:107], v[52:55]
    ds_read_b64_tr_b16 v[140:141], v147 offset:24576
    v_mfma_f32_16x16x32_bf16 v[60:63], v[132:135], v[108:111], v[60:63]
    ds_read_b64_tr_b16 v[142:143], v147 offset:25600
    v_mfma_f32_16x16x32_bf16 v[152:155], v[128:131], v[168:171], v[152:155]
    v_mfma_f32_16x16x32_bf16 v[156:159], v[132:135], v[168:171], v[156:159]
    s_waitcnt lgkmcnt(0)
    s_barrier
    v_mfma_f32_16x16x32_bf16 v[32:35], v[136:139], v[112:115], v[32:35]
    ds_read_b128 v[96:99], v144 offset:24576
    v_mfma_f32_16x16x32_bf16 v[40:43], v[136:139], v[116:119], v[40:43]
    ds_read_b128 v[100:103], v144 offset:26624
    v_mfma_f32_16x16x32_bf16 v[48:51], v[136:139], v[120:123], v[48:51]
    ds_read_b128 v[104:107], v144 offset:28672
    v_mfma_f32_16x16x32_bf16 v[56:59], v[136:139], v[124:127], v[56:59]
    ds_read_b128 v[108:111], v144 offset:30720
    v_mfma_f32_16x16x32_bf16 v[36:39], v[140:143], v[112:115], v[36:39]
    ds_read_b64_tr_b16 v[128:129], v146 offset:32768
    v_mfma_f32_16x16x32_bf16 v[44:47], v[140:143], v[116:119], v[44:47]
    ds_read_b64_tr_b16 v[130:131], v146 offset:33792
    v_mfma_f32_16x16x32_bf16 v[52:55], v[140:143], v[120:123], v[52:55]
    ds_read_b64_tr_b16 v[132:133], v147 offset:32768
    v_mfma_f32_16x16x32_bf16 v[60:63], v[140:143], v[124:127], v[60:63]
    ds_read_b64_tr_b16 v[134:135], v147 offset:33792
    v_mfma_f32_16x16x32_bf16 v[152:155], v[136:139], v[168:171], v[152:155]
    v_mfma_f32_16x16x32_bf16 v[156:159], v[140:143], v[168:171], v[156:159]
    s_waitcnt lgkmcnt(0)
    v_mfma_f32_16x16x32_bf16 v[32:35], v[128:131], v[96:99], v[32:35]
    ds_read_b128 v[112:115], v145 offset:24576
    v_mfma_f32_16x16x32_bf16 v[40:43], v[128:131], v[100:103], v[40:43]
    ds_read_b128 v[116:119], v145 offset:26624
    v_mfma_f32_16x16x32_bf16 v[48:51], v[128:131], v[104:107], v[48:51]
    ds_read_b128 v[120:123], v145 offset:28672
    v_mfma_f32_16x16x32_bf16 v[56:59], v[128:131], v[108:111], v[56:59]
    ds_read_b128 v[124:127], v145 offset:30720
    v_mfma_f32_16x16x32_bf16 v[36:39], v[132:135], v[96:99], v[36:39]
    ds_read_b64_tr_b16 v[136:137], v146 offset:40960
    v_mfma_f32_16x16x32_bf16 v[44:47], v[132:135], v[100:103], v[44:47]
    ds_read_b64_tr_b16 v[138:139], v146 offset:41984
    v_mfma_f32_16x16x32_bf16 v[52:55], v[132:135], v[104:107], v[52:55]
    ds_read_b64_tr_b16 v[140:141], v147 offset:40960
    v_mfma_f32_16x16x32_bf16 v[60:63], v[132:135], v[108:111], v[60:63]
    ds_read_b64_tr_b16 v[142:143], v147 offset:41984
    v_mfma_f32_16x16x32_bf16 v[152:155], v[128:131], v[168:171], v[152:155]
    v_mfma_f32_16x16x32_bf16 v[156:159], v[132:135], v[168:171], v[156:159]
    s_waitcnt lgkmcnt(0)
    s_barrier
    v_mfma_f32_16x16x32_bf16 v[32:35], v[136:139], v[112:115], v[32:35]
    ds_read_b128 v[96:99], v144 offset:32768
    v_mfma_f32_16x16x32_bf16 v[40:43], v[136:139], v[116:119], v[40:43]
    ds_read_b128 v[100:103], v144 offset:34816
    v_mfma_f32_16x16x32_bf16 v[48:51], v[136:139], v[120:123], v[48:51]
    ds_read_b128 v[104:107], v144 offset:36864
    v_mfma_f32_16x16x32_bf16 v[56:59], v[136:139], v[124:127], v[56:59]
    ds_read_b128 v[108:111], v144 offset:38912
    v_mfma_f32_16x16x32_bf16 v[36:39], v[140:143], v[112:115], v[36:39]
    ds_read_b64_tr_b16 v[128:129], v146 offset:49152
    v_mfma_f32_16x16x32_bf16 v[44:47], v[140:143], v[116:119], v[44:47]
    ds_read_b64_tr_b16 v[130:131], v146 offset:50176
    v_mfma_f32_16x16x32_bf16 v[52:55], v[140:143], v[120:123], v[52:55]
    ds_read_b64_tr_b16 v[132:133], v147 offset:49152
    v_mfma_f32_16x16x32_bf16 v[60:63], v[140:143], v[124:127], v[60:63]
    ds_read_b64_tr_b16 v[134:135], v147 offset:50176
    v_mfma_f32_16x16x32_bf16 v[152:155], v[136:139], v[168:171], v[152:155]
    v_mfma_f32_16x16x32_bf16 v[156:159], v[140:143], v[168:171], v[156:159]
    s_waitcnt lgkmcnt(0)
    v_mfma_f32_16x16x32_bf16 v[32:35], v[128:131], v[96:99], v[32:35]
    ds_read_b128 v[112:115], v145 offset:32768
    v_mfma_f32_16x16x32_bf16 v[40:43], v[128:131], v[100:103], v[40:43]
    ds_read_b128 v[116:119], v145 offset:34816
    v_mfma_f32_16x16x32_bf16 v[48:51], v[128:131], v[104:107], v[48:51]
    ds_read_b128 v[120:123], v145 offset:36864
    v_mfma_f32_16x16x32_bf16 v[56:59], v[128:131], v[108:111], v[56:59]
    ds_read_b128 v[124:127], v145 offset:38912
    v_mfma_f32_16x16x32_bf16 v[36:39], v[132:135], v[96:99], v[36:39]
    ds_read_b64_tr_b16 v[136:137], v146 offset:57344
    v_mfma_f32_16x16x32_bf16 v[44:47], v[132:135], v[100:103], v[44:47]
    ds_read_b64_tr_b16 v[138:139], v146 offset:58368
    v_mfma_f32_16x16x32_bf16 v[52:55], v[132:135], v[104:107], v[52:55]
    ds_read_b64_tr_b16 v[140:141], v147 offset:57344
    v_mfma_f32_16x16x32_bf16 v[60:63], v[132:135], v[108:111], v[60:63]
    ds_read_b64_tr_b16 v[142:143], v147 offset:58368
    v_mfma_f32_16x16x32_bf16 v[152:155], v[128:131], v[168:171], v[152:155]
    v_mfma_f32_16x16x32_bf16 v[156:159], v[132:135], v[168:171], v[156:159]
    s_waitcnt lgkmcnt(0)
    s_barrier
    v_mfma_f32_16x16x32_bf16 v[32:35], v[136:139], v[112:115], v[32:35]
    ds_read_b128 v[96:99], v144 offset:40960
    v_mfma_f32_16x16x32_bf16 v[40:43], v[136:139], v[116:119], v[40:43]
    ds_read_b128 v[100:103], v144 offset:43008
    v_mfma_f32_16x16x32_bf16 v[48:51], v[136:139], v[120:123], v[48:51]
    ds_read_b128 v[104:107], v144 offset:45056
    v_mfma_f32_16x16x32_bf16 v[56:59], v[136:139], v[124:127], v[56:59]
    ds_read_b128 v[108:111], v144 offset:47104
    v_mfma_f32_16x16x32_bf16 v[36:39], v[140:143], v[112:115], v[36:39]
    ds_read_b64_tr_b16 v[128:129], v148 offset:0
    v_mfma_f32_16x16x32_bf16 v[44:47], v[140:143], v[116:119], v[44:47]
    ds_read_b64_tr_b16 v[130:131], v148 offset:1024
    v_mfma_f32_16x16x32_bf16 v[52:55], v[140:143], v[120:123], v[52:55]
    ds_read_b64_tr_b16 v[132:133], v149 offset:0
    v_mfma_f32_16x16x32_bf16 v[60:63], v[140:143], v[124:127], v[60:63]
    ds_read_b64_tr_b16 v[134:135], v149 offset:1024
    v_mfma_f32_16x16x32_bf16 v[152:155], v[136:139], v[168:171], v[152:155]
    v_mfma_f32_16x16x32_bf16 v[156:159], v[140:143], v[168:171], v[156:159]
    s_waitcnt lgkmcnt(0)
    v_mfma_f32_16x16x32_bf16 v[32:35], v[128:131], v[96:99], v[32:35]
    ds_read_b128 v[112:115], v145 offset:40960
    v_mfma_f32_16x16x32_bf16 v[40:43], v[128:131], v[100:103], v[40:43]
    ds_read_b128 v[116:119], v145 offset:43008
    v_mfma_f32_16x16x32_bf16 v[48:51], v[128:131], v[104:107], v[48:51]
    ds_read_b128 v[120:123], v145 offset:45056
    v_mfma_f32_16x16x32_bf16 v[56:59], v[128:131], v[108:111], v[56:59]
    ds_read_b128 v[124:127], v145 offset:47104
    v_mfma_f32_16x16x32_bf16 v[36:39], v[132:135], v[96:99], v[36:39]
    ds_read_b64_tr_b16 v[136:137], v148 offset:8192
    v_mfma_f32_16x16x32_bf16 v[44:47], v[132:135], v[100:103], v[44:47]
    ds_read_b64_tr_b16 v[138:139], v148 offset:9216
    v_mfma_f32_16x16x32_bf16 v[52:55], v[132:135], v[104:107], v[52:55]
    ds_read_b64_tr_b16 v[140:141], v149 offset:8192
    v_mfma_f32_16x16x32_bf16 v[60:63], v[132:135], v[108:111], v[60:63]
    ds_read_b64_tr_b16 v[142:143], v149 offset:9216
    v_mfma_f32_16x16x32_bf16 v[152:155], v[128:131], v[168:171], v[152:155]
    v_mfma_f32_16x16x32_bf16 v[156:159], v[132:135], v[168:171], v[156:159]
    s_waitcnt lgkmcnt(0)
    s_barrier
    v_mfma_f32_16x16x32_bf16 v[32:35], v[136:139], v[112:115], v[32:35]
    ds_read_b128 v[96:99], v144 offset:49152
    v_mfma_f32_16x16x32_bf16 v[40:43], v[136:139], v[116:119], v[40:43]
    ds_read_b128 v[100:103], v144 offset:51200
    v_mfma_f32_16x16x32_bf16 v[48:51], v[136:139], v[120:123], v[48:51]
    ds_read_b128 v[104:107], v144 offset:53248
    v_mfma_f32_16x16x32_bf16 v[56:59], v[136:139], v[124:127], v[56:59]
    ds_read_b128 v[108:111], v144 offset:55296
    v_mfma_f32_16x16x32_bf16 v[36:39], v[140:143], v[112:115], v[36:39]
    ds_read_b64_tr_b16 v[128:129], v146 offset:0
    v_mfma_f32_16x16x32_bf16 v[44:47], v[140:143], v[116:119], v[44:47]
    ds_read_b64_tr_b16 v[130:131], v146 offset:1024
    v_mfma_f32_16x16x32_bf16 v[52:55], v[140:143], v[120:123], v[52:55]
    ds_read_b64_tr_b16 v[132:133], v147 offset:0
    v_mfma_f32_16x16x32_bf16 v[60:63], v[140:143], v[124:127], v[60:63]
    ds_read_b64_tr_b16 v[134:135], v147 offset:1024
    v_mfma_f32_16x16x32_bf16 v[152:155], v[136:139], v[168:171], v[152:155]
    v_mfma_f32_16x16x32_bf16 v[156:159], v[140:143], v[168:171], v[156:159]
    s_waitcnt lgkmcnt(0)
    v_mfma_f32_16x16x32_bf16 v[32:35], v[128:131], v[96:99], v[32:35]
    ds_read_b128 v[112:115], v145 offset:49152
    v_mfma_f32_16x16x32_bf16 v[40:43], v[128:131], v[100:103], v[40:43]
    ds_read_b128 v[116:119], v145 offset:51200
    v_mfma_f32_16x16x32_bf16 v[48:51], v[128:131], v[104:107], v[48:51]
    ds_read_b128 v[120:123], v145 offset:53248
    v_mfma_f32_16x16x32_bf16 v[56:59], v[128:131], v[108:111], v[56:59]
    ds_read_b128 v[124:127], v145 offset:55296
    v_mfma_f32_16x16x32_bf16 v[36:39], v[132:135], v[96:99], v[36:39]
    ds_read_b64_tr_b16 v[136:137], v146 offset:8192
    v_mfma_f32_16x16x32_bf16 v[44:47], v[132:135], v[100:103], v[44:47]
    ds_read_b64_tr_b16 v[138:139], v146 offset:9216
    v_mfma_f32_16x16x32_bf16 v[52:55], v[132:135], v[104:107], v[52:55]
    ds_read_b64_tr_b16 v[140:141], v147 offset:8192
    v_mfma_f32_16x16x32_bf16 v[60:63], v[132:135], v[108:111], v[60:63]
    ds_read_b64_tr_b16 v[142:143], v147 offset:9216
    v_mfma_f32_16x16x32_bf16 v[152:155], v[128:131], v[168:171], v[152:155]
    v_mfma_f32_16x16x32_bf16 v[156:159], v[132:135], v[168:171], v[156:159]
    s_waitcnt lgkmcnt(0)
    s_barrier
    v_mfma_f32_16x16x32_bf16 v[32:35], v[136:139], v[112:115], v[32:35]
    ds_read_b128 v[96:99], v144 offset:57344
    v_mfma_f32_16x16x32_bf16 v[40:43], v[136:139], v[116:119], v[40:43]
    ds_read_b128 v[100:103], v144 offset:59392
    v_mfma_f32_16x16x32_bf16 v[48:51], v[136:139], v[120:123], v[48:51]
    ds_read_b128 v[104:107], v144 offset:61440
    v_mfma_f32_16x16x32_bf16 v[56:59], v[136:139], v[124:127], v[56:59]
    ds_read_b128 v[108:111], v144 offset:63488
    v_mfma_f32_16x16x32_bf16 v[36:39], v[140:143], v[112:115], v[36:39]
    ds_read_b64_tr_b16 v[128:129], v146 offset:16384
    v_mfma_f32_16x16x32_bf16 v[44:47], v[140:143], v[116:119], v[44:47]
    ds_read_b64_tr_b16 v[130:131], v146 offset:17408
    v_mfma_f32_16x16x32_bf16 v[52:55], v[140:143], v[120:123], v[52:55]
    ds_read_b64_tr_b16 v[132:133], v147 offset:16384
    v_mfma_f32_16x16x32_bf16 v[60:63], v[140:143], v[124:127], v[60:63]
    ds_read_b64_tr_b16 v[134:135], v147 offset:17408
    v_mfma_f32_16x16x32_bf16 v[152:155], v[136:139], v[168:171], v[152:155]
    v_mfma_f32_16x16x32_bf16 v[156:159], v[140:143], v[168:171], v[156:159]
    s_waitcnt lgkmcnt(0)
    v_mfma_f32_16x16x32_bf16 v[32:35], v[128:131], v[96:99], v[32:35]
    ds_read_b128 v[112:115], v145 offset:57344
    v_mfma_f32_16x16x32_bf16 v[40:43], v[128:131], v[100:103], v[40:43]
    ds_read_b128 v[116:119], v145 offset:59392
    v_mfma_f32_16x16x32_bf16 v[48:51], v[128:131], v[104:107], v[48:51]
    ds_read_b128 v[120:123], v145 offset:61440
    v_mfma_f32_16x16x32_bf16 v[56:59], v[128:131], v[108:111], v[56:59]
    ds_read_b128 v[124:127], v145 offset:63488
    v_mfma_f32_16x16x32_bf16 v[36:39], v[132:135], v[96:99], v[36:39]
    ds_read_b64_tr_b16 v[136:137], v146 offset:24576
    v_mfma_f32_16x16x32_bf16 v[44:47], v[132:135], v[100:103], v[44:47]
    ds_read_b64_tr_b16 v[138:139], v146 offset:25600
    v_mfma_f32_16x16x32_bf16 v[52:55], v[132:135], v[104:107], v[52:55]
    ds_read_b64_tr_b16 v[140:141], v147 offset:24576
    v_mfma_f32_16x16x32_bf16 v[60:63], v[132:135], v[108:111], v[60:63]
    ds_read_b64_tr_b16 v[142:143], v147 offset:25600
    v_mfma_f32_16x16x32_bf16 v[152:155], v[128:131], v[168:171], v[152:155]
    v_mfma_f32_16x16x32_bf16 v[156:159], v[132:135], v[168:171], v[156:159]
    s_waitcnt lgkmcnt(0)
    s_barrier
    v_mfma_f32_16x16x32_bf16 v[32:35], v[136:139], v[112:115], v[32:35]
    ds_read_b128 v[96:99], v144 offset:0
    v_mfma_f32_16x16x32_bf16 v[40:43], v[136:139], v[116:119], v[40:43]
    ds_read_b128 v[100:103], v144 offset:2048
    v_mfma_f32_16x16x32_bf16 v[48:51], v[136:139], v[120:123], v[48:51]
    ds_read_b128 v[104:107], v144 offset:4096
    v_mfma_f32_16x16x32_bf16 v[56:59], v[136:139], v[124:127], v[56:59]
    ds_read_b128 v[108:111], v144 offset:6144
    v_mfma_f32_16x16x32_bf16 v[36:39], v[140:143], v[112:115], v[36:39]
    ds_read_b64_tr_b16 v[128:129], v146 offset:32768
    v_mfma_f32_16x16x32_bf16 v[44:47], v[140:143], v[116:119], v[44:47]
    ds_read_b64_tr_b16 v[130:131], v146 offset:33792
    v_mfma_f32_16x16x32_bf16 v[52:55], v[140:143], v[120:123], v[52:55]
    ds_read_b64_tr_b16 v[132:133], v147 offset:32768
    v_mfma_f32_16x16x32_bf16 v[60:63], v[140:143], v[124:127], v[60:63]
    ds_read_b64_tr_b16 v[134:135], v147 offset:33792
    v_mfma_f32_16x16x32_bf16 v[152:155], v[136:139], v[168:171], v[152:155]
    v_mfma_f32_16x16x32_bf16 v[156:159], v[140:143], v[168:171], v[156:159]
    s_nop 6
    v_pk_fma_f32 v[32:33], v[152:153], v[204:205], v[32:33] op_sel_hi:[1,0,1] neg_lo:[0,1,0] neg_hi:[0,1,0]
    v_pk_fma_f32 v[34:35], v[154:155], v[204:205], v[34:35] op_sel_hi:[1,0,1] neg_lo:[0,1,0] neg_hi:[0,1,0]
    v_pk_mul_f32 v[32:33], v[32:33], v[204:205] op_sel:[0,1] op_sel_hi:[1,1]
    v_pk_mul_f32 v[34:35], v[34:35], v[204:205] op_sel:[0,1] op_sel_hi:[1,1]
    v_pk_fma_f32 v[40:41], v[152:153], v[206:207], v[40:41] op_sel_hi:[1,0,1] neg_lo:[0,1,0] neg_hi:[0,1,0]
    v_pk_fma_f32 v[42:43], v[154:155], v[206:207], v[42:43] op_sel_hi:[1,0,1] neg_lo:[0,1,0] neg_hi:[0,1,0]
    v_pk_mul_f32 v[40:41], v[40:41], v[206:207] op_sel:[0,1] op_sel_hi:[1,1]
    v_pk_mul_f32 v[42:43], v[42:43], v[206:207] op_sel:[0,1] op_sel_hi:[1,1]
    v_pk_fma_f32 v[48:49], v[152:153], v[208:209], v[48:49] op_sel_hi:[1,0,1] neg_lo:[0,1,0] neg_hi:[0,1,0]
    v_pk_fma_f32 v[50:51], v[154:155], v[208:209], v[50:51] op_sel_hi:[1,0,1] neg_lo:[0,1,0] neg_hi:[0,1,0]
    v_pk_mul_f32 v[48:49], v[48:49], v[208:209] op_sel:[0,1] op_sel_hi:[1,1]
    v_pk_mul_f32 v[50:51], v[50:51], v[208:209] op_sel:[0,1] op_sel_hi:[1,1]
    v_pk_fma_f32 v[56:57], v[152:153], v[210:211], v[56:57] op_sel_hi:[1,0,1] neg_lo:[0,1,0] neg_hi:[0,1,0]
    v_pk_fma_f32 v[58:59], v[154:155], v[210:211], v[58:59] op_sel_hi:[1,0,1] neg_lo:[0,1,0] neg_hi:[0,1,0]
    v_pk_mul_f32 v[56:57], v[56:57], v[210:211] op_sel:[0,1] op_sel_hi:[1,1]
    v_pk_mul_f32 v[58:59], v[58:59], v[210:211] op_sel:[0,1] op_sel_hi:[1,1]
    v_pk_mul_f32 v[214:215], v[32:33], v[32:33]
    v_pk_mul_f32 v[216:217], v[34:35], v[34:35]
    v_pk_mul_f32 v[218:219], v[40:41], v[40:41]
    v_pk_mul_f32 v[220:221], v[42:43], v[42:43]
    v_pk_mul_f32 v[222:223], v[48:49], v[48:49]
    v_pk_mul_f32 v[224:225], v[50:51], v[50:51]
    v_pk_mul_f32 v[226:227], v[56:57], v[56:57]
    v_pk_mul_f32 v[228:229], v[58:59], v[58:59]
    v_pk_fma_f32 v[214:215], v[214:215], v[212:213], v[212:213] op_sel:[0,1,0] op_sel_hi:[1,1,0]
    v_pk_fma_f32 v[216:217], v[216:217], v[212:213], v[212:213] op_sel:[0,1,0] op_sel_hi:[1,1,0]
    v_pk_fma_f32 v[218:219], v[218:219], v[212:213], v[212:213] op_sel:[0,1,0] op_sel_hi:[1,1,0]
    v_pk_fma_f32 v[220:221], v[220:221], v[212:213], v[212:213] op_sel:[0,1,0] op_sel_hi:[1,1,0]
    v_pk_fma_f32 v[222:223], v[222:223], v[212:213], v[212:213] op_sel:[0,1,0] op_sel_hi:[1,1,0]
    v_pk_fma_f32 v[224:225], v[224:225], v[212:213], v[212:213] op_sel:[0,1,0] op_sel_hi:[1,1,0]
    v_pk_fma_f32 v[226:227], v[226:227], v[212:213], v[212:213] op_sel:[0,1,0] op_sel_hi:[1,1,0]
    v_pk_fma_f32 v[228:229], v[228:229], v[212:213], v[212:213] op_sel:[0,1,0] op_sel_hi:[1,1,0]
    v_pk_mul_f32 v[214:215], v[214:215], v[32:33]
    v_pk_mul_f32 v[216:217], v[216:217], v[34:35]
    v_pk_mul_f32 v[218:219], v[218:219], v[40:41]
    v_pk_mul_f32 v[220:221], v[220:221], v[42:43]
    v_pk_mul_f32 v[222:223], v[222:223], v[48:49]
    v_pk_mul_f32 v[224:225], v[224:225], v[50:51]
    v_pk_mul_f32 v[226:227], v[226:227], v[56:57]
    v_pk_mul_f32 v[228:229], v[228:229], v[58:59]
    v_exp_f32 v214, v214
    v_exp_f32 v215, v215
    v_exp_f32 v216, v216
    v_exp_f32 v217, v217
    v_exp_f32 v218, v218
    v_exp_f32 v219, v219
    v_exp_f32 v220, v220
    v_exp_f32 v221, v221
    v_exp_f32 v222, v222
    v_exp_f32 v223, v223
    v_exp_f32 v224, v224
    v_exp_f32 v225, v225
    v_exp_f32 v226, v226
    v_exp_f32 v227, v227
    v_exp_f32 v228, v228
    v_exp_f32 v229, v229
    v_pk_add_f32 v[214:215], v[214:215], 1.0 op_sel_hi:[1,0]
    v_pk_add_f32 v[216:217], v[216:217], 1.0 op_sel_hi:[1,0]
    v_pk_add_f32 v[218:219], v[218:219], 1.0 op_sel_hi:[1,0]
    v_pk_add_f32 v[220:221], v[220:221], 1.0 op_sel_hi:[1,0]
    v_pk_add_f32 v[222:223], v[222:223], 1.0 op_sel_hi:[1,0]
    v_pk_add_f32 v[224:225], v[224:225], 1.0 op_sel_hi:[1,0]
    v_pk_add_f32 v[226:227], v[226:227], 1.0 op_sel_hi:[1,0]
    v_pk_add_f32 v[228:229], v[228:229], 1.0 op_sel_hi:[1,0]
    v_rcp_f32 v214, v214
    v_rcp_f32 v215, v215
    v_rcp_f32 v216, v216
    v_rcp_f32 v217, v217
    v_rcp_f32 v218, v218
    v_rcp_f32 v219, v219
    v_rcp_f32 v220, v220
    v_rcp_f32 v221, v221
    v_rcp_f32 v222, v222
    v_rcp_f32 v223, v223
    v_rcp_f32 v224, v224
    v_rcp_f32 v225, v225
    v_rcp_f32 v226, v226
    v_rcp_f32 v227, v227
    v_rcp_f32 v228, v228
    v_rcp_f32 v229, v229
    v_pk_mul_f32 v[32:33], v[32:33], v[214:215]
    v_pk_mul_f32 v[34:35], v[34:35], v[216:217]
    v_pk_mul_f32 v[40:41], v[40:41], v[218:219]
    v_pk_mul_f32 v[42:43], v[42:43], v[220:221]
    v_pk_mul_f32 v[48:49], v[48:49], v[222:223]
    v_pk_mul_f32 v[50:51], v[50:51], v[224:225]
    v_pk_mul_f32 v[56:57], v[56:57], v[226:227]
    v_pk_mul_f32 v[58:59], v[58:59], v[228:229]
    v_pk_fma_f32 v[36:37], v[156:157], v[204:205], v[36:37] op_sel_hi:[1,0,1] neg_lo:[0,1,0] neg_hi:[0,1,0]
    v_pk_fma_f32 v[38:39], v[158:159], v[204:205], v[38:39] op_sel_hi:[1,0,1] neg_lo:[0,1,0] neg_hi:[0,1,0]
    v_pk_mul_f32 v[36:37], v[36:37], v[204:205] op_sel:[0,1] op_sel_hi:[1,1]
    v_pk_mul_f32 v[38:39], v[38:39], v[204:205] op_sel:[0,1] op_sel_hi:[1,1]
    v_pk_fma_f32 v[44:45], v[156:157], v[206:207], v[44:45] op_sel_hi:[1,0,1] neg_lo:[0,1,0] neg_hi:[0,1,0]
    v_pk_fma_f32 v[46:47], v[158:159], v[206:207], v[46:47] op_sel_hi:[1,0,1] neg_lo:[0,1,0] neg_hi:[0,1,0]
    v_pk_mul_f32 v[44:45], v[44:45], v[206:207] op_sel:[0,1] op_sel_hi:[1,1]
    v_pk_mul_f32 v[46:47], v[46:47], v[206:207] op_sel:[0,1] op_sel_hi:[1,1]
    v_pk_fma_f32 v[52:53], v[156:157], v[208:209], v[52:53] op_sel_hi:[1,0,1] neg_lo:[0,1,0] neg_hi:[0,1,0]
    v_pk_fma_f32 v[54:55], v[158:159], v[208:209], v[54:55] op_sel_hi:[1,0,1] neg_lo:[0,1,0] neg_hi:[0,1,0]
    v_pk_mul_f32 v[52:53], v[52:53], v[208:209] op_sel:[0,1] op_sel_hi:[1,1]
    v_pk_mul_f32 v[54:55], v[54:55], v[208:209] op_sel:[0,1] op_sel_hi:[1,1]
    v_pk_fma_f32 v[60:61], v[156:157], v[210:211], v[60:61] op_sel_hi:[1,0,1] neg_lo:[0,1,0] neg_hi:[0,1,0]
    v_pk_fma_f32 v[62:63], v[158:159], v[210:211], v[62:63] op_sel_hi:[1,0,1] neg_lo:[0,1,0] neg_hi:[0,1,0]
    v_pk_mul_f32 v[60:61], v[60:61], v[210:211] op_sel:[0,1] op_sel_hi:[1,1]
    v_pk_mul_f32 v[62:63], v[62:63], v[210:211] op_sel:[0,1] op_sel_hi:[1,1]
    v_pk_mul_f32 v[214:215], v[36:37], v[36:37]
    v_pk_mul_f32 v[216:217], v[38:39], v[38:39]
    v_pk_mul_f32 v[218:219], v[44:45], v[44:45]
    v_pk_mul_f32 v[220:221], v[46:47], v[46:47]
    v_pk_mul_f32 v[222:223], v[52:53], v[52:53]
    v_pk_mul_f32 v[224:225], v[54:55], v[54:55]
    v_pk_mul_f32 v[226:227], v[60:61], v[60:61]
    v_pk_mul_f32 v[228:229], v[62:63], v[62:63]
    v_pk_fma_f32 v[214:215], v[214:215], v[212:213], v[212:213] op_sel:[0,1,0] op_sel_hi:[1,1,0]
    v_pk_fma_f32 v[216:217], v[216:217], v[212:213], v[212:213] op_sel:[0,1,0] op_sel_hi:[1,1,0]
    v_pk_fma_f32 v[218:219], v[218:219], v[212:213], v[212:213] op_sel:[0,1,0] op_sel_hi:[1,1,0]
    v_pk_fma_f32 v[220:221], v[220:221], v[212:213], v[212:213] op_sel:[0,1,0] op_sel_hi:[1,1,0]
    v_pk_fma_f32 v[222:223], v[222:223], v[212:213], v[212:213] op_sel:[0,1,0] op_sel_hi:[1,1,0]
    v_pk_fma_f32 v[224:225], v[224:225], v[212:213], v[212:213] op_sel:[0,1,0] op_sel_hi:[1,1,0]
    v_pk_fma_f32 v[226:227], v[226:227], v[212:213], v[212:213] op_sel:[0,1,0] op_sel_hi:[1,1,0]
    v_pk_fma_f32 v[228:229], v[228:229], v[212:213], v[212:213] op_sel:[0,1,0] op_sel_hi:[1,1,0]
    v_pk_mul_f32 v[214:215], v[214:215], v[36:37]
    v_pk_mul_f32 v[216:217], v[216:217], v[38:39]
    v_pk_mul_f32 v[218:219], v[218:219], v[44:45]
    v_pk_mul_f32 v[220:221], v[220:221], v[46:47]
    v_pk_mul_f32 v[222:223], v[222:223], v[52:53]
    v_pk_mul_f32 v[224:225], v[224:225], v[54:55]
    v_pk_mul_f32 v[226:227], v[226:227], v[60:61]
    v_pk_mul_f32 v[228:229], v[228:229], v[62:63]
    v_exp_f32 v214, v214
    v_exp_f32 v215, v215
    v_exp_f32 v216, v216
    v_exp_f32 v217, v217
    v_exp_f32 v218, v218
    v_exp_f32 v219, v219
    v_exp_f32 v220, v220
    v_exp_f32 v221, v221
    v_exp_f32 v222, v222
    v_exp_f32 v223, v223
    v_exp_f32 v224, v224
    v_exp_f32 v225, v225
    v_exp_f32 v226, v226
    v_exp_f32 v227, v227
    v_exp_f32 v228, v228
    v_exp_f32 v229, v229
    v_pk_add_f32 v[214:215], v[214:215], 1.0 op_sel_hi:[1,0]
    v_pk_add_f32 v[216:217], v[216:217], 1.0 op_sel_hi:[1,0]
    v_pk_add_f32 v[218:219], v[218:219], 1.0 op_sel_hi:[1,0]
    v_pk_add_f32 v[220:221], v[220:221], 1.0 op_sel_hi:[1,0]
    v_pk_add_f32 v[222:223], v[222:223], 1.0 op_sel_hi:[1,0]
    v_pk_add_f32 v[224:225], v[224:225], 1.0 op_sel_hi:[1,0]
    v_pk_add_f32 v[226:227], v[226:227], 1.0 op_sel_hi:[1,0]
    v_pk_add_f32 v[228:229], v[228:229], 1.0 op_sel_hi:[1,0]
    v_rcp_f32 v214, v214
    v_rcp_f32 v215, v215
    v_rcp_f32 v216, v216
    v_rcp_f32 v217, v217
    v_rcp_f32 v218, v218
    v_rcp_f32 v219, v219
    v_rcp_f32 v220, v220
    v_rcp_f32 v221, v221
    v_rcp_f32 v222, v222
    v_rcp_f32 v223, v223
    v_rcp_f32 v224, v224
    v_rcp_f32 v225, v225
    v_rcp_f32 v226, v226
    v_rcp_f32 v227, v227
    v_rcp_f32 v228, v228
    v_rcp_f32 v229, v229
    v_pk_mul_f32 v[36:37], v[36:37], v[214:215]
    v_pk_mul_f32 v[38:39], v[38:39], v[216:217]
    v_pk_mul_f32 v[44:45], v[44:45], v[218:219]
    v_pk_mul_f32 v[46:47], v[46:47], v[220:221]
    v_pk_mul_f32 v[52:53], v[52:53], v[222:223]
    v_pk_mul_f32 v[54:55], v[54:55], v[224:225]
    v_pk_mul_f32 v[60:61], v[60:61], v[226:227]
    v_pk_mul_f32 v[62:63], v[62:63], v[228:229]
    v_pk_mul_f32 v[216:217], v[32:33], v[32:33]
    v_mov_b32 v214, v32
    v_mov_b32 v215, v33
    v_pk_add_f32 v[214:215], v[214:215], v[34:35]
    v_pk_fma_f32 v[216:217], v[34:35], v[34:35], v[216:217]
    v_pk_add_f32 v[214:215], v[214:215], v[36:37]
    v_pk_fma_f32 v[216:217], v[36:37], v[36:37], v[216:217]
    v_pk_add_f32 v[214:215], v[214:215], v[38:39]
    v_pk_fma_f32 v[216:217], v[38:39], v[38:39], v[216:217]
    v_add_f32 v172, v214, v215
    v_add_f32 v173, v216, v217
    v_pk_mul_f32 v[220:221], v[40:41], v[40:41]
    v_mov_b32 v218, v40
    v_mov_b32 v219, v41
    v_pk_add_f32 v[218:219], v[218:219], v[42:43]
    v_pk_fma_f32 v[220:221], v[42:43], v[42:43], v[220:221]
    v_pk_add_f32 v[218:219], v[218:219], v[44:45]
    v_pk_fma_f32 v[220:221], v[44:45], v[44:45], v[220:221]
    v_pk_add_f32 v[218:219], v[218:219], v[46:47]
    v_pk_fma_f32 v[220:221], v[46:47], v[46:47], v[220:221]
    v_add_f32 v174, v218, v219
    v_add_f32 v175, v220, v221
    v_pk_mul_f32 v[216:217], v[48:49], v[48:49]
    v_mov_b32 v214, v48
    v_mov_b32 v215, v49
    v_pk_add_f32 v[214:215], v[214:215], v[50:51]
    v_pk_fma_f32 v[216:217], v[50:51], v[50:51], v[216:217]
    v_pk_add_f32 v[214:215], v[214:215], v[52:53]
    v_pk_fma_f32 v[216:217], v[52:53], v[52:53], v[216:217]
    v_pk_add_f32 v[214:215], v[214:215], v[54:55]
    v_pk_fma_f32 v[216:217], v[54:55], v[54:55], v[216:217]
    v_add_f32 v176, v214, v215
    v_add_f32 v177, v216, v217
    v_pk_mul_f32 v[220:221], v[56:57], v[56:57]
    v_mov_b32 v218, v56
    v_mov_b32 v219, v57
    v_pk_add_f32 v[218:219], v[218:219], v[58:59]
    v_pk_fma_f32 v[220:221], v[58:59], v[58:59], v[220:221]
    v_pk_add_f32 v[218:219], v[218:219], v[60:61]
    v_pk_fma_f32 v[220:221], v[60:61], v[60:61], v[220:221]
    v_pk_add_f32 v[218:219], v[218:219], v[62:63]
    v_pk_fma_f32 v[220:221], v[62:63], v[62:63], v[220:221]
    v_add_f32 v178, v218, v219
    v_add_f32 v179, v220, v221
    v_mov_b32 v2, v172
    s_nop 1
    v_permlane16_swap_b32 v2, v172
    v_add_f32 v172, v172, v2
    v_mov_b32 v2, v172
    s_nop 1
    v_permlane32_swap_b32 v2, v172
    v_add_f32 v172, v172, v2
    v_mov_b32 v3, v173
    s_nop 1
    v_permlane16_swap_b32 v3, v173
    v_add_f32 v173, v173, v3
    v_mov_b32 v3, v173
    s_nop 1
    v_permlane32_swap_b32 v3, v173
    v_add_f32 v173, v173, v3
    v_mov_b32 v2, v174
    s_nop 1
    v_permlane16_swap_b32 v2, v174
    v_add_f32 v174, v174, v2
    v_mov_b32 v2, v174
    s_nop 1
    v_permlane32_swap_b32 v2, v174
    v_add_f32 v174, v174, v2
    v_mov_b32 v3, v175
    s_nop 1
    v_permlane16_swap_b32 v3, v175
    v_add_f32 v175, v175, v3
    v_mov_b32 v3, v175
    s_nop 1
    v_permlane32_swap_b32 v3, v175
    v_add_f32 v175, v175, v3
    v_mov_b32 v2, v176
    s_nop 1
    v_permlane16_swap_b32 v2, v176
    v_add_f32 v176, v176, v2
    v_mov_b32 v2, v176
    s_nop 1
    v_permlane32_swap_b32 v2, v176
    v_add_f32 v176, v176, v2
    v_mov_b32 v3, v177
    s_nop 1
    v_permlane16_swap_b32 v3, v177
    v_add_f32 v177, v177, v3
    v_mov_b32 v3, v177
    s_nop 1
    v_permlane32_swap_b32 v3, v177
    v_add_f32 v177, v177, v3
    v_mov_b32 v2, v178
    s_nop 1
    v_permlane16_swap_b32 v2, v178
    v_add_f32 v178, v178, v2
    v_mov_b32 v2, v178
    s_nop 1
    v_permlane32_swap_b32 v2, v178
    v_add_f32 v178, v178, v2
    v_mov_b32 v3, v179
    s_nop 1
    v_permlane16_swap_b32 v3, v179
    v_add_f32 v179, v179, v3
    v_mov_b32 v3, v179
    s_nop 1
    v_permlane32_swap_b32 v3, v179
    v_add_f32 v179, v179, v3
    v_lshrrev_b32 v3, 4, v1
    v_cmp_eq_u32 vcc, 1, v3
    s_nop 1
    v_cndmask_b32 v172, v172, v174, vcc
    v_cndmask_b32 v173, v173, v175, vcc
    v_cmp_eq_u32 vcc, 2, v3
    s_nop 1
    v_cndmask_b32 v172, v172, v176, vcc
    v_cndmask_b32 v173, v173, v177, vcc
    v_cmp_eq_u32 vcc, 3, v3
    s_nop 1
    v_cndmask_b32 v172, v172, v178, vcc
    v_cndmask_b32 v173, v173, v179, vcc
    s_lshl_b32 s5, s44, 9
    s_add_u32 s5, s5, 157696
    v_lshlrev_b32 v2, 3, v1
    v_add_u32 v4, s5, v2
    ds_write_b64 v4, v[172:173]
    v_mov_b32 v4, 156680
    v_mov_b32 v3, 1
    s_waitcnt lgkmcnt(0)
    s_mov_b64 exec, 1
    ds_add_rtn_u32 v5, v4, v3
    s_waitcnt lgkmcnt(0)
    v_readfirstlane_b32 s21, v5
    s_mov_b64 exec, -1
    s_nop 1
    s_cmp_lg_u32 s21, 3
    s_cbranch_scc1 zsig_sequential_preLN__grouped_kv_mqa__mixer_gmlp__prompt_kernel_17
    v_add_u32 v4, 157696, v2
    ds_read_b64 v[172:173], v4 offset:0
    ds_read_b64 v[174:175], v4 offset:512
    ds_read_b64 v[176:177], v4 offset:1024
    ds_read_b64 v[178:179], v4 offset:1536
    s_waitcnt lgkmcnt(0)
    v_add_f32 v172, v172, v174
    v_add_f32 v176, v176, v178
    v_add_f32 v172, v172, v176
    v_add_f32 v173, v173, v175
    v_add_f32 v177, v177, v179
    v_add_f32 v173, v173, v177
    s_mul_i32 s5, s76, 7
    s_add_u32 s5, s5, s77
    s_lshl_b32 s5, s5, 9
    buffer_store_dwordx2 v[172:173], v2, s[56:59], s5 offen sc1
zsig_sequential_preLN__grouped_kv_mqa__mixer_gmlp__prompt_kernel_17:
    s_waitcnt lgkmcnt(0)
    v_mfma_f32_16x16x32_bf16 v[64:67], v[128:131], v[96:99], v[64:67]
    ds_read_b128 v[112:115], v145 offset:0
    v_mfma_f32_16x16x32_bf16 v[72:75], v[128:131], v[100:103], v[72:75]
    ds_read_b128 v[116:119], v145 offset:2048
    v_mfma_f32_16x16x32_bf16 v[80:83], v[128:131], v[104:107], v[80:83]
    ds_read_b128 v[120:123], v145 offset:4096
    v_mfma_f32_16x16x32_bf16 v[88:91], v[128:131], v[108:111], v[88:91]
    ds_read_b128 v[124:127], v145 offset:6144
    v_mfma_f32_16x16x32_bf16 v[68:71], v[132:135], v[96:99], v[68:71]
    ds_read_b64_tr_b16 v[136:137], v146 offset:40960
    v_mfma_f32_16x16x32_bf16 v[76:79], v[132:135], v[100:103], v[76:79]
    ds_read_b64_tr_b16 v[138:139], v146 offset:41984
    v_mfma_f32_16x16x32_bf16 v[84:87], v[132:135], v[104:107], v[84:87]
    ds_read_b64_tr_b16 v[140:141], v147 offset:40960
    v_mfma_f32_16x16x32_bf16 v[92:95], v[132:135], v[108:111], v[92:95]
    ds_read_b64_tr_b16 v[142:143], v147 offset:41984
    v_mfma_f32_16x16x32_bf16 v[160:163], v[128:131], v[168:171], v[160:163]
    v_mfma_f32_16x16x32_bf16 v[164:167], v[132:135], v[168:171], v[164:167]
    s_waitcnt lgkmcnt(0)
    s_barrier
    v_mfma_f32_16x16x32_bf16 v[64:67], v[136:139], v[112:115], v[64:67]
    ds_read_b128 v[96:99], v144 offset:8192
    v_mfma_f32_16x16x32_bf16 v[72:75], v[136:139], v[116:119], v[72:75]
    ds_read_b128 v[100:103], v144 offset:10240
    v_mfma_f32_16x16x32_bf16 v[80:83], v[136:139], v[120:123], v[80:83]
    ds_read_b128 v[104:107], v144 offset:12288
    v_mfma_f32_16x16x32_bf16 v[88:91], v[136:139], v[124:127], v[88:91]
    ds_read_b128 v[108:111], v144 offset:14336
    v_mfma_f32_16x16x32_bf16 v[68:71], v[140:143], v[112:115], v[68:71]
    ds_read_b64_tr_b16 v[128:129], v146 offset:49152
    v_mfma_f32_16x16x32_bf16 v[76:79], v[140:143], v[116:119], v[76:79]
    ds_read_b64_tr_b16 v[130:131], v146 offset:50176
    v_mfma_f32_16x16x32_bf16 v[84:87], v[140:143], v[120:123], v[84:87]
    ds_read_b64_tr_b16 v[132:133], v147 offset:49152
    v_mfma_f32_16x16x32_bf16 v[92:95], v[140:143], v[124:127], v[92:95]
    ds_read_b64_tr_b16 v[134:135], v147 offset:50176
    v_mfma_f32_16x16x32_bf16 v[160:163], v[136:139], v[168:171], v[160:163]
    v_mfma_f32_16x16x32_bf16 v[164:167], v[140:143], v[168:171], v[164:167]
    s_waitcnt lgkmcnt(0)
    v_mfma_f32_16x16x32_bf16 v[64:67], v[128:131], v[96:99], v[64:67]
    ds_read_b128 v[112:115], v145 offset:8192
    v_mfma_f32_16x16x32_bf16 v[72:75], v[128:131], v[100:103], v[72:75]
    ds_read_b128 v[116:119], v145 offset:10240
    v_mfma_f32_16x16x32_bf16 v[80:83], v[128:131], v[104:107], v[80:83]
    ds_read_b128 v[120:123], v145 offset:12288
    v_mfma_f32_16x16x32_bf16 v[88:91], v[128:131], v[108:111], v[88:91]
    ds_read_b128 v[124:127], v145 offset:14336
    v_mfma_f32_16x16x32_bf16 v[68:71], v[132:135], v[96:99], v[68:71]
    ds_read_b64_tr_b16 v[136:137], v146 offset:57344
    v_mfma_f32_16x16x32_bf16 v[76:79], v[132:135], v[100:103], v[76:79]
    ds_read_b64_tr_b16 v[138:139], v146 offset:58368
    v_mfma_f32_16x16x32_bf16 v[84:87], v[132:135], v[104:107], v[84:87]
    ds_read_b64_tr_b16 v[140:141], v147 offset:57344
    v_mfma_f32_16x16x32_bf16 v[92:95], v[132:135], v[108:111], v[92:95]
    ds_read_b64_tr_b16 v[142:143], v147 offset:58368
    v_mfma_f32_16x16x32_bf16 v[160:163], v[128:131], v[168:171], v[160:163]
    v_mfma_f32_16x16x32_bf16 v[164:167], v[132:135], v[168:171], v[164:167]
    s_waitcnt lgkmcnt(0)
    s_barrier
    v_mfma_f32_16x16x32_bf16 v[64:67], v[136:139], v[112:115], v[64:67]
    ds_read_b128 v[96:99], v144 offset:16384
    v_mfma_f32_16x16x32_bf16 v[72:75], v[136:139], v[116:119], v[72:75]
    ds_read_b128 v[100:103], v144 offset:18432
    v_mfma_f32_16x16x32_bf16 v[80:83], v[136:139], v[120:123], v[80:83]
    ds_read_b128 v[104:107], v144 offset:20480
    v_mfma_f32_16x16x32_bf16 v[88:91], v[136:139], v[124:127], v[88:91]
    ds_read_b128 v[108:111], v144 offset:22528
    v_mfma_f32_16x16x32_bf16 v[68:71], v[140:143], v[112:115], v[68:71]
    ds_read_b64_tr_b16 v[128:129], v148 offset:0
    v_mfma_f32_16x16x32_bf16 v[76:79], v[140:143], v[116:119], v[76:79]
    ds_read_b64_tr_b16 v[130:131], v148 offset:1024
    v_mfma_f32_16x16x32_bf16 v[84:87], v[140:143], v[120:123], v[84:87]
    ds_read_b64_tr_b16 v[132:133], v149 offset:0
    v_mfma_f32_16x16x32_bf16 v[92:95], v[140:143], v[124:127], v[92:95]
    ds_read_b64_tr_b16 v[134:135], v149 offset:1024
    v_mfma_f32_16x16x32_bf16 v[160:163], v[136:139], v[168:171], v[160:163]
    v_mfma_f32_16x16x32_bf16 v[164:167], v[140:143], v[168:171], v[164:167]
    s_cmp_lg_u32 s21, 3
    s_cbranch_scc1 zflag_sequential_preLN__grouped_kv_mqa__mixer_gmlp__prompt_kernel_18
    s_waitcnt vmcnt(0)
    s_lshl_b32 s4, s77, 2
    s_add_u32 s4, s4, s88
    s_add_u32 s4, s4, 8192
    s_mov_b64 exec, 1
    v_mov_b32 v2, 0
    v_mov_b32 v3, s26
    buffer_store_dword v3, v2, s[72:75], s4 offen sc1
    s_mov_b64 exec, -1
zflag_sequential_preLN__grouped_kv_mqa__mixer_gmlp__prompt_kernel_18:
    s_waitcnt lgkmcnt(0)
    v_mfma_f32_16x16x32_bf16 v[64:67], v[128:131], v[96:99], v[64:67]
    ds_read_b128 v[112:115], v145 offset:16384
    v_mfma_f32_16x16x32_bf16 v[72:75], v[128:131], v[100:103], v[72:75]
    ds_read_b128 v[116:119], v145 offset:18432
    v_mfma_f32_16x16x32_bf16 v[80:83], v[128:131], v[104:107], v[80:83]
    ds_read_b128 v[120:123], v145 offset:20480
    v_mfma_f32_16x16x32_bf16 v[88:91], v[128:131], v[108:111], v[88:91]
    ds_read_b128 v[124:127], v145 offset:22528
    v_mfma_f32_16x16x32_bf16 v[68:71], v[132:135], v[96:99], v[68:71]
    ds_read_b64_tr_b16 v[136:137], v148 offset:8192
    v_mfma_f32_16x16x32_bf16 v[76:79], v[132:135], v[100:103], v[76:79]
    ds_read_b64_tr_b16 v[138:139], v148 offset:9216
    v_mfma_f32_16x16x32_bf16 v[84:87], v[132:135], v[104:107], v[84:87]
    ds_read_b64_tr_b16 v[140:141], v149 offset:8192
    v_mfma_f32_16x16x32_bf16 v[92:95], v[132:135], v[108:111], v[92:95]
    ds_read_b64_tr_b16 v[142:143], v149 offset:9216
    v_mfma_f32_16x16x32_bf16 v[160:163], v[128:131], v[168:171], v[160:163]
    v_mfma_f32_16x16x32_bf16 v[164:167], v[132:135], v[168:171], v[164:167]
    s_waitcnt lgkmcnt(0)
    s_barrier
    v_mfma_f32_16x16x32_bf16 v[64:67], v[136:139], v[112:115], v[64:67]
    ds_read_b128 v[96:99], v144 offset:24576
    v_mfma_f32_16x16x32_bf16 v[72:75], v[136:139], v[116:119], v[72:75]
    ds_read_b128 v[100:103], v144 offset:26624
    v_mfma_f32_16x16x32_bf16 v[80:83], v[136:139], v[120:123], v[80:83]
    ds_read_b128 v[104:107], v144 offset:28672
    v_mfma_f32_16x16x32_bf16 v[88:91], v[136:139], v[124:127], v[88:91]
    ds_read_b128 v[108:111], v144 offset:30720
    v_mfma_f32_16x16x32_bf16 v[68:71], v[140:143], v[112:115], v[68:71]
    ds_read_b64_tr_b16 v[128:129], v146 offset:0
    v_mfma_f32_16x16x32_bf16 v[76:79], v[140:143], v[116:119], v[76:79]
    ds_read_b64_tr_b16 v[130:131], v146 offset:1024
    v_mfma_f32_16x16x32_bf16 v[84:87], v[140:143], v[120:123], v[84:87]
    ds_read_b64_tr_b16 v[132:133], v147 offset:0
    v_mfma_f32_16x16x32_bf16 v[92:95], v[140:143], v[124:127], v[92:95]
    ds_read_b64_tr_b16 v[134:135], v147 offset:1024
    v_mfma_f32_16x16x32_bf16 v[160:163], v[136:139], v[168:171], v[160:163]
    v_mfma_f32_16x16x32_bf16 v[164:167], v[140:143], v[168:171], v[164:167]
    s_waitcnt lgkmcnt(0)
    v_mfma_f32_16x16x32_bf16 v[64:67], v[128:131], v[96:99], v[64:67]
    ds_read_b128 v[112:115], v145 offset:24576
    v_mfma_f32_16x16x32_bf16 v[72:75], v[128:131], v[100:103], v[72:75]
    ds_read_b128 v[116:119], v145 offset:26624
    v_mfma_f32_16x16x32_bf16 v[80:83], v[128:131], v[104:107], v[80:83]
    ds_read_b128 v[120:123], v145 offset:28672
    v_mfma_f32_16x16x32_bf16 v[88:91], v[128:131], v[108:111], v[88:91]
    ds_read_b128 v[124:127], v145 offset:30720
    v_mfma_f32_16x16x32_bf16 v[68:71], v[132:135], v[96:99], v[68:71]
    ds_read_b64_tr_b16 v[136:137], v146 offset:8192
    v_mfma_f32_16x16x32_bf16 v[76:79], v[132:135], v[100:103], v[76:79]
    ds_read_b64_tr_b16 v[138:139], v146 offset:9216
    v_mfma_f32_16x16x32_bf16 v[84:87], v[132:135], v[104:107], v[84:87]
    ds_read_b64_tr_b16 v[140:141], v147 offset:8192
    v_mfma_f32_16x16x32_bf16 v[92:95], v[132:135], v[108:111], v[92:95]
    ds_read_b64_tr_b16 v[142:143], v147 offset:9216
    v_mfma_f32_16x16x32_bf16 v[160:163], v[128:131], v[168:171], v[160:163]
    v_mfma_f32_16x16x32_bf16 v[164:167], v[132:135], v[168:171], v[164:167]
    s_waitcnt lgkmcnt(0)
    s_barrier
    v_mfma_f32_16x16x32_bf16 v[64:67], v[136:139], v[112:115], v[64:67]
    ds_read_b128 v[96:99], v144 offset:32768
    v_mfma_f32_16x16x32_bf16 v[72:75], v[136:139], v[116:119], v[72:75]
    ds_read_b128 v[100:103], v144 offset:34816
    v_mfma_f32_16x16x32_bf16 v[80:83], v[136:139], v[120:123], v[80:83]
    ds_read_b128 v[104:107], v144 offset:36864
    v_mfma_f32_16x16x32_bf16 v[88:91], v[136:139], v[124:127], v[88:91]
    ds_read_b128 v[108:111], v144 offset:38912
    v_mfma_f32_16x16x32_bf16 v[68:71], v[140:143], v[112:115], v[68:71]
    ds_read_b64_tr_b16 v[128:129], v146 offset:16384
    v_mfma_f32_16x16x32_bf16 v[76:79], v[140:143], v[116:119], v[76:79]
    ds_read_b64_tr_b16 v[130:131], v146 offset:17408
    v_mfma_f32_16x16x32_bf16 v[84:87], v[140:143], v[120:123], v[84:87]
    ds_read_b64_tr_b16 v[132:133], v147 offset:16384
    v_mfma_f32_16x16x32_bf16 v[92:95], v[140:143], v[124:127], v[92:95]
    ds_read_b64_tr_b16 v[134:135], v147 offset:17408
    v_mfma_f32_16x16x32_bf16 v[160:163], v[136:139], v[168:171], v[160:163]
    v_mfma_f32_16x16x32_bf16 v[164:167], v[140:143], v[168:171], v[164:167]
    s_waitcnt lgkmcnt(0)
    v_mfma_f32_16x16x32_bf16 v[64:67], v[128:131], v[96:99], v[64:67]
    ds_read_b128 v[112:115], v145 offset:32768
    v_mfma_f32_16x16x32_bf16 v[72:75], v[128:131], v[100:103], v[72:75]
    ds_read_b128 v[116:119], v145 offset:34816
    v_mfma_f32_16x16x32_bf16 v[80:83], v[128:131], v[104:107], v[80:83]
    ds_read_b128 v[120:123], v145 offset:36864
    v_mfma_f32_16x16x32_bf16 v[88:91], v[128:131], v[108:111], v[88:91]
    ds_read_b128 v[124:127], v145 offset:38912
    v_mfma_f32_16x16x32_bf16 v[68:71], v[132:135], v[96:99], v[68:71]
    ds_read_b64_tr_b16 v[136:137], v146 offset:24576
    v_mfma_f32_16x16x32_bf16 v[76:79], v[132:135], v[100:103], v[76:79]
    ds_read_b64_tr_b16 v[138:139], v146 offset:25600
    v_mfma_f32_16x16x32_bf16 v[84:87], v[132:135], v[104:107], v[84:87]
    ds_read_b64_tr_b16 v[140:141], v147 offset:24576
    v_mfma_f32_16x16x32_bf16 v[92:95], v[132:135], v[108:111], v[92:95]
    ds_read_b64_tr_b16 v[142:143], v147 offset:25600
    v_mfma_f32_16x16x32_bf16 v[160:163], v[128:131], v[168:171], v[160:163]
    v_mfma_f32_16x16x32_bf16 v[164:167], v[132:135], v[168:171], v[164:167]
    s_waitcnt lgkmcnt(0)
    s_barrier
    v_mfma_f32_16x16x32_bf16 v[64:67], v[136:139], v[112:115], v[64:67]
    ds_read_b128 v[96:99], v144 offset:40960
    v_mfma_f32_16x16x32_bf16 v[72:75], v[136:139], v[116:119], v[72:75]
    ds_read_b128 v[100:103], v144 offset:43008
    v_mfma_f32_16x16x32_bf16 v[80:83], v[136:139], v[120:123], v[80:83]
    ds_read_b128 v[104:107], v144 offset:45056
    v_mfma_f32_16x16x32_bf16 v[88:91], v[136:139], v[124:127], v[88:91]
    ds_read_b128 v[108:111], v144 offset:47104
    v_mfma_f32_16x16x32_bf16 v[68:71], v[140:143], v[112:115], v[68:71]
    ds_read_b64_tr_b16 v[128:129], v146 offset:32768
    v_mfma_f32_16x16x32_bf16 v[76:79], v[140:143], v[116:119], v[76:79]
    ds_read_b64_tr_b16 v[130:131], v146 offset:33792
    v_mfma_f32_16x16x32_bf16 v[84:87], v[140:143], v[120:123], v[84:87]
    ds_read_b64_tr_b16 v[132:133], v147 offset:32768
    v_mfma_f32_16x16x32_bf16 v[92:95], v[140:143], v[124:127], v[92:95]
    ds_read_b64_tr_b16 v[134:135], v147 offset:33792
    v_mfma_f32_16x16x32_bf16 v[160:163], v[136:139], v[168:171], v[160:163]
    v_mfma_f32_16x16x32_bf16 v[164:167], v[140:143], v[168:171], v[164:167]
    s_waitcnt lgkmcnt(0)
    v_mfma_f32_16x16x32_bf16 v[64:67], v[128:131], v[96:99], v[64:67]
    ds_read_b128 v[112:115], v145 offset:40960
    v_mfma_f32_16x16x32_bf16 v[72:75], v[128:131], v[100:103], v[72:75]
    ds_read_b128 v[116:119], v145 offset:43008
    v_mfma_f32_16x16x32_bf16 v[80:83], v[128:131], v[104:107], v[80:83]
    ds_read_b128 v[120:123], v145 offset:45056
    v_mfma_f32_16x16x32_bf16 v[88:91], v[128:131], v[108:111], v[88:91]
    ds_read_b128 v[124:127], v145 offset:47104
    v_mfma_f32_16x16x32_bf16 v[68:71], v[132:135], v[96:99], v[68:71]
    ds_read_b64_tr_b16 v[136:137], v146 offset:40960
    v_mfma_f32_16x16x32_bf16 v[76:79], v[132:135], v[100:103], v[76:79]
    ds_read_b64_tr_b16 v[138:139], v146 offset:41984
    v_mfma_f32_16x16x32_bf16 v[84:87], v[132:135], v[104:107], v[84:87]
    ds_read_b64_tr_b16 v[140:141], v147 offset:40960
    v_mfma_f32_16x16x32_bf16 v[92:95], v[132:135], v[108:111], v[92:95]
    ds_read_b64_tr_b16 v[142:143], v147 offset:41984
    v_mfma_f32_16x16x32_bf16 v[160:163], v[128:131], v[168:171], v[160:163]
    v_mfma_f32_16x16x32_bf16 v[164:167], v[132:135], v[168:171], v[164:167]
    s_waitcnt lgkmcnt(0)
    s_barrier
    v_mfma_f32_16x16x32_bf16 v[64:67], v[136:139], v[112:115], v[64:67]
    ds_read_b128 v[96:99], v144 offset:49152
    v_mfma_f32_16x16x32_bf16 v[72:75], v[136:139], v[116:119], v[72:75]
    ds_read_b128 v[100:103], v144 offset:51200
    v_mfma_f32_16x16x32_bf16 v[80:83], v[136:139], v[120:123], v[80:83]
    ds_read_b128 v[104:107], v144 offset:53248
    v_mfma_f32_16x16x32_bf16 v[88:91], v[136:139], v[124:127], v[88:91]
    ds_read_b128 v[108:111], v144 offset:55296
    v_mfma_f32_16x16x32_bf16 v[68:71], v[140:143], v[112:115], v[68:71]
    ds_read_b64_tr_b16 v[128:129], v146 offset:49152
    v_mfma_f32_16x16x32_bf16 v[76:79], v[140:143], v[116:119], v[76:79]
    ds_read_b64_tr_b16 v[130:131], v146 offset:50176
    v_mfma_f32_16x16x32_bf16 v[84:87], v[140:143], v[120:123], v[84:87]
    ds_read_b64_tr_b16 v[132:133], v147 offset:49152
    v_mfma_f32_16x16x32_bf16 v[92:95], v[140:143], v[124:127], v[92:95]
    ds_read_b64_tr_b16 v[134:135], v147 offset:50176
    v_mfma_f32_16x16x32_bf16 v[160:163], v[136:139], v[168:171], v[160:163]
    v_mfma_f32_16x16x32_bf16 v[164:167], v[140:143], v[168:171], v[164:167]
    s_add_u32 s4, s88, 8192
    v_lshlrev_b32 v2, 2, v1
    buffer_load_dword v231, v2, s[72:75], s4 offen sc1
    s_waitcnt lgkmcnt(0)
    v_mfma_f32_16x16x32_bf16 v[64:67], v[128:131], v[96:99], v[64:67]
    ds_read_b128 v[112:115], v145 offset:49152
    v_mfma_f32_16x16x32_bf16 v[72:75], v[128:131], v[100:103], v[72:75]
    ds_read_b128 v[116:119], v145 offset:51200
    v_mfma_f32_16x16x32_bf16 v[80:83], v[128:131], v[104:107], v[80:83]
    ds_read_b128 v[120:123], v145 offset:53248
    v_mfma_f32_16x16x32_bf16 v[88:91], v[128:131], v[108:111], v[88:91]
    ds_read_b128 v[124:127], v145 offset:55296
    v_mfma_f32_16x16x32_bf16 v[68:71], v[132:135], v[96:99], v[68:71]
    ds_read_b64_tr_b16 v[136:137], v146 offset:57344
    v_mfma_f32_16x16x32_bf16 v[76:79], v[132:135], v[100:103], v[76:79]
    ds_read_b64_tr_b16 v[138:139], v146 offset:58368
    v_mfma_f32_16x16x32_bf16 v[84:87], v[132:135], v[104:107], v[84:87]
    ds_read_b64_tr_b16 v[140:141], v147 offset:57344
    v_mfma_f32_16x16x32_bf16 v[92:95], v[132:135], v[108:111], v[92:95]
    ds_read_b64_tr_b16 v[142:143], v147 offset:58368
    v_mfma_f32_16x16x32_bf16 v[160:163], v[128:131], v[168:171], v[160:163]
    v_mfma_f32_16x16x32_bf16 v[164:167], v[132:135], v[168:171], v[164:167]
    s_waitcnt lgkmcnt(0)
    s_barrier
    v_mfma_f32_16x16x32_bf16 v[64:67], v[136:139], v[112:115], v[64:67]
    ds_read_b128 v[96:99], v144 offset:57344
    v_mfma_f32_16x16x32_bf16 v[72:75], v[136:139], v[116:119], v[72:75]
    ds_read_b128 v[100:103], v144 offset:59392
    v_mfma_f32_16x16x32_bf16 v[80:83], v[136:139], v[120:123], v[80:83]
    ds_read_b128 v[104:107], v144 offset:61440
    v_mfma_f32_16x16x32_bf16 v[88:91], v[136:139], v[124:127], v[88:91]
    ds_read_b128 v[108:111], v144 offset:63488
    v_mfma_f32_16x16x32_bf16 v[68:71], v[140:143], v[112:115], v[68:71]
    ds_read_b64_tr_b16 v[128:129], v148 offset:0
    v_mfma_f32_16x16x32_bf16 v[76:79], v[140:143], v[116:119], v[76:79]
    ds_read_b64_tr_b16 v[130:131], v148 offset:1024
    v_mfma_f32_16x16x32_bf16 v[84:87], v[140:143], v[120:123], v[84:87]
    ds_read_b64_tr_b16 v[132:133], v149 offset:0
    v_mfma_f32_16x16x32_bf16 v[92:95], v[140:143], v[124:127], v[92:95]
    ds_read_b64_tr_b16 v[134:135], v149 offset:1024
    v_mfma_f32_16x16x32_bf16 v[160:163], v[136:139], v[168:171], v[160:163]
    v_mfma_f32_16x16x32_bf16 v[164:167], v[140:143], v[168:171], v[164:167]
    s_waitcnt vmcnt(0)
    s_mov_b64 exec, 127
    v_cmp_ne_u32 vcc, s26, v231
    s_mov_b64 exec, -1
    s_nop 1
    s_cmp_eq_u64 vcc, 0
    s_cbranch_scc1 zsok_sequential_preLN__grouped_kv_mqa__mixer_gmlp__prompt_kernel_19
    s_add_u32 s4, s88, 8192
    v_lshlrev_b32 v2, 2, v1
    s_mov_b64 exec, 127
    s_mov_b32 s83, 0x40000
poll_sequential_preLN__grouped_kv_mqa__mixer_gmlp__prompt_kernel_20:
    buffer_load_dword v3, v2, s[72:75], s4 offen sc1
    s_waitcnt vmcnt(0)
    v_cmp_ne_u32 vcc, s26, v3
    s_nop 2
    s_cmp_eq_u64 vcc, 0
    s_cbranch_scc1 polld_sequential_preLN__grouped_kv_mqa__mixer_gmlp__prompt_kernel_21
    s_sleep 0
    s_sub_u32 s83, s83, 1
    s_cmp_lg_u32 s83, 0
    s_cbranch_scc1 poll_sequential_preLN__grouped_kv_mqa__mixer_gmlp__prompt_kernel_20
polld_sequential_preLN__grouped_kv_mqa__mixer_gmlp__prompt_kernel_21:
    s_mov_b64 exec, -1
zsok_sequential_preLN__grouped_kv_mqa__mixer_gmlp__prompt_kernel_19:
    v_lshrrev_b32 v2, 4, v1
    v_and_b32 v3, 15, v1
    v_lshlrev_b32 v4, 9, v2
    v_lshl_add_u32 v4, v3, 3, v4
    v_cmp_gt_u32 vcc, 3, v2
    v_mov_b32 v5, 0x7f000000
    s_nop 0
    v_cndmask_b32 v5, v5, v4, vcc
    s_mul_i32 s5, s76, 3584
    buffer_load_dwordx2 v[172:173], v4, s[56:59], s5 offen offset:0 sc1
    buffer_load_dwordx2 v[174:175], v5, s[56:59], s5 offen offset:2048 sc1
    buffer_load_dwordx2 v[180:181], v4, s[56:59], s5 offen offset:128 sc1
    buffer_load_dwordx2 v[182:183], v5, s[56:59], s5 offen offset:2176 sc1
    buffer_load_dwordx2 v[188:189], v4, s[56:59], s5 offen offset:256 sc1
    buffer_load_dwordx2 v[190:191], v5, s[56:59], s5 offen offset:2304 sc1
    buffer_load_dwordx2 v[196:197], v4, s[56:59], s5 offen offset:384 sc1
    buffer_load_dwordx2 v[198:199], v5, s[56:59], s5 offen offset:2432 sc1
    s_waitcnt lgkmcnt(0)
    v_mfma_f32_16x16x32_bf16 v[64:67], v[128:131], v[96:99], v[64:67]
    ds_read_b128 v[112:115], v145 offset:57344
    v_mfma_f32_16x16x32_bf16 v[72:75], v[128:131], v[100:103], v[72:75]
    ds_read_b128 v[116:119], v145 offset:59392
    v_mfma_f32_16x16x32_bf16 v[80:83], v[128:131], v[104:107], v[80:83]
    ds_read_b128 v[120:123], v145 offset:61440
    v_mfma_f32_16x16x32_bf16 v[88:91], v[128:131], v[108:111], v[88:91]
    ds_read_b128 v[124:127], v145 offset:63488
    v_mfma_f32_16x16x32_bf16 v[68:71], v[132:135], v[96:99], v[68:71]
    ds_read_b64_tr_b16 v[136:137], v148 offset:8192
    v_mfma_f32_16x16x32_bf16 v[76:79], v[132:135], v[100:103], v[76:79]
    ds_read_b64_tr_b16 v[138:139], v148 offset:9216
    v_mfma_f32_16x16x32_bf16 v[84:87], v[132:135], v[104:107], v[84:87]
    ds_read_b64_tr_b16 v[140:141], v149 offset:8192
    v_mfma_f32_16x16x32_bf16 v[92:95], v[132:135], v[108:111], v[92:95]
    ds_read_b64_tr_b16 v[142:143], v149 offset:9216
    v_mfma_f32_16x16x32_bf16 v[160:163], v[128:131], v[168:171], v[160:163]
    v_mfma_f32_16x16x32_bf16 v[164:167], v[132:135], v[168:171], v[164:167]
    s_waitcnt lgkmcnt(0)
    v_mfma_f32_16x16x32_bf16 v[64:67], v[136:139], v[112:115], v[64:67]
    v_mfma_f32_16x16x32_bf16 v[72:75], v[136:139], v[116:119], v[72:75]
    v_mfma_f32_16x16x32_bf16 v[80:83], v[136:139], v[120:123], v[80:83]
    v_mfma_f32_16x16x32_bf16 v[88:91], v[136:139], v[124:127], v[88:91]
    v_mfma_f32_16x16x32_bf16 v[68:71], v[140:143], v[112:115], v[68:71]
    v_mfma_f32_16x16x32_bf16 v[76:79], v[140:143], v[116:119], v[76:79]
    v_mfma_f32_16x16x32_bf16 v[84:87], v[140:143], v[120:123], v[84:87]
    v_mfma_f32_16x16x32_bf16 v[92:95], v[140:143], v[124:127], v[92:95]
    v_mfma_f32_16x16x32_bf16 v[160:163], v[136:139], v[168:171], v[160:163]
    v_mfma_f32_16x16x32_bf16 v[164:167], v[140:143], v[168:171], v[164:167]
    s_barrier
    v_lshrrev_b32 v2, 4, v1
    v_and_b32 v3, 15, v1
    s_lshl_b32 s6, s44, 12
    s_add_u32 s6, s6, 98304
    v_lshlrev_b32 v214, 6, v3
    v_lshl_add_u32 v214, v2, 3, v214
    v_add_u32 v214, s6, v214
    v_lshrrev_b32 v215, 2, v3
    v_lshl_add_u32 v215, v2, 3, v215
    v_lshlrev_b32 v215, 6, v215
    v_and_b32 v3, 3, v3
    v_lshl_add_u32 v215, v3, 3, v215
    v_add_u32 v215, s6, v215
    s_waitcnt vmcnt(0)
    v_add_f32 v232, v172, v174
    v_add_f32 v233, v173, v175
    v_mov_b32 v2, v232
    s_nop 1
    v_permlane16_swap_b32 v2, v232
    v_add_f32 v232, v232, v2
    v_mov_b32 v2, v232
    s_nop 1
    v_permlane32_swap_b32 v2, v232
    v_add_f32 v232, v232, v2
    v_mov_b32 v2, v233
    s_nop 1
    v_permlane16_swap_b32 v2, v233
    v_add_f32 v233, v233, v2
    v_mov_b32 v2, v233
    s_nop 1
    v_permlane32_swap_b32 v2, v233
    v_add_f32 v233, v233, v2
    v_mul_f32 v232, 0x3a924925, v232
    v_mul_f32 v233, 0x3a924925, v233
    v_fma_f32 v233, -v232, v232, v233
    v_max_f32 v233, 0, v233
    v_add_f32 v233, s81, v233
    v_rsq_f32 v233, v233
    s_nop 0
    v_pk_add_f32 v[32:33], v[32:33], v[232:233] op_sel_hi:[1,0] neg_lo:[0,1] neg_hi:[0,1]
    v_pk_add_f32 v[34:35], v[34:35], v[232:233] op_sel_hi:[1,0] neg_lo:[0,1] neg_hi:[0,1]
    v_pk_mul_f32 v[32:33], v[32:33], v[232:233] op_sel:[0,1] op_sel_hi:[1,1]
    v_pk_mul_f32 v[34:35], v[34:35], v[232:233] op_sel:[0,1] op_sel_hi:[1,1]
    v_cvt_pk_bf16_f32 v32, v32, v33
    v_cvt_pk_bf16_f32 v33, v34, v35
    ds_write_b64 v214, v[32:33] offset:0
    v_pk_add_f32 v[36:37], v[36:37], v[232:233] op_sel_hi:[1,0] neg_lo:[0,1] neg_hi:[0,1]
    v_pk_add_f32 v[38:39], v[38:39], v[232:233] op_sel_hi:[1,0] neg_lo:[0,1] neg_hi:[0,1]
    v_pk_mul_f32 v[36:37], v[36:37], v[232:233] op_sel:[0,1] op_sel_hi:[1,1]
    v_pk_mul_f32 v[38:39], v[38:39], v[232:233] op_sel:[0,1] op_sel_hi:[1,1]
    v_cvt_pk_bf16_f32 v36, v36, v37
    v_cvt_pk_bf16_f32 v37, v38, v39
    ds_write_b64 v214, v[36:37] offset:32
    v_add_f32 v234, v180, v182
    v_add_f32 v235, v181, v183
    v_mov_b32 v2, v234
    s_nop 1
    v_permlane16_swap_b32 v2, v234
    v_add_f32 v234, v234, v2
    v_mov_b32 v2, v234
    s_nop 1
    v_permlane32_swap_b32 v2, v234
    v_add_f32 v234, v234, v2
    v_mov_b32 v2, v235
    s_nop 1
    v_permlane16_swap_b32 v2, v235
    v_add_f32 v235, v235, v2
    v_mov_b32 v2, v235
    s_nop 1
    v_permlane32_swap_b32 v2, v235
    v_add_f32 v235, v235, v2
    v_mul_f32 v234, 0x3a924925, v234
    v_mul_f32 v235, 0x3a924925, v235
    v_fma_f32 v235, -v234, v234, v235
    v_max_f32 v235, 0, v235
    v_add_f32 v235, s81, v235
    v_rsq_f32 v235, v235
    s_nop 0
    v_pk_add_f32 v[40:41], v[40:41], v[234:235] op_sel_hi:[1,0] neg_lo:[0,1] neg_hi:[0,1]
    v_pk_add_f32 v[42:43], v[42:43], v[234:235] op_sel_hi:[1,0] neg_lo:[0,1] neg_hi:[0,1]
    v_pk_mul_f32 v[40:41], v[40:41], v[234:235] op_sel:[0,1] op_sel_hi:[1,1]
    v_pk_mul_f32 v[42:43], v[42:43], v[234:235] op_sel:[0,1] op_sel_hi:[1,1]
    v_cvt_pk_bf16_f32 v40, v40, v41
    v_cvt_pk_bf16_f32 v41, v42, v43
    ds_write_b64 v214, v[40:41] offset:1024
    v_pk_add_f32 v[44:45], v[44:45], v[234:235] op_sel_hi:[1,0] neg_lo:[0,1] neg_hi:[0,1]
    v_pk_add_f32 v[46:47], v[46:47], v[234:235] op_sel_hi:[1,0] neg_lo:[0,1] neg_hi:[0,1]
    v_pk_mul_f32 v[44:45], v[44:45], v[234:235] op_sel:[0,1] op_sel_hi:[1,1]
    v_pk_mul_f32 v[46:47], v[46:47], v[234:235] op_sel:[0,1] op_sel_hi:[1,1]
    v_cvt_pk_bf16_f32 v44, v44, v45
    v_cvt_pk_bf16_f32 v45, v46, v47
    ds_write_b64 v214, v[44:45] offset:1056
    v_add_f32 v236, v188, v190
    v_add_f32 v237, v189, v191
    v_mov_b32 v2, v236
    s_nop 1
    v_permlane16_swap_b32 v2, v236
    v_add_f32 v236, v236, v2
    v_mov_b32 v2, v236
    s_nop 1
    v_permlane32_swap_b32 v2, v236
    v_add_f32 v236, v236, v2
    v_mov_b32 v2, v237
    s_nop 1
    v_permlane16_swap_b32 v2, v237
    v_add_f32 v237, v237, v2
    v_mov_b32 v2, v237
    s_nop 1
    v_permlane32_swap_b32 v2, v237
    v_add_f32 v237, v237, v2
    v_mul_f32 v236, 0x3a924925, v236
    v_mul_f32 v237, 0x3a924925, v237
    v_fma_f32 v237, -v236, v236, v237
    v_max_f32 v237, 0, v237
    v_add_f32 v237, s81, v237
    v_rsq_f32 v237, v237
    s_nop 0
    v_pk_add_f32 v[48:49], v[48:49], v[236:237] op_sel_hi:[1,0] neg_lo:[0,1] neg_hi:[0,1]
    v_pk_add_f32 v[50:51], v[50:51], v[236:237] op_sel_hi:[1,0] neg_lo:[0,1] neg_hi:[0,1]
    v_pk_mul_f32 v[48:49], v[48:49], v[236:237] op_sel:[0,1] op_sel_hi:[1,1]
    v_pk_mul_f32 v[50:51], v[50:51], v[236:237] op_sel:[0,1] op_sel_hi:[1,1]
    v_cvt_pk_bf16_f32 v48, v48, v49
    v_cvt_pk_bf16_f32 v49, v50, v51
    ds_write_b64 v214, v[48:49] offset:2048
    v_pk_add_f32 v[52:53], v[52:53], v[236:237] op_sel_hi:[1,0] neg_lo:[0,1] neg_hi:[0,1]
    v_pk_add_f32 v[54:55], v[54:55], v[236:237] op_sel_hi:[1,0] neg_lo:[0,1] neg_hi:[0,1]
    v_pk_mul_f32 v[52:53], v[52:53], v[236:237] op_sel:[0,1] op_sel_hi:[1,1]
    v_pk_mul_f32 v[54:55], v[54:55], v[236:237] op_sel:[0,1] op_sel_hi:[1,1]
    v_cvt_pk_bf16_f32 v52, v52, v53
    v_cvt_pk_bf16_f32 v53, v54, v55
    ds_write_b64 v214, v[52:53] offset:2080
    v_add_f32 v238, v196, v198
    v_add_f32 v239, v197, v199
    v_mov_b32 v2, v238
    s_nop 1
    v_permlane16_swap_b32 v2, v238
    v_add_f32 v238, v238, v2
    v_mov_b32 v2, v238
    s_nop 1
    v_permlane32_swap_b32 v2, v238
    v_add_f32 v238, v238, v2
    v_mov_b32 v2, v239
    s_nop 1
    v_permlane16_swap_b32 v2, v239
    v_add_f32 v239, v239, v2
    v_mov_b32 v2, v239
    s_nop 1
    v_permlane32_swap_b32 v2, v239
    v_add_f32 v239, v239, v2
    v_mul_f32 v238, 0x3a924925, v238
    v_mul_f32 v239, 0x3a924925, v239
    v_fma_f32 v239, -v238, v238, v239
    v_max_f32 v239, 0, v239
    v_add_f32 v239, s81, v239
    v_rsq_f32 v239, v239
    s_nop 0
    v_pk_add_f32 v[56:57], v[56:57], v[238:239] op_sel_hi:[1,0] neg_lo:[0,1] neg_hi:[0,1]
    v_pk_add_f32 v[58:59], v[58:59], v[238:239] op_sel_hi:[1,0] neg_lo:[0,1] neg_hi:[0,1]
    v_pk_mul_f32 v[56:57], v[56:57], v[238:239] op_sel:[0,1] op_sel_hi:[1,1]
    v_pk_mul_f32 v[58:59], v[58:59], v[238:239] op_sel:[0,1] op_sel_hi:[1,1]
    v_cvt_pk_bf16_f32 v56, v56, v57
    v_cvt_pk_bf16_f32 v57, v58, v59
    ds_write_b64 v214, v[56:57] offset:3072
    v_pk_add_f32 v[60:61], v[60:61], v[238:239] op_sel_hi:[1,0] neg_lo:[0,1] neg_hi:[0,1]
    v_pk_add_f32 v[62:63], v[62:63], v[238:239] op_sel_hi:[1,0] neg_lo:[0,1] neg_hi:[0,1]
    v_pk_mul_f32 v[60:61], v[60:61], v[238:239] op_sel:[0,1] op_sel_hi:[1,1]
    v_pk_mul_f32 v[62:63], v[62:63], v[238:239] op_sel:[0,1] op_sel_hi:[1,1]
    v_cvt_pk_bf16_f32 v60, v60, v61
    v_cvt_pk_bf16_f32 v61, v62, v63
    ds_write_b64 v214, v[60:61] offset:3104
    s_waitcnt lgkmcnt(0)
    ds_read_b64_tr_b16 v[96:97], v215 offset:0
    ds_read_b64_tr_b16 v[98:99], v215 offset:256
    ds_read_b64_tr_b16 v[100:101], v215 offset:2048
    ds_read_b64_tr_b16 v[102:103], v215 offset:2304
    ds_read_b64_tr_b16 v[104:105], v215 offset:32
    ds_read_b64_tr_b16 v[106:107], v215 offset:288
    ds_read_b64_tr_b16 v[108:109], v215 offset:2080
    ds_read_b64_tr_b16 v[110:111], v215 offset:2336
    s_lshl_b32 s5, s77, 5
    s_add_u32 s5, s5, s76
    s_lshl_b32 s5, s5, 2
    s_add_u32 s5, s5, s44
    s_lshl_b32 s5, s5, 12
    s_waitcnt lgkmcnt(0)
    buffer_store_dwordx4 v[96:99], v6, s[60:63], s5 offen offset:0 sc1
    buffer_store_dwordx4 v[100:103], v6, s[60:63], s5 offen offset:1024 sc1
    buffer_store_dwordx4 v[104:107], v6, s[60:63], s5 offen offset:2048 sc1
    buffer_store_dwordx4 v[108:111], v6, s[60:63], s5 offen offset:3072 sc1
    v_pk_fma_f32 v[64:65], v[160:161], v[204:205], v[64:65] op_sel_hi:[1,0,1] neg_lo:[0,1,0] neg_hi:[0,1,0]
    v_pk_fma_f32 v[66:67], v[162:163], v[204:205], v[66:67] op_sel_hi:[1,0,1] neg_lo:[0,1,0] neg_hi:[0,1,0]
    v_pk_mul_f32 v[64:65], v[64:65], v[204:205] op_sel:[0,1] op_sel_hi:[1,1]
    v_pk_mul_f32 v[66:67], v[66:67], v[204:205] op_sel:[0,1] op_sel_hi:[1,1]
    v_pk_fma_f32 v[72:73], v[160:161], v[206:207], v[72:73] op_sel_hi:[1,0,1] neg_lo:[0,1,0] neg_hi:[0,1,0]
    v_pk_fma_f32 v[74:75], v[162:163], v[206:207], v[74:75] op_sel_hi:[1,0,1] neg_lo:[0,1,0] neg_hi:[0,1,0]
    v_pk_mul_f32 v[72:73], v[72:73], v[206:207] op_sel:[0,1] op_sel_hi:[1,1]
    v_pk_mul_f32 v[74:75], v[74:75], v[206:207] op_sel:[0,1] op_sel_hi:[1,1]
    v_pk_fma_f32 v[80:81], v[160:161], v[208:209], v[80:81] op_sel_hi:[1,0,1] neg_lo:[0,1,0] neg_hi:[0,1,0]
    v_pk_fma_f32 v[82:83], v[162:163], v[208:209], v[82:83] op_sel_hi:[1,0,1] neg_lo:[0,1,0] neg_hi:[0,1,0]
    v_pk_mul_f32 v[80:81], v[80:81], v[208:209] op_sel:[0,1] op_sel_hi:[1,1]
    v_pk_mul_f32 v[82:83], v[82:83], v[208:209] op_sel:[0,1] op_sel_hi:[1,1]
    v_pk_fma_f32 v[88:89], v[160:161], v[210:211], v[88:89] op_sel_hi:[1,0,1] neg_lo:[0,1,0] neg_hi:[0,1,0]
    v_pk_fma_f32 v[90:91], v[162:163], v[210:211], v[90:91] op_sel_hi:[1,0,1] neg_lo:[0,1,0] neg_hi:[0,1,0]
    v_pk_mul_f32 v[88:89], v[88:89], v[210:211] op_sel:[0,1] op_sel_hi:[1,1]
    v_pk_mul_f32 v[90:91], v[90:91], v[210:211] op_sel:[0,1] op_sel_hi:[1,1]
    v_pk_mul_f32 v[214:215], v[64:65], v[64:65]
    v_pk_mul_f32 v[216:217], v[66:67], v[66:67]
    v_pk_mul_f32 v[218:219], v[72:73], v[72:73]
    v_pk_mul_f32 v[220:221], v[74:75], v[74:75]
    v_pk_mul_f32 v[222:223], v[80:81], v[80:81]
    v_pk_mul_f32 v[224:225], v[82:83], v[82:83]
    v_pk_mul_f32 v[226:227], v[88:89], v[88:89]
    v_pk_mul_f32 v[228:229], v[90:91], v[90:91]
    v_pk_fma_f32 v[214:215], v[214:215], v[212:213], v[212:213] op_sel:[0,1,0] op_sel_hi:[1,1,0]
    v_pk_fma_f32 v[216:217], v[216:217], v[212:213], v[212:213] op_sel:[0,1,0] op_sel_hi:[1,1,0]
    v_pk_fma_f32 v[218:219], v[218:219], v[212:213], v[212:213] op_sel:[0,1,0] op_sel_hi:[1,1,0]
    v_pk_fma_f32 v[220:221], v[220:221], v[212:213], v[212:213] op_sel:[0,1,0] op_sel_hi:[1,1,0]
    v_pk_fma_f32 v[222:223], v[222:223], v[212:213], v[212:213] op_sel:[0,1,0] op_sel_hi:[1,1,0]
    v_pk_fma_f32 v[224:225], v[224:225], v[212:213], v[212:213] op_sel:[0,1,0] op_sel_hi:[1,1,0]
    v_pk_fma_f32 v[226:227], v[226:227], v[212:213], v[212:213] op_sel:[0,1,0] op_sel_hi:[1,1,0]
    v_pk_fma_f32 v[228:229], v[228:229], v[212:213], v[212:213] op_sel:[0,1,0] op_sel_hi:[1,1,0]
    v_pk_mul_f32 v[214:215], v[214:215], v[64:65]
    v_pk_mul_f32 v[216:217], v[216:217], v[66:67]
    v_pk_mul_f32 v[218:219], v[218:219], v[72:73]
    v_pk_mul_f32 v[220:221], v[220:221], v[74:75]
    v_pk_mul_f32 v[222:223], v[222:223], v[80:81]
    v_pk_mul_f32 v[224:225], v[224:225], v[82:83]
    v_pk_mul_f32 v[226:227], v[226:227], v[88:89]
    v_pk_mul_f32 v[228:229], v[228:229], v[90:91]
    v_exp_f32 v214, v214
    v_exp_f32 v215, v215
    v_exp_f32 v216, v216
    v_exp_f32 v217, v217
    v_exp_f32 v218, v218
    v_exp_f32 v219, v219
    v_exp_f32 v220, v220
    v_exp_f32 v221, v221
    v_exp_f32 v222, v222
    v_exp_f32 v223, v223
    v_exp_f32 v224, v224
    v_exp_f32 v225, v225
    v_exp_f32 v226, v226
    v_exp_f32 v227, v227
    v_exp_f32 v228, v228
    v_exp_f32 v229, v229
    v_pk_add_f32 v[214:215], v[214:215], 1.0 op_sel_hi:[1,0]
    v_pk_add_f32 v[216:217], v[216:217], 1.0 op_sel_hi:[1,0]
    v_pk_add_f32 v[218:219], v[218:219], 1.0 op_sel_hi:[1,0]
    v_pk_add_f32 v[220:221], v[220:221], 1.0 op_sel_hi:[1,0]
    v_pk_add_f32 v[222:223], v[222:223], 1.0 op_sel_hi:[1,0]
    v_pk_add_f32 v[224:225], v[224:225], 1.0 op_sel_hi:[1,0]
    v_pk_add_f32 v[226:227], v[226:227], 1.0 op_sel_hi:[1,0]
    v_pk_add_f32 v[228:229], v[228:229], 1.0 op_sel_hi:[1,0]
    v_rcp_f32 v214, v214
    v_rcp_f32 v215, v215
    v_rcp_f32 v216, v216
    v_rcp_f32 v217, v217
    v_rcp_f32 v218, v218
    v_rcp_f32 v219, v219
    v_rcp_f32 v220, v220
    v_rcp_f32 v221, v221
    v_rcp_f32 v222, v222
    v_rcp_f32 v223, v223
    v_rcp_f32 v224, v224
    v_rcp_f32 v225, v225
    v_rcp_f32 v226, v226
    v_rcp_f32 v227, v227
    v_rcp_f32 v228, v228
    v_rcp_f32 v229, v229
    v_pk_mul_f32 v[64:65], v[64:65], v[214:215]
    v_pk_mul_f32 v[66:67], v[66:67], v[216:217]
    v_pk_mul_f32 v[72:73], v[72:73], v[218:219]
    v_pk_mul_f32 v[74:75], v[74:75], v[220:221]
    v_pk_mul_f32 v[80:81], v[80:81], v[222:223]
    v_pk_mul_f32 v[82:83], v[82:83], v[224:225]
    v_pk_mul_f32 v[88:89], v[88:89], v[226:227]
    v_pk_mul_f32 v[90:91], v[90:91], v[228:229]
    v_pk_fma_f32 v[68:69], v[164:165], v[204:205], v[68:69] op_sel_hi:[1,0,1] neg_lo:[0,1,0] neg_hi:[0,1,0]
    v_pk_fma_f32 v[70:71], v[166:167], v[204:205], v[70:71] op_sel_hi:[1,0,1] neg_lo:[0,1,0] neg_hi:[0,1,0]
    v_pk_mul_f32 v[68:69], v[68:69], v[204:205] op_sel:[0,1] op_sel_hi:[1,1]
    v_pk_mul_f32 v[70:71], v[70:71], v[204:205] op_sel:[0,1] op_sel_hi:[1,1]
    v_pk_fma_f32 v[76:77], v[164:165], v[206:207], v[76:77] op_sel_hi:[1,0,1] neg_lo:[0,1,0] neg_hi:[0,1,0]
    v_pk_fma_f32 v[78:79], v[166:167], v[206:207], v[78:79] op_sel_hi:[1,0,1] neg_lo:[0,1,0] neg_hi:[0,1,0]
    v_pk_mul_f32 v[76:77], v[76:77], v[206:207] op_sel:[0,1] op_sel_hi:[1,1]
    v_pk_mul_f32 v[78:79], v[78:79], v[206:207] op_sel:[0,1] op_sel_hi:[1,1]
    v_pk_fma_f32 v[84:85], v[164:165], v[208:209], v[84:85] op_sel_hi:[1,0,1] neg_lo:[0,1,0] neg_hi:[0,1,0]
    v_pk_fma_f32 v[86:87], v[166:167], v[208:209], v[86:87] op_sel_hi:[1,0,1] neg_lo:[0,1,0] neg_hi:[0,1,0]
    v_pk_mul_f32 v[84:85], v[84:85], v[208:209] op_sel:[0,1] op_sel_hi:[1,1]
    v_pk_mul_f32 v[86:87], v[86:87], v[208:209] op_sel:[0,1] op_sel_hi:[1,1]
    v_pk_fma_f32 v[92:93], v[164:165], v[210:211], v[92:93] op_sel_hi:[1,0,1] neg_lo:[0,1,0] neg_hi:[0,1,0]
    v_pk_fma_f32 v[94:95], v[166:167], v[210:211], v[94:95] op_sel_hi:[1,0,1] neg_lo:[0,1,0] neg_hi:[0,1,0]
    v_pk_mul_f32 v[92:93], v[92:93], v[210:211] op_sel:[0,1] op_sel_hi:[1,1]
    v_pk_mul_f32 v[94:95], v[94:95], v[210:211] op_sel:[0,1] op_sel_hi:[1,1]
    v_pk_mul_f32 v[214:215], v[68:69], v[68:69]
    v_pk_mul_f32 v[216:217], v[70:71], v[70:71]
    v_pk_mul_f32 v[218:219], v[76:77], v[76:77]
    v_pk_mul_f32 v[220:221], v[78:79], v[78:79]
    v_pk_mul_f32 v[222:223], v[84:85], v[84:85]
    v_pk_mul_f32 v[224:225], v[86:87], v[86:87]
    v_pk_mul_f32 v[226:227], v[92:93], v[92:93]
    v_pk_mul_f32 v[228:229], v[94:95], v[94:95]
    v_pk_fma_f32 v[214:215], v[214:215], v[212:213], v[212:213] op_sel:[0,1,0] op_sel_hi:[1,1,0]
    v_pk_fma_f32 v[216:217], v[216:217], v[212:213], v[212:213] op_sel:[0,1,0] op_sel_hi:[1,1,0]
    v_pk_fma_f32 v[218:219], v[218:219], v[212:213], v[212:213] op_sel:[0,1,0] op_sel_hi:[1,1,0]
    v_pk_fma_f32 v[220:221], v[220:221], v[212:213], v[212:213] op_sel:[0,1,0] op_sel_hi:[1,1,0]
    v_pk_fma_f32 v[222:223], v[222:223], v[212:213], v[212:213] op_sel:[0,1,0] op_sel_hi:[1,1,0]
    v_pk_fma_f32 v[224:225], v[224:225], v[212:213], v[212:213] op_sel:[0,1,0] op_sel_hi:[1,1,0]
    v_pk_fma_f32 v[226:227], v[226:227], v[212:213], v[212:213] op_sel:[0,1,0] op_sel_hi:[1,1,0]
    v_pk_fma_f32 v[228:229], v[228:229], v[212:213], v[212:213] op_sel:[0,1,0] op_sel_hi:[1,1,0]
    v_pk_mul_f32 v[214:215], v[214:215], v[68:69]
    v_pk_mul_f32 v[216:217], v[216:217], v[70:71]
    v_pk_mul_f32 v[218:219], v[218:219], v[76:77]
    v_pk_mul_f32 v[220:221], v[220:221], v[78:79]
    v_pk_mul_f32 v[222:223], v[222:223], v[84:85]
    v_pk_mul_f32 v[224:225], v[224:225], v[86:87]
    v_pk_mul_f32 v[226:227], v[226:227], v[92:93]
    v_pk_mul_f32 v[228:229], v[228:229], v[94:95]
    v_exp_f32 v214, v214
    v_exp_f32 v215, v215
    v_exp_f32 v216, v216
    v_exp_f32 v217, v217
    v_exp_f32 v218, v218
    v_exp_f32 v219, v219
    v_exp_f32 v220, v220
    v_exp_f32 v221, v221
    v_exp_f32 v222, v222
    v_exp_f32 v223, v223
    v_exp_f32 v224, v224
    v_exp_f32 v225, v225
    v_exp_f32 v226, v226
    v_exp_f32 v227, v227
    v_exp_f32 v228, v228
    v_exp_f32 v229, v229
    v_pk_add_f32 v[214:215], v[214:215], 1.0 op_sel_hi:[1,0]
    v_pk_add_f32 v[216:217], v[216:217], 1.0 op_sel_hi:[1,0]
    v_pk_add_f32 v[218:219], v[218:219], 1.0 op_sel_hi:[1,0]
    v_pk_add_f32 v[220:221], v[220:221], 1.0 op_sel_hi:[1,0]
    v_pk_add_f32 v[222:223], v[222:223], 1.0 op_sel_hi:[1,0]
    v_pk_add_f32 v[224:225], v[224:225], 1.0 op_sel_hi:[1,0]
    v_pk_add_f32 v[226:227], v[226:227], 1.0 op_sel_hi:[1,0]
    v_pk_add_f32 v[228:229], v[228:229], 1.0 op_sel_hi:[1,0]
    v_rcp_f32 v214, v214
    v_rcp_f32 v215, v215
    v_rcp_f32 v216, v216
    v_rcp_f32 v217, v217
    v_rcp_f32 v218, v218
    v_rcp_f32 v219, v219
    v_rcp_f32 v220, v220
    v_rcp_f32 v221, v221
    v_rcp_f32 v222, v222
    v_rcp_f32 v223, v223
    v_rcp_f32 v224, v224
    v_rcp_f32 v225, v225
    v_rcp_f32 v226, v226
    v_rcp_f32 v227, v227
    v_rcp_f32 v228, v228
    v_rcp_f32 v229, v229
    v_pk_mul_f32 v[68:69], v[68:69], v[214:215]
    v_pk_mul_f32 v[70:71], v[70:71], v[216:217]
    v_pk_mul_f32 v[76:77], v[76:77], v[218:219]
    v_pk_mul_f32 v[78:79], v[78:79], v[220:221]
    v_pk_mul_f32 v[84:85], v[84:85], v[222:223]
    v_pk_mul_f32 v[86:87], v[86:87], v[224:225]
    v_pk_mul_f32 v[92:93], v[92:93], v[226:227]
    v_pk_mul_f32 v[94:95], v[94:95], v[228:229]
    v_cvt_pk_bf16_f32 v16, v64, v65
    v_cvt_pk_bf16_f32 v17, v66, v67
    v_cvt_pk_bf16_f32 v18, v68, v69
    v_cvt_pk_bf16_f32 v19, v70, v71
    v_cvt_pk_bf16_f32 v20, v72, v73
    v_cvt_pk_bf16_f32 v21, v74, v75
    v_cvt_pk_bf16_f32 v22, v76, v77
    v_cvt_pk_bf16_f32 v23, v78, v79
    v_cvt_pk_bf16_f32 v24, v80, v81
    v_cvt_pk_bf16_f32 v25, v82, v83
    v_cvt_pk_bf16_f32 v26, v84, v85
    v_cvt_pk_bf16_f32 v27, v86, v87
    v_cvt_pk_bf16_f32 v28, v88, v89
    v_cvt_pk_bf16_f32 v29, v90, v91
    v_cvt_pk_bf16_f32 v30, v92, v93
    v_cvt_pk_bf16_f32 v31, v94, v95
    s_waitcnt vmcnt(0)
    s_mov_b64 exec, 1
    v_mov_b32 v2, 156684
    v_mov_b32 v3, 1
    ds_add_rtn_u32 v4, v2, v3
    s_waitcnt lgkmcnt(0)
    v_readfirstlane_b32 s4, v4
    s_nop 2
    s_cmp_lg_u32 s4, 3
    s_cbranch_scc1 sig_sequential_preLN__grouped_kv_mqa__mixer_gmlp__prompt_kernel_22
    s_lshl_b32 s4, s77, 2
    s_add_u32 s4, s4, s88
    s_add_u32 s4, s4, 12288
    v_mov_b32 v2, 0
    v_mov_b32 v3, s26
    buffer_store_dword v3, v2, s[72:75], s4 offen sc1
sig_sequential_preLN__grouped_kv_mqa__mixer_gmlp__prompt_kernel_22:
    s_mov_b64 exec, -1
    v_and_b32 v2, 15, v1
    v_lshrrev_b32 v3, 4, v1
    v_lshrrev_b32 v4, 1, v2
    s_mov_b32 s5, 0
    v_add_u32 v5, 0, v3
    v_xor_b32 v5, v5, v4
    v_lshlrev_b32 v5, 4, v5
    v_lshl_add_u32 v5, v2, 7, v5
    v_add_u32 v5, s5, v5
    v_add_u32 v208, 0, v5
    v_add_u32 v5, 4, v3
    v_xor_b32 v5, v5, v4
    v_lshlrev_b32 v5, 4, v5
    v_lshl_add_u32 v5, v2, 7, v5
    v_add_u32 v5, s5, v5
    v_add_u32 v209, 0, v5
    v_lshrrev_b32 v4, 2, v2
    v_and_b32 v2, 3, v2
    v_lshl_add_u32 v5, v3, 3, v4
    v_lshlrev_b32 v5, 8, v5
    v_lshl_add_u32 v5, v2, 3, v5
    v_and_b32 v3, 1, v3
    v_lshl_or_b32 v4, v3, 2, v4
    v_mov_b32 v32, 0
    v_mov_b32 v33, 0
    v_mov_b32 v34, 0
    v_mov_b32 v35, 0
    v_mov_b32 v36, 0
    v_mov_b32 v37, 0
    v_mov_b32 v38, 0
    v_mov_b32 v39, 0
    v_mov_b32 v40, 0
    v_mov_b32 v41, 0
    v_mov_b32 v42, 0
    v_mov_b32 v43, 0
    v_mov_b32 v44, 0
    v_mov_b32 v45, 0
    v_mov_b32 v46, 0
    v_mov_b32 v47, 0
    v_mov_b32 v48, 0
    v_mov_b32 v49, 0
    v_mov_b32 v50, 0
    v_mov_b32 v51, 0
    v_mov_b32 v52, 0
    v_mov_b32 v53, 0
    v_mov_b32 v54, 0
    v_mov_b32 v55, 0
    v_mov_b32 v56, 0
    v_mov_b32 v57, 0
    v_mov_b32 v58, 0
    v_mov_b32 v59, 0
    v_mov_b32 v60, 0
    v_mov_b32 v61, 0
    v_mov_b32 v62, 0
    v_mov_b32 v63, 0
    v_and_b32 v2, 15, v1
    v_add_u32 v2, s78, v2
    v_lshlrev_b32 v2, 1, v2
    s_mov_b32 s56, s32
    s_mov_b32 s57, s33
    s_mov_b32 s58, 4096
    s_mov_b32 s59, 0x00020000
    buffer_load_ushort v210, v2, s[56:59], 0 offen offset:0
    buffer_load_ushort v211, v2, s[56:59], 0 offen offset:32
    buffer_load_ushort v212, v2, s[56:59], 0 offen offset:64
    buffer_load_ushort v213, v2, s[56:59], 0 offen offset:96
    s_add_u32 s64, s40, 20971520
    s_addc_u32 s65, s41, 0
    s_mov_b32 s66, 3670016
    s_mov_b32 s67, 0x00020000
    s_lshl_b32 s20, s77, 19
    s_lshl_b32 s5, s44, 12
    s_add_u32 s20, s20, s5
    s_and_b32 s27, s76, 7
    s_lshl_b32 s27, s27, 0
    v_and_b32 v2, 15, v1
    v_add_u32 v2, s78, v2
    v_mul_u32_u24 v2, 1792, v2
    v_bfe_u32 v3, v1, 4, 1
    v_lshl_add_u32 v2, v3, 5, v2
    v_lshrrev_b32 v3, 5, v1
    v_lshl_add_u32 v214, v3, 4, v2
    v_add_u32 v215, 28672, v214
    s_cmp_lg_u32 s44, 0
    s_cbranch_scc1 rel_sequential_preLN__grouped_kv_mqa__mixer_gmlp__prompt_kernel_23
    v_lshlrev_b32 v2, 7, v1
    s_lshl_b32 s4, s77, 2
    s_add_u32 s4, s4, 12288
    s_mov_b64 exec, 0xffffffff
    s_mov_b32 s83, 0x40000
pollc_sequential_preLN__grouped_kv_mqa__mixer_gmlp__prompt_kernel_24:
    buffer_load_dword v3, v2, s[72:75], s4 offen sc1
    s_waitcnt vmcnt(0)
    v_cmp_ne_u32 vcc, s26, v3
    s_nop 2
    s_cmp_eq_u64 vcc, 0
    s_cbranch_scc1 pollcd_sequential_preLN__grouped_kv_mqa__mixer_gmlp__prompt_kernel_25
    s_sleep 0
    s_sub_u32 s83, s83, 1
    s_cmp_lg_u32 s83, 0
    s_cbranch_scc1 pollc_sequential_preLN__grouped_kv_mqa__mixer_gmlp__prompt_kernel_24
pollcd_sequential_preLN__grouped_kv_mqa__mixer_gmlp__prompt_kernel_25:
    s_mov_b64 exec, -1
rel_sequential_preLN__grouped_kv_mqa__mixer_gmlp__prompt_kernel_23:
    s_barrier
    s_waitcnt vmcnt(0)
    s_add_u32 s21, s27, 0
    s_and_b32 s21, s21, 31
    s_lshl_b32 s21, s21, 14
    s_add_u32 s21, s21, s20
    buffer_load_dwordx4 v[128:131], v6, s[60:63], s21 offen offset:0 sc1
    buffer_load_dwordx4 v[132:135], v6, s[60:63], s21 offen offset:1024 sc1
    buffer_load_dwordx4 v[136:139], v6, s[60:63], s21 offen offset:2048 sc1
    buffer_load_dwordx4 v[140:143], v6, s[60:63], s21 offen offset:3072 sc1
    s_add_u32 s21, s27, 1
    s_and_b32 s21, s21, 31
    s_lshl_b32 s21, s21, 14
    s_add_u32 s21, s21, s20
    buffer_load_dwordx4 v[144:147], v6, s[60:63], s21 offen offset:0 sc1
    buffer_load_dwordx4 v[148:151], v6, s[60:63], s21 offen offset:1024 sc1
    buffer_load_dwordx4 v[152:155], v6, s[60:63], s21 offen offset:2048 sc1
    buffer_load_dwordx4 v[156:159], v6, s[60:63], s21 offen offset:3072 sc1
    s_add_u32 s21, s27, 2
    s_and_b32 s21, s21, 31
    s_lshl_b32 s21, s21, 14
    s_add_u32 s21, s21, s20
    buffer_load_dwordx4 v[160:163], v6, s[60:63], s21 offen offset:0 sc1
    buffer_load_dwordx4 v[164:167], v6, s[60:63], s21 offen offset:1024 sc1
    buffer_load_dwordx4 v[168:171], v6, s[60:63], s21 offen offset:2048 sc1
    buffer_load_dwordx4 v[172:175], v6, s[60:63], s21 offen offset:3072 sc1
    s_add_u32 s21, s27, 3
    s_and_b32 s21, s21, 31
    s_lshl_b32 s21, s21, 14
    s_add_u32 s21, s21, s20
    buffer_load_dwordx4 v[176:179], v6, s[60:63], s21 offen offset:0 sc1
    buffer_load_dwordx4 v[180:183], v6, s[60:63], s21 offen offset:1024 sc1
    buffer_load_dwordx4 v[184:187], v6, s[60:63], s21 offen offset:2048 sc1
    buffer_load_dwordx4 v[188:191], v6, s[60:63], s21 offen offset:3072 sc1
    s_barrier
    ds_read_b128 v[64:67], v208 offset:0
    ds_read_b128 v[68:71], v208 offset:2048
    ds_read_b128 v[72:75], v208 offset:4096
    ds_read_b128 v[76:79], v208 offset:6144
    ds_read_b128 v[80:83], v209 offset:0
    ds_read_b128 v[84:87], v209 offset:2048
    ds_read_b128 v[88:91], v209 offset:4096
    ds_read_b128 v[92:95], v209 offset:6144
    s_waitcnt lgkmcnt(0)
    s_barrier
    s_waitcnt vmcnt(12)
    s_add_u32 s21, s27, 4
    s_and_b32 s21, s21, 31
    s_lshl_b32 s21, s21, 14
    s_add_u32 s21, s21, s20
    v_mfma_f32_16x16x32_bf16 v[32:35], v[128:131], v[64:67], v[32:35]
    ds_read_b128 v[96:99], v208 offset:8192
    v_mfma_f32_16x16x32_bf16 v[40:43], v[128:131], v[68:71], v[40:43]
    ds_read_b128 v[100:103], v208 offset:10240
    v_mfma_f32_16x16x32_bf16 v[48:51], v[128:131], v[72:75], v[48:51]
    ds_read_b128 v[104:107], v208 offset:12288
    v_mfma_f32_16x16x32_bf16 v[56:59], v[128:131], v[76:79], v[56:59]
    buffer_load_dwordx4 v[192:195], v6, s[60:63], s21 offen offset:0 sc1
    v_mfma_f32_16x16x32_bf16 v[36:39], v[136:139], v[64:67], v[36:39]
    ds_read_b128 v[108:111], v208 offset:14336
    v_mfma_f32_16x16x32_bf16 v[44:47], v[136:139], v[68:71], v[44:47]
    ds_read_b128 v[112:115], v209 offset:8192
    v_mfma_f32_16x16x32_bf16 v[52:55], v[136:139], v[72:75], v[52:55]
    ds_read_b128 v[116:119], v209 offset:10240
    v_mfma_f32_16x16x32_bf16 v[60:63], v[136:139], v[76:79], v[60:63]
    buffer_load_dwordx4 v[196:199], v6, s[60:63], s21 offen offset:1024 sc1
    v_mfma_f32_16x16x32_bf16 v[32:35], v[132:135], v[80:83], v[32:35]
    ds_read_b128 v[120:123], v209 offset:12288
    v_mfma_f32_16x16x32_bf16 v[40:43], v[132:135], v[84:87], v[40:43]
    ds_read_b128 v[124:127], v209 offset:14336
    v_mfma_f32_16x16x32_bf16 v[48:51], v[132:135], v[88:91], v[48:51]
    v_mfma_f32_16x16x32_bf16 v[56:59], v[132:135], v[92:95], v[56:59]
    buffer_load_dwordx4 v[200:203], v6, s[60:63], s21 offen offset:2048 sc1
    v_mfma_f32_16x16x32_bf16 v[36:39], v[140:143], v[80:83], v[36:39]
    v_mfma_f32_16x16x32_bf16 v[44:47], v[140:143], v[84:87], v[44:47]
    v_mfma_f32_16x16x32_bf16 v[52:55], v[140:143], v[88:91], v[52:55]
    v_mfma_f32_16x16x32_bf16 v[60:63], v[140:143], v[92:95], v[60:63]
    buffer_load_dwordx4 v[204:207], v6, s[60:63], s21 offen offset:3072 sc1
    s_waitcnt lgkmcnt(0)
    s_waitcnt vmcnt(12)
    s_add_u32 s21, s27, 5
    s_and_b32 s21, s21, 31
    s_lshl_b32 s21, s21, 14
    s_add_u32 s21, s21, s20
    v_mfma_f32_16x16x32_bf16 v[32:35], v[144:147], v[96:99], v[32:35]
    ds_read_b128 v[64:67], v208 offset:16384
    v_mfma_f32_16x16x32_bf16 v[40:43], v[144:147], v[100:103], v[40:43]
    ds_read_b128 v[68:71], v208 offset:18432
    v_mfma_f32_16x16x32_bf16 v[48:51], v[144:147], v[104:107], v[48:51]
    ds_read_b128 v[72:75], v208 offset:20480
    v_mfma_f32_16x16x32_bf16 v[56:59], v[144:147], v[108:111], v[56:59]
    buffer_load_dwordx4 v[128:131], v6, s[60:63], s21 offen offset:0 sc1
    v_mfma_f32_16x16x32_bf16 v[36:39], v[152:155], v[96:99], v[36:39]
    ds_read_b128 v[76:79], v208 offset:22528
    v_mfma_f32_16x16x32_bf16 v[44:47], v[152:155], v[100:103], v[44:47]
    ds_read_b128 v[80:83], v209 offset:16384
    v_mfma_f32_16x16x32_bf16 v[52:55], v[152:155], v[104:107], v[52:55]
    ds_read_b128 v[84:87], v209 offset:18432
    v_mfma_f32_16x16x32_bf16 v[60:63], v[152:155], v[108:111], v[60:63]
    buffer_load_dwordx4 v[132:135], v6, s[60:63], s21 offen offset:1024 sc1
    v_mfma_f32_16x16x32_bf16 v[32:35], v[148:151], v[112:115], v[32:35]
    ds_read_b128 v[88:91], v209 offset:20480
    v_mfma_f32_16x16x32_bf16 v[40:43], v[148:151], v[116:119], v[40:43]
    ds_read_b128 v[92:95], v209 offset:22528
    v_mfma_f32_16x16x32_bf16 v[48:51], v[148:151], v[120:123], v[48:51]
    v_mfma_f32_16x16x32_bf16 v[56:59], v[148:151], v[124:127], v[56:59]
    buffer_load_dwordx4 v[136:139], v6, s[60:63], s21 offen offset:2048 sc1
    v_mfma_f32_16x16x32_bf16 v[36:39], v[156:159], v[112:115], v[36:39]
    v_mfma_f32_16x16x32_bf16 v[44:47], v[156:159], v[116:119], v[44:47]
    v_mfma_f32_16x16x32_bf16 v[52:55], v[156:159], v[120:123], v[52:55]
    v_mfma_f32_16x16x32_bf16 v[60:63], v[156:159], v[124:127], v[60:63]
    buffer_load_dwordx4 v[140:143], v6, s[60:63], s21 offen offset:3072 sc1
    s_waitcnt lgkmcnt(0)
    s_barrier
    s_waitcnt vmcnt(12)
    s_add_u32 s21, s27, 6
    s_and_b32 s21, s21, 31
    s_lshl_b32 s21, s21, 14
    s_add_u32 s21, s21, s20
    v_mfma_f32_16x16x32_bf16 v[32:35], v[160:163], v[64:67], v[32:35]
    ds_read_b128 v[96:99], v208 offset:24576
    v_mfma_f32_16x16x32_bf16 v[40:43], v[160:163], v[68:71], v[40:43]
    ds_read_b128 v[100:103], v208 offset:26624
    v_mfma_f32_16x16x32_bf16 v[48:51], v[160:163], v[72:75], v[48:51]
    ds_read_b128 v[104:107], v208 offset:28672
    v_mfma_f32_16x16x32_bf16 v[56:59], v[160:163], v[76:79], v[56:59]
    buffer_load_dwordx4 v[144:147], v6, s[60:63], s21 offen offset:0 sc1
    v_mfma_f32_16x16x32_bf16 v[36:39], v[168:171], v[64:67], v[36:39]
    ds_read_b128 v[108:111], v208 offset:30720
    v_mfma_f32_16x16x32_bf16 v[44:47], v[168:171], v[68:71], v[44:47]
    ds_read_b128 v[112:115], v209 offset:24576
    v_mfma_f32_16x16x32_bf16 v[52:55], v[168:171], v[72:75], v[52:55]
    ds_read_b128 v[116:119], v209 offset:26624
    v_mfma_f32_16x16x32_bf16 v[60:63], v[168:171], v[76:79], v[60:63]
    buffer_load_dwordx4 v[148:151], v6, s[60:63], s21 offen offset:1024 sc1
    v_mfma_f32_16x16x32_bf16 v[32:35], v[164:167], v[80:83], v[32:35]
    ds_read_b128 v[120:123], v209 offset:28672
    v_mfma_f32_16x16x32_bf16 v[40:43], v[164:167], v[84:87], v[40:43]
    ds_read_b128 v[124:127], v209 offset:30720
    v_mfma_f32_16x16x32_bf16 v[48:51], v[164:167], v[88:91], v[48:51]
    v_mfma_f32_16x16x32_bf16 v[56:59], v[164:167], v[92:95], v[56:59]
    buffer_load_dwordx4 v[152:155], v6, s[60:63], s21 offen offset:2048 sc1
    v_mfma_f32_16x16x32_bf16 v[36:39], v[172:175], v[80:83], v[36:39]
    v_mfma_f32_16x16x32_bf16 v[44:47], v[172:175], v[84:87], v[44:47]
    v_mfma_f32_16x16x32_bf16 v[52:55], v[172:175], v[88:91], v[52:55]
    v_mfma_f32_16x16x32_bf16 v[60:63], v[172:175], v[92:95], v[60:63]
    buffer_load_dwordx4 v[156:159], v6, s[60:63], s21 offen offset:3072 sc1
    s_waitcnt lgkmcnt(0)
    s_waitcnt vmcnt(12)
    s_add_u32 s21, s27, 7
    s_and_b32 s21, s21, 31
    s_lshl_b32 s21, s21, 14
    s_add_u32 s21, s21, s20
    v_mfma_f32_16x16x32_bf16 v[32:35], v[176:179], v[96:99], v[32:35]
    ds_read_b128 v[64:67], v208 offset:32768
    v_mfma_f32_16x16x32_bf16 v[40:43], v[176:179], v[100:103], v[40:43]
    ds_read_b128 v[68:71], v208 offset:34816
    v_mfma_f32_16x16x32_bf16 v[48:51], v[176:179], v[104:107], v[48:51]
    ds_read_b128 v[72:75], v208 offset:36864
    v_mfma_f32_16x16x32_bf16 v[56:59], v[176:179], v[108:111], v[56:59]
    buffer_load_dwordx4 v[160:163], v6, s[60:63], s21 offen offset:0 sc1
    v_mfma_f32_16x16x32_bf16 v[36:39], v[184:187], v[96:99], v[36:39]
    ds_read_b128 v[76:79], v208 offset:38912
    v_mfma_f32_16x16x32_bf16 v[44:47], v[184:187], v[100:103], v[44:47]
    ds_read_b128 v[80:83], v209 offset:32768
    v_mfma_f32_16x16x32_bf16 v[52:55], v[184:187], v[104:107], v[52:55]
    ds_read_b128 v[84:87], v209 offset:34816
    v_mfma_f32_16x16x32_bf16 v[60:63], v[184:187], v[108:111], v[60:63]
    buffer_load_dwordx4 v[164:167], v6, s[60:63], s21 offen offset:1024 sc1
    v_mfma_f32_16x16x32_bf16 v[32:35], v[180:183], v[112:115], v[32:35]
    ds_read_b128 v[88:91], v209 offset:36864
    v_mfma_f32_16x16x32_bf16 v[40:43], v[180:183], v[116:119], v[40:43]
    ds_read_b128 v[92:95], v209 offset:38912
    v_mfma_f32_16x16x32_bf16 v[48:51], v[180:183], v[120:123], v[48:51]
    v_mfma_f32_16x16x32_bf16 v[56:59], v[180:183], v[124:127], v[56:59]
    buffer_load_dwordx4 v[168:171], v6, s[60:63], s21 offen offset:2048 sc1
    v_mfma_f32_16x16x32_bf16 v[36:39], v[188:191], v[112:115], v[36:39]
    v_mfma_f32_16x16x32_bf16 v[44:47], v[188:191], v[116:119], v[44:47]
    v_mfma_f32_16x16x32_bf16 v[52:55], v[188:191], v[120:123], v[52:55]
    v_mfma_f32_16x16x32_bf16 v[60:63], v[188:191], v[124:127], v[60:63]
    buffer_load_dwordx4 v[172:175], v6, s[60:63], s21 offen offset:3072 sc1
    s_waitcnt lgkmcnt(0)
    s_barrier
    s_waitcnt vmcnt(12)
    s_add_u32 s21, s27, 8
    s_and_b32 s21, s21, 31
    s_lshl_b32 s21, s21, 14
    s_add_u32 s21, s21, s20
    v_mfma_f32_16x16x32_bf16 v[32:35], v[192:195], v[64:67], v[32:35]
    ds_read_b128 v[96:99], v208 offset:40960
    v_mfma_f32_16x16x32_bf16 v[40:43], v[192:195], v[68:71], v[40:43]
    ds_read_b128 v[100:103], v208 offset:43008
    v_mfma_f32_16x16x32_bf16 v[48:51], v[192:195], v[72:75], v[48:51]
    ds_read_b128 v[104:107], v208 offset:45056
    v_mfma_f32_16x16x32_bf16 v[56:59], v[192:195], v[76:79], v[56:59]
    buffer_load_dwordx4 v[176:179], v6, s[60:63], s21 offen offset:0 sc1
    v_mfma_f32_16x16x32_bf16 v[36:39], v[200:203], v[64:67], v[36:39]
    ds_read_b128 v[108:111], v208 offset:47104
    v_mfma_f32_16x16x32_bf16 v[44:47], v[200:203], v[68:71], v[44:47]
    ds_read_b128 v[112:115], v209 offset:40960
    v_mfma_f32_16x16x32_bf16 v[52:55], v[200:203], v[72:75], v[52:55]
    ds_read_b128 v[116:119], v209 offset:43008
    v_mfma_f32_16x16x32_bf16 v[60:63], v[200:203], v[76:79], v[60:63]
    buffer_load_dwordx4 v[180:183], v6, s[60:63], s21 offen offset:1024 sc1
    v_mfma_f32_16x16x32_bf16 v[32:35], v[196:199], v[80:83], v[32:35]
    ds_read_b128 v[120:123], v209 offset:45056
    v_mfma_f32_16x16x32_bf16 v[40:43], v[196:199], v[84:87], v[40:43]
    ds_read_b128 v[124:127], v209 offset:47104
    v_mfma_f32_16x16x32_bf16 v[48:51], v[196:199], v[88:91], v[48:51]
    v_mfma_f32_16x16x32_bf16 v[56:59], v[196:199], v[92:95], v[56:59]
    buffer_load_dwordx4 v[184:187], v6, s[60:63], s21 offen offset:2048 sc1
    v_mfma_f32_16x16x32_bf16 v[36:39], v[204:207], v[80:83], v[36:39]
    v_mfma_f32_16x16x32_bf16 v[44:47], v[204:207], v[84:87], v[44:47]
    v_mfma_f32_16x16x32_bf16 v[52:55], v[204:207], v[88:91], v[52:55]
    v_mfma_f32_16x16x32_bf16 v[60:63], v[204:207], v[92:95], v[60:63]
    buffer_load_dwordx4 v[188:191], v6, s[60:63], s21 offen offset:3072 sc1
    s_waitcnt lgkmcnt(0)
    s_waitcnt vmcnt(12)
    s_add_u32 s21, s27, 9
    s_and_b32 s21, s21, 31
    s_lshl_b32 s21, s21, 14
    s_add_u32 s21, s21, s20
    v_mfma_f32_16x16x32_bf16 v[32:35], v[128:131], v[96:99], v[32:35]
    ds_read_b128 v[64:67], v208 offset:49152
    v_mfma_f32_16x16x32_bf16 v[40:43], v[128:131], v[100:103], v[40:43]
    ds_read_b128 v[68:71], v208 offset:51200
    v_mfma_f32_16x16x32_bf16 v[48:51], v[128:131], v[104:107], v[48:51]
    ds_read_b128 v[72:75], v208 offset:53248
    v_mfma_f32_16x16x32_bf16 v[56:59], v[128:131], v[108:111], v[56:59]
    buffer_load_dwordx4 v[192:195], v6, s[60:63], s21 offen offset:0 sc1
    v_mfma_f32_16x16x32_bf16 v[36:39], v[136:139], v[96:99], v[36:39]
    ds_read_b128 v[76:79], v208 offset:55296
    v_mfma_f32_16x16x32_bf16 v[44:47], v[136:139], v[100:103], v[44:47]
    ds_read_b128 v[80:83], v209 offset:49152
    v_mfma_f32_16x16x32_bf16 v[52:55], v[136:139], v[104:107], v[52:55]
    ds_read_b128 v[84:87], v209 offset:51200
    v_mfma_f32_16x16x32_bf16 v[60:63], v[136:139], v[108:111], v[60:63]
    buffer_load_dwordx4 v[196:199], v6, s[60:63], s21 offen offset:1024 sc1
    v_mfma_f32_16x16x32_bf16 v[32:35], v[132:135], v[112:115], v[32:35]
    ds_read_b128 v[88:91], v209 offset:53248
    v_mfma_f32_16x16x32_bf16 v[40:43], v[132:135], v[116:119], v[40:43]
    ds_read_b128 v[92:95], v209 offset:55296
    v_mfma_f32_16x16x32_bf16 v[48:51], v[132:135], v[120:123], v[48:51]
    v_mfma_f32_16x16x32_bf16 v[56:59], v[132:135], v[124:127], v[56:59]
    buffer_load_dwordx4 v[200:203], v6, s[60:63], s21 offen offset:2048 sc1
    v_mfma_f32_16x16x32_bf16 v[36:39], v[140:143], v[112:115], v[36:39]
    v_mfma_f32_16x16x32_bf16 v[44:47], v[140:143], v[116:119], v[44:47]
    v_mfma_f32_16x16x32_bf16 v[52:55], v[140:143], v[120:123], v[52:55]
    v_mfma_f32_16x16x32_bf16 v[60:63], v[140:143], v[124:127], v[60:63]
    buffer_load_dwordx4 v[204:207], v6, s[60:63], s21 offen offset:3072 sc1
    s_waitcnt lgkmcnt(0)
    s_barrier
    s_waitcnt vmcnt(12)
    s_add_u32 s21, s27, 10
    s_and_b32 s21, s21, 31
    s_lshl_b32 s21, s21, 14
    s_add_u32 s21, s21, s20
    v_mfma_f32_16x16x32_bf16 v[32:35], v[144:147], v[64:67], v[32:35]
    ds_read_b128 v[96:99], v208 offset:57344
    v_mfma_f32_16x16x32_bf16 v[40:43], v[144:147], v[68:71], v[40:43]
    ds_read_b128 v[100:103], v208 offset:59392
    v_mfma_f32_16x16x32_bf16 v[48:51], v[144:147], v[72:75], v[48:51]
    ds_read_b128 v[104:107], v208 offset:61440
    v_mfma_f32_16x16x32_bf16 v[56:59], v[144:147], v[76:79], v[56:59]
    buffer_load_dwordx4 v[128:131], v6, s[60:63], s21 offen offset:0 sc1
    v_mfma_f32_16x16x32_bf16 v[36:39], v[152:155], v[64:67], v[36:39]
    ds_read_b128 v[108:111], v208 offset:63488
    v_mfma_f32_16x16x32_bf16 v[44:47], v[152:155], v[68:71], v[44:47]
    ds_read_b128 v[112:115], v209 offset:57344
    v_mfma_f32_16x16x32_bf16 v[52:55], v[152:155], v[72:75], v[52:55]
    ds_read_b128 v[116:119], v209 offset:59392
    v_mfma_f32_16x16x32_bf16 v[60:63], v[152:155], v[76:79], v[60:63]
    buffer_load_dwordx4 v[132:135], v6, s[60:63], s21 offen offset:1024 sc1
    v_mfma_f32_16x16x32_bf16 v[32:35], v[148:151], v[80:83], v[32:35]
    ds_read_b128 v[120:123], v209 offset:61440
    v_mfma_f32_16x16x32_bf16 v[40:43], v[148:151], v[84:87], v[40:43]
    ds_read_b128 v[124:127], v209 offset:63488
    v_mfma_f32_16x16x32_bf16 v[48:51], v[148:151], v[88:91], v[48:51]
    v_mfma_f32_16x16x32_bf16 v[56:59], v[148:151], v[92:95], v[56:59]
    buffer_load_dwordx4 v[136:139], v6, s[60:63], s21 offen offset:2048 sc1
    v_mfma_f32_16x16x32_bf16 v[36:39], v[156:159], v[80:83], v[36:39]
    v_mfma_f32_16x16x32_bf16 v[44:47], v[156:159], v[84:87], v[44:47]
    v_mfma_f32_16x16x32_bf16 v[52:55], v[156:159], v[88:91], v[52:55]
    v_mfma_f32_16x16x32_bf16 v[60:63], v[156:159], v[92:95], v[60:63]
    buffer_load_dwordx4 v[140:143], v6, s[60:63], s21 offen offset:3072 sc1
    s_waitcnt lgkmcnt(0)
    s_waitcnt vmcnt(12)
    s_add_u32 s21, s27, 11
    s_and_b32 s21, s21, 31
    s_lshl_b32 s21, s21, 14
    s_add_u32 s21, s21, s20
    v_mfma_f32_16x16x32_bf16 v[32:35], v[160:163], v[96:99], v[32:35]
    ds_read_b128 v[64:67], v208 offset:0
    v_mfma_f32_16x16x32_bf16 v[40:43], v[160:163], v[100:103], v[40:43]
    ds_read_b128 v[68:71], v208 offset:2048
    v_mfma_f32_16x16x32_bf16 v[48:51], v[160:163], v[104:107], v[48:51]
    ds_read_b128 v[72:75], v208 offset:4096
    v_mfma_f32_16x16x32_bf16 v[56:59], v[160:163], v[108:111], v[56:59]
    buffer_load_dwordx4 v[144:147], v6, s[60:63], s21 offen offset:0 sc1
    v_mfma_f32_16x16x32_bf16 v[36:39], v[168:171], v[96:99], v[36:39]
    ds_read_b128 v[76:79], v208 offset:6144
    v_mfma_f32_16x16x32_bf16 v[44:47], v[168:171], v[100:103], v[44:47]
    ds_read_b128 v[80:83], v209 offset:0
    v_mfma_f32_16x16x32_bf16 v[52:55], v[168:171], v[104:107], v[52:55]
    ds_read_b128 v[84:87], v209 offset:2048
    v_mfma_f32_16x16x32_bf16 v[60:63], v[168:171], v[108:111], v[60:63]
    buffer_load_dwordx4 v[148:151], v6, s[60:63], s21 offen offset:1024 sc1
    v_mfma_f32_16x16x32_bf16 v[32:35], v[164:167], v[112:115], v[32:35]
    ds_read_b128 v[88:91], v209 offset:4096
    v_mfma_f32_16x16x32_bf16 v[40:43], v[164:167], v[116:119], v[40:43]
    ds_read_b128 v[92:95], v209 offset:6144
    v_mfma_f32_16x16x32_bf16 v[48:51], v[164:167], v[120:123], v[48:51]
    v_mfma_f32_16x16x32_bf16 v[56:59], v[164:167], v[124:127], v[56:59]
    buffer_load_dwordx4 v[152:155], v6, s[60:63], s21 offen offset:2048 sc1
    v_mfma_f32_16x16x32_bf16 v[36:39], v[172:175], v[112:115], v[36:39]
    v_mfma_f32_16x16x32_bf16 v[44:47], v[172:175], v[116:119], v[44:47]
    v_mfma_f32_16x16x32_bf16 v[52:55], v[172:175], v[120:123], v[52:55]
    v_mfma_f32_16x16x32_bf16 v[60:63], v[172:175], v[124:127], v[60:63]
    buffer_load_dwordx4 v[156:159], v6, s[60:63], s21 offen offset:3072 sc1
    s_waitcnt lgkmcnt(0)
    s_barrier
    s_waitcnt vmcnt(12)
    s_add_u32 s21, s27, 12
    s_and_b32 s21, s21, 31
    s_lshl_b32 s21, s21, 14
    s_add_u32 s21, s21, s20
    v_mfma_f32_16x16x32_bf16 v[32:35], v[176:179], v[64:67], v[32:35]
    ds_read_b128 v[96:99], v208 offset:8192
    v_mfma_f32_16x16x32_bf16 v[40:43], v[176:179], v[68:71], v[40:43]
    ds_read_b128 v[100:103], v208 offset:10240
    v_mfma_f32_16x16x32_bf16 v[48:51], v[176:179], v[72:75], v[48:51]
    ds_read_b128 v[104:107], v208 offset:12288
    v_mfma_f32_16x16x32_bf16 v[56:59], v[176:179], v[76:79], v[56:59]
    buffer_load_dwordx4 v[160:163], v6, s[60:63], s21 offen offset:0 sc1
    v_mfma_f32_16x16x32_bf16 v[36:39], v[184:187], v[64:67], v[36:39]
    ds_read_b128 v[108:111], v208 offset:14336
    v_mfma_f32_16x16x32_bf16 v[44:47], v[184:187], v[68:71], v[44:47]
    ds_read_b128 v[112:115], v209 offset:8192
    v_mfma_f32_16x16x32_bf16 v[52:55], v[184:187], v[72:75], v[52:55]
    ds_read_b128 v[116:119], v209 offset:10240
    v_mfma_f32_16x16x32_bf16 v[60:63], v[184:187], v[76:79], v[60:63]
    buffer_load_dwordx4 v[164:167], v6, s[60:63], s21 offen offset:1024 sc1
    v_mfma_f32_16x16x32_bf16 v[32:35], v[180:183], v[80:83], v[32:35]
    ds_read_b128 v[120:123], v209 offset:12288
    v_mfma_f32_16x16x32_bf16 v[40:43], v[180:183], v[84:87], v[40:43]
    ds_read_b128 v[124:127], v209 offset:14336
    v_mfma_f32_16x16x32_bf16 v[48:51], v[180:183], v[88:91], v[48:51]
    v_mfma_f32_16x16x32_bf16 v[56:59], v[180:183], v[92:95], v[56:59]
    buffer_load_dwordx4 v[168:171], v6, s[60:63], s21 offen offset:2048 sc1
    v_mfma_f32_16x16x32_bf16 v[36:39], v[188:191], v[80:83], v[36:39]
    v_mfma_f32_16x16x32_bf16 v[44:47], v[188:191], v[84:87], v[44:47]
    v_mfma_f32_16x16x32_bf16 v[52:55], v[188:191], v[88:91], v[52:55]
    v_mfma_f32_16x16x32_bf16 v[60:63], v[188:191], v[92:95], v[60:63]
    buffer_load_dwordx4 v[172:175], v6, s[60:63], s21 offen offset:3072 sc1
    s_waitcnt lgkmcnt(0)
    s_waitcnt vmcnt(12)
    s_add_u32 s21, s27, 13
    s_and_b32 s21, s21, 31
    s_lshl_b32 s21, s21, 14
    s_add_u32 s21, s21, s20
    v_mfma_f32_16x16x32_bf16 v[32:35], v[192:195], v[96:99], v[32:35]
    ds_read_b128 v[64:67], v208 offset:16384
    v_mfma_f32_16x16x32_bf16 v[40:43], v[192:195], v[100:103], v[40:43]
    ds_read_b128 v[68:71], v208 offset:18432
    v_mfma_f32_16x16x32_bf16 v[48:51], v[192:195], v[104:107], v[48:51]
    ds_read_b128 v[72:75], v208 offset:20480
    v_mfma_f32_16x16x32_bf16 v[56:59], v[192:195], v[108:111], v[56:59]
    buffer_load_dwordx4 v[176:179], v6, s[60:63], s21 offen offset:0 sc1
    v_mfma_f32_16x16x32_bf16 v[36:39], v[200:203], v[96:99], v[36:39]
    ds_read_b128 v[76:79], v208 offset:22528
    v_mfma_f32_16x16x32_bf16 v[44:47], v[200:203], v[100:103], v[44:47]
    ds_read_b128 v[80:83], v209 offset:16384
    v_mfma_f32_16x16x32_bf16 v[52:55], v[200:203], v[104:107], v[52:55]
    ds_read_b128 v[84:87], v209 offset:18432
    v_mfma_f32_16x16x32_bf16 v[60:63], v[200:203], v[108:111], v[60:63]
    buffer_load_dwordx4 v[180:183], v6, s[60:63], s21 offen offset:1024 sc1
    v_mfma_f32_16x16x32_bf16 v[32:35], v[196:199], v[112:115], v[32:35]
    ds_read_b128 v[88:91], v209 offset:20480
    v_mfma_f32_16x16x32_bf16 v[40:43], v[196:199], v[116:119], v[40:43]
    ds_read_b128 v[92:95], v209 offset:22528
    v_mfma_f32_16x16x32_bf16 v[48:51], v[196:199], v[120:123], v[48:51]
    v_mfma_f32_16x16x32_bf16 v[56:59], v[196:199], v[124:127], v[56:59]
    buffer_load_dwordx4 v[184:187], v6, s[60:63], s21 offen offset:2048 sc1
    v_mfma_f32_16x16x32_bf16 v[36:39], v[204:207], v[112:115], v[36:39]
    v_mfma_f32_16x16x32_bf16 v[44:47], v[204:207], v[116:119], v[44:47]
    v_mfma_f32_16x16x32_bf16 v[52:55], v[204:207], v[120:123], v[52:55]
    v_mfma_f32_16x16x32_bf16 v[60:63], v[204:207], v[124:127], v[60:63]
    buffer_load_dwordx4 v[188:191], v6, s[60:63], s21 offen offset:3072 sc1
    s_waitcnt lgkmcnt(0)
    s_barrier
    s_waitcnt vmcnt(12)
    s_add_u32 s21, s27, 14
    s_and_b32 s21, s21, 31
    s_lshl_b32 s21, s21, 14
    s_add_u32 s21, s21, s20
    v_mfma_f32_16x16x32_bf16 v[32:35], v[128:131], v[64:67], v[32:35]
    ds_read_b128 v[96:99], v208 offset:24576
    v_mfma_f32_16x16x32_bf16 v[40:43], v[128:131], v[68:71], v[40:43]
    ds_read_b128 v[100:103], v208 offset:26624
    v_mfma_f32_16x16x32_bf16 v[48:51], v[128:131], v[72:75], v[48:51]
    ds_read_b128 v[104:107], v208 offset:28672
    v_mfma_f32_16x16x32_bf16 v[56:59], v[128:131], v[76:79], v[56:59]
    buffer_load_dwordx4 v[192:195], v6, s[60:63], s21 offen offset:0 sc1
    v_mfma_f32_16x16x32_bf16 v[36:39], v[136:139], v[64:67], v[36:39]
    ds_read_b128 v[108:111], v208 offset:30720
    v_mfma_f32_16x16x32_bf16 v[44:47], v[136:139], v[68:71], v[44:47]
    ds_read_b128 v[112:115], v209 offset:24576
    v_mfma_f32_16x16x32_bf16 v[52:55], v[136:139], v[72:75], v[52:55]
    ds_read_b128 v[116:119], v209 offset:26624
    v_mfma_f32_16x16x32_bf16 v[60:63], v[136:139], v[76:79], v[60:63]
    buffer_load_dwordx4 v[196:199], v6, s[60:63], s21 offen offset:1024 sc1
    v_mfma_f32_16x16x32_bf16 v[32:35], v[132:135], v[80:83], v[32:35]
    ds_read_b128 v[120:123], v209 offset:28672
    v_mfma_f32_16x16x32_bf16 v[40:43], v[132:135], v[84:87], v[40:43]
    ds_read_b128 v[124:127], v209 offset:30720
    v_mfma_f32_16x16x32_bf16 v[48:51], v[132:135], v[88:91], v[48:51]
    v_mfma_f32_16x16x32_bf16 v[56:59], v[132:135], v[92:95], v[56:59]
    buffer_load_dwordx4 v[200:203], v6, s[60:63], s21 offen offset:2048 sc1
    v_mfma_f32_16x16x32_bf16 v[36:39], v[140:143], v[80:83], v[36:39]
    v_mfma_f32_16x16x32_bf16 v[44:47], v[140:143], v[84:87], v[44:47]
    v_mfma_f32_16x16x32_bf16 v[52:55], v[140:143], v[88:91], v[52:55]
    v_mfma_f32_16x16x32_bf16 v[60:63], v[140:143], v[92:95], v[60:63]
    buffer_load_dwordx4 v[204:207], v6, s[60:63], s21 offen offset:3072 sc1
    s_waitcnt lgkmcnt(0)
    s_waitcnt vmcnt(12)
    s_add_u32 s21, s27, 15
    s_and_b32 s21, s21, 31
    s_lshl_b32 s21, s21, 14
    s_add_u32 s21, s21, s20
    v_mfma_f32_16x16x32_bf16 v[32:35], v[144:147], v[96:99], v[32:35]
    ds_read_b128 v[64:67], v208 offset:32768
    v_mfma_f32_16x16x32_bf16 v[40:43], v[144:147], v[100:103], v[40:43]
    ds_read_b128 v[68:71], v208 offset:34816
    v_mfma_f32_16x16x32_bf16 v[48:51], v[144:147], v[104:107], v[48:51]
    ds_read_b128 v[72:75], v208 offset:36864
    v_mfma_f32_16x16x32_bf16 v[56:59], v[144:147], v[108:111], v[56:59]
    buffer_load_dwordx4 v[128:131], v6, s[60:63], s21 offen offset:0 sc1
    v_mfma_f32_16x16x32_bf16 v[36:39], v[152:155], v[96:99], v[36:39]
    ds_read_b128 v[76:79], v208 offset:38912
    v_mfma_f32_16x16x32_bf16 v[44:47], v[152:155], v[100:103], v[44:47]
    ds_read_b128 v[80:83], v209 offset:32768
    v_mfma_f32_16x16x32_bf16 v[52:55], v[152:155], v[104:107], v[52:55]
    ds_read_b128 v[84:87], v209 offset:34816
    v_mfma_f32_16x16x32_bf16 v[60:63], v[152:155], v[108:111], v[60:63]
    buffer_load_dwordx4 v[132:135], v6, s[60:63], s21 offen offset:1024 sc1
    v_mfma_f32_16x16x32_bf16 v[32:35], v[148:151], v[112:115], v[32:35]
    ds_read_b128 v[88:91], v209 offset:36864
    v_mfma_f32_16x16x32_bf16 v[40:43], v[148:151], v[116:119], v[40:43]
    ds_read_b128 v[92:95], v209 offset:38912
    v_mfma_f32_16x16x32_bf16 v[48:51], v[148:151], v[120:123], v[48:51]
    v_mfma_f32_16x16x32_bf16 v[56:59], v[148:151], v[124:127], v[56:59]
    buffer_load_dwordx4 v[136:139], v6, s[60:63], s21 offen offset:2048 sc1
    v_mfma_f32_16x16x32_bf16 v[36:39], v[156:159], v[112:115], v[36:39]
    v_mfma_f32_16x16x32_bf16 v[44:47], v[156:159], v[116:119], v[44:47]
    v_mfma_f32_16x16x32_bf16 v[52:55], v[156:159], v[120:123], v[52:55]
    v_mfma_f32_16x16x32_bf16 v[60:63], v[156:159], v[124:127], v[60:63]
    buffer_load_dwordx4 v[140:143], v6, s[60:63], s21 offen offset:3072 sc1
    s_waitcnt lgkmcnt(0)
    s_barrier
    s_waitcnt vmcnt(12)
    s_add_u32 s21, s27, 16
    s_and_b32 s21, s21, 31
    s_lshl_b32 s21, s21, 14
    s_add_u32 s21, s21, s20
    v_mfma_f32_16x16x32_bf16 v[32:35], v[160:163], v[64:67], v[32:35]
    ds_read_b128 v[96:99], v208 offset:40960
    v_mfma_f32_16x16x32_bf16 v[40:43], v[160:163], v[68:71], v[40:43]
    ds_read_b128 v[100:103], v208 offset:43008
    v_mfma_f32_16x16x32_bf16 v[48:51], v[160:163], v[72:75], v[48:51]
    ds_read_b128 v[104:107], v208 offset:45056
    v_mfma_f32_16x16x32_bf16 v[56:59], v[160:163], v[76:79], v[56:59]
    buffer_load_dwordx4 v[144:147], v6, s[60:63], s21 offen offset:0 sc1
    v_mfma_f32_16x16x32_bf16 v[36:39], v[168:171], v[64:67], v[36:39]
    ds_read_b128 v[108:111], v208 offset:47104
    v_mfma_f32_16x16x32_bf16 v[44:47], v[168:171], v[68:71], v[44:47]
    ds_read_b128 v[112:115], v209 offset:40960
    v_mfma_f32_16x16x32_bf16 v[52:55], v[168:171], v[72:75], v[52:55]
    ds_read_b128 v[116:119], v209 offset:43008
    v_mfma_f32_16x16x32_bf16 v[60:63], v[168:171], v[76:79], v[60:63]
    buffer_load_dwordx4 v[148:151], v6, s[60:63], s21 offen offset:1024 sc1
    v_mfma_f32_16x16x32_bf16 v[32:35], v[164:167], v[80:83], v[32:35]
    ds_read_b128 v[120:123], v209 offset:45056
    v_mfma_f32_16x16x32_bf16 v[40:43], v[164:167], v[84:87], v[40:43]
    ds_read_b128 v[124:127], v209 offset:47104
    v_mfma_f32_16x16x32_bf16 v[48:51], v[164:167], v[88:91], v[48:51]
    v_mfma_f32_16x16x32_bf16 v[56:59], v[164:167], v[92:95], v[56:59]
    buffer_load_dwordx4 v[152:155], v6, s[60:63], s21 offen offset:2048 sc1
    v_mfma_f32_16x16x32_bf16 v[36:39], v[172:175], v[80:83], v[36:39]
    v_mfma_f32_16x16x32_bf16 v[44:47], v[172:175], v[84:87], v[44:47]
    v_mfma_f32_16x16x32_bf16 v[52:55], v[172:175], v[88:91], v[52:55]
    v_mfma_f32_16x16x32_bf16 v[60:63], v[172:175], v[92:95], v[60:63]
    buffer_load_dwordx4 v[156:159], v6, s[60:63], s21 offen offset:3072 sc1
    s_waitcnt lgkmcnt(0)
    s_waitcnt vmcnt(12)
    s_add_u32 s21, s27, 17
    s_and_b32 s21, s21, 31
    s_lshl_b32 s21, s21, 14
    s_add_u32 s21, s21, s20
    v_mfma_f32_16x16x32_bf16 v[32:35], v[176:179], v[96:99], v[32:35]
    ds_read_b128 v[64:67], v208 offset:49152
    v_mfma_f32_16x16x32_bf16 v[40:43], v[176:179], v[100:103], v[40:43]
    ds_read_b128 v[68:71], v208 offset:51200
    v_mfma_f32_16x16x32_bf16 v[48:51], v[176:179], v[104:107], v[48:51]
    ds_read_b128 v[72:75], v208 offset:53248
    v_mfma_f32_16x16x32_bf16 v[56:59], v[176:179], v[108:111], v[56:59]
    buffer_load_dwordx4 v[160:163], v6, s[60:63], s21 offen offset:0 sc1
    v_mfma_f32_16x16x32_bf16 v[36:39], v[184:187], v[96:99], v[36:39]
    ds_read_b128 v[76:79], v208 offset:55296
    v_mfma_f32_16x16x32_bf16 v[44:47], v[184:187], v[100:103], v[44:47]
    ds_read_b128 v[80:83], v209 offset:49152
    v_mfma_f32_16x16x32_bf16 v[52:55], v[184:187], v[104:107], v[52:55]
    ds_read_b128 v[84:87], v209 offset:51200
    v_mfma_f32_16x16x32_bf16 v[60:63], v[184:187], v[108:111], v[60:63]
    buffer_load_dwordx4 v[164:167], v6, s[60:63], s21 offen offset:1024 sc1
    v_mfma_f32_16x16x32_bf16 v[32:35], v[180:183], v[112:115], v[32:35]
    ds_read_b128 v[88:91], v209 offset:53248
    v_mfma_f32_16x16x32_bf16 v[40:43], v[180:183], v[116:119], v[40:43]
    ds_read_b128 v[92:95], v209 offset:55296
    v_mfma_f32_16x16x32_bf16 v[48:51], v[180:183], v[120:123], v[48:51]
    v_mfma_f32_16x16x32_bf16 v[56:59], v[180:183], v[124:127], v[56:59]
    buffer_load_dwordx4 v[168:171], v6, s[60:63], s21 offen offset:2048 sc1
    v_mfma_f32_16x16x32_bf16 v[36:39], v[188:191], v[112:115], v[36:39]
    v_mfma_f32_16x16x32_bf16 v[44:47], v[188:191], v[116:119], v[44:47]
    v_mfma_f32_16x16x32_bf16 v[52:55], v[188:191], v[120:123], v[52:55]
    v_mfma_f32_16x16x32_bf16 v[60:63], v[188:191], v[124:127], v[60:63]
    buffer_load_dwordx4 v[172:175], v6, s[60:63], s21 offen offset:3072 sc1
    s_waitcnt lgkmcnt(0)
    s_barrier
    s_waitcnt vmcnt(12)
    s_add_u32 s21, s27, 18
    s_and_b32 s21, s21, 31
    s_lshl_b32 s21, s21, 14
    s_add_u32 s21, s21, s20
    v_mfma_f32_16x16x32_bf16 v[32:35], v[192:195], v[64:67], v[32:35]
    ds_read_b128 v[96:99], v208 offset:57344
    v_mfma_f32_16x16x32_bf16 v[40:43], v[192:195], v[68:71], v[40:43]
    ds_read_b128 v[100:103], v208 offset:59392
    v_mfma_f32_16x16x32_bf16 v[48:51], v[192:195], v[72:75], v[48:51]
    ds_read_b128 v[104:107], v208 offset:61440
    v_mfma_f32_16x16x32_bf16 v[56:59], v[192:195], v[76:79], v[56:59]
    buffer_load_dwordx4 v[176:179], v6, s[60:63], s21 offen offset:0 sc1
    v_mfma_f32_16x16x32_bf16 v[36:39], v[200:203], v[64:67], v[36:39]
    ds_read_b128 v[108:111], v208 offset:63488
    v_mfma_f32_16x16x32_bf16 v[44:47], v[200:203], v[68:71], v[44:47]
    ds_read_b128 v[112:115], v209 offset:57344
    v_mfma_f32_16x16x32_bf16 v[52:55], v[200:203], v[72:75], v[52:55]
    ds_read_b128 v[116:119], v209 offset:59392
    v_mfma_f32_16x16x32_bf16 v[60:63], v[200:203], v[76:79], v[60:63]
    buffer_load_dwordx4 v[180:183], v6, s[60:63], s21 offen offset:1024 sc1
    v_mfma_f32_16x16x32_bf16 v[32:35], v[196:199], v[80:83], v[32:35]
    ds_read_b128 v[120:123], v209 offset:61440
    v_mfma_f32_16x16x32_bf16 v[40:43], v[196:199], v[84:87], v[40:43]
    ds_read_b128 v[124:127], v209 offset:63488
    v_mfma_f32_16x16x32_bf16 v[48:51], v[196:199], v[88:91], v[48:51]
    v_mfma_f32_16x16x32_bf16 v[56:59], v[196:199], v[92:95], v[56:59]
    buffer_load_dwordx4 v[184:187], v6, s[60:63], s21 offen offset:2048 sc1
    v_mfma_f32_16x16x32_bf16 v[36:39], v[204:207], v[80:83], v[36:39]
    v_mfma_f32_16x16x32_bf16 v[44:47], v[204:207], v[84:87], v[44:47]
    v_mfma_f32_16x16x32_bf16 v[52:55], v[204:207], v[88:91], v[52:55]
    v_mfma_f32_16x16x32_bf16 v[60:63], v[204:207], v[92:95], v[60:63]
    buffer_load_dwordx4 v[188:191], v6, s[60:63], s21 offen offset:3072 sc1
    s_waitcnt lgkmcnt(0)
    s_waitcnt vmcnt(12)
    s_add_u32 s21, s27, 19
    s_and_b32 s21, s21, 31
    s_lshl_b32 s21, s21, 14
    s_add_u32 s21, s21, s20
    v_mfma_f32_16x16x32_bf16 v[32:35], v[128:131], v[96:99], v[32:35]
    ds_read_b128 v[64:67], v208 offset:0
    v_mfma_f32_16x16x32_bf16 v[40:43], v[128:131], v[100:103], v[40:43]
    ds_read_b128 v[68:71], v208 offset:2048
    v_mfma_f32_16x16x32_bf16 v[48:51], v[128:131], v[104:107], v[48:51]
    ds_read_b128 v[72:75], v208 offset:4096
    v_mfma_f32_16x16x32_bf16 v[56:59], v[128:131], v[108:111], v[56:59]
    buffer_load_dwordx4 v[192:195], v6, s[60:63], s21 offen offset:0 sc1
    v_mfma_f32_16x16x32_bf16 v[36:39], v[136:139], v[96:99], v[36:39]
    ds_read_b128 v[76:79], v208 offset:6144
    v_mfma_f32_16x16x32_bf16 v[44:47], v[136:139], v[100:103], v[44:47]
    ds_read_b128 v[80:83], v209 offset:0
    v_mfma_f32_16x16x32_bf16 v[52:55], v[136:139], v[104:107], v[52:55]
    ds_read_b128 v[84:87], v209 offset:2048
    v_mfma_f32_16x16x32_bf16 v[60:63], v[136:139], v[108:111], v[60:63]
    buffer_load_dwordx4 v[196:199], v6, s[60:63], s21 offen offset:1024 sc1
    v_mfma_f32_16x16x32_bf16 v[32:35], v[132:135], v[112:115], v[32:35]
    ds_read_b128 v[88:91], v209 offset:4096
    v_mfma_f32_16x16x32_bf16 v[40:43], v[132:135], v[116:119], v[40:43]
    ds_read_b128 v[92:95], v209 offset:6144
    v_mfma_f32_16x16x32_bf16 v[48:51], v[132:135], v[120:123], v[48:51]
    v_mfma_f32_16x16x32_bf16 v[56:59], v[132:135], v[124:127], v[56:59]
    buffer_load_dwordx4 v[200:203], v6, s[60:63], s21 offen offset:2048 sc1
    v_mfma_f32_16x16x32_bf16 v[36:39], v[140:143], v[112:115], v[36:39]
    v_mfma_f32_16x16x32_bf16 v[44:47], v[140:143], v[116:119], v[44:47]
    v_mfma_f32_16x16x32_bf16 v[52:55], v[140:143], v[120:123], v[52:55]
    v_mfma_f32_16x16x32_bf16 v[60:63], v[140:143], v[124:127], v[60:63]
    buffer_load_dwordx4 v[204:207], v6, s[60:63], s21 offen offset:3072 sc1
    s_waitcnt lgkmcnt(0)
    s_barrier
    s_waitcnt vmcnt(12)
    s_add_u32 s21, s27, 20
    s_and_b32 s21, s21, 31
    s_lshl_b32 s21, s21, 14
    s_add_u32 s21, s21, s20
    v_mfma_f32_16x16x32_bf16 v[32:35], v[144:147], v[64:67], v[32:35]
    ds_read_b128 v[96:99], v208 offset:8192
    v_mfma_f32_16x16x32_bf16 v[40:43], v[144:147], v[68:71], v[40:43]
    ds_read_b128 v[100:103], v208 offset:10240
    v_mfma_f32_16x16x32_bf16 v[48:51], v[144:147], v[72:75], v[48:51]
    ds_read_b128 v[104:107], v208 offset:12288
    v_mfma_f32_16x16x32_bf16 v[56:59], v[144:147], v[76:79], v[56:59]
    buffer_load_dwordx4 v[128:131], v6, s[60:63], s21 offen offset:0 sc1
    v_mfma_f32_16x16x32_bf16 v[36:39], v[152:155], v[64:67], v[36:39]
    ds_read_b128 v[108:111], v208 offset:14336
    v_mfma_f32_16x16x32_bf16 v[44:47], v[152:155], v[68:71], v[44:47]
    ds_read_b128 v[112:115], v209 offset:8192
    v_mfma_f32_16x16x32_bf16 v[52:55], v[152:155], v[72:75], v[52:55]
    ds_read_b128 v[116:119], v209 offset:10240
    v_mfma_f32_16x16x32_bf16 v[60:63], v[152:155], v[76:79], v[60:63]
    buffer_load_dwordx4 v[132:135], v6, s[60:63], s21 offen offset:1024 sc1
    v_mfma_f32_16x16x32_bf16 v[32:35], v[148:151], v[80:83], v[32:35]
    ds_read_b128 v[120:123], v209 offset:12288
    v_mfma_f32_16x16x32_bf16 v[40:43], v[148:151], v[84:87], v[40:43]
    ds_read_b128 v[124:127], v209 offset:14336
    v_mfma_f32_16x16x32_bf16 v[48:51], v[148:151], v[88:91], v[48:51]
    v_mfma_f32_16x16x32_bf16 v[56:59], v[148:151], v[92:95], v[56:59]
    buffer_load_dwordx4 v[136:139], v6, s[60:63], s21 offen offset:2048 sc1
    v_mfma_f32_16x16x32_bf16 v[36:39], v[156:159], v[80:83], v[36:39]
    v_mfma_f32_16x16x32_bf16 v[44:47], v[156:159], v[84:87], v[44:47]
    v_mfma_f32_16x16x32_bf16 v[52:55], v[156:159], v[88:91], v[52:55]
    v_mfma_f32_16x16x32_bf16 v[60:63], v[156:159], v[92:95], v[60:63]
    buffer_load_dwordx4 v[140:143], v6, s[60:63], s21 offen offset:3072 sc1
    s_waitcnt lgkmcnt(0)
    s_waitcnt vmcnt(12)
    s_add_u32 s21, s27, 21
    s_and_b32 s21, s21, 31
    s_lshl_b32 s21, s21, 14
    s_add_u32 s21, s21, s20
    v_mfma_f32_16x16x32_bf16 v[32:35], v[160:163], v[96:99], v[32:35]
    ds_read_b128 v[64:67], v208 offset:16384
    v_mfma_f32_16x16x32_bf16 v[40:43], v[160:163], v[100:103], v[40:43]
    ds_read_b128 v[68:71], v208 offset:18432
    v_mfma_f32_16x16x32_bf16 v[48:51], v[160:163], v[104:107], v[48:51]
    ds_read_b128 v[72:75], v208 offset:20480
    v_mfma_f32_16x16x32_bf16 v[56:59], v[160:163], v[108:111], v[56:59]
    buffer_load_dwordx4 v[144:147], v6, s[60:63], s21 offen offset:0 sc1
    v_mfma_f32_16x16x32_bf16 v[36:39], v[168:171], v[96:99], v[36:39]
    ds_read_b128 v[76:79], v208 offset:22528
    v_mfma_f32_16x16x32_bf16 v[44:47], v[168:171], v[100:103], v[44:47]
    ds_read_b128 v[80:83], v209 offset:16384
    v_mfma_f32_16x16x32_bf16 v[52:55], v[168:171], v[104:107], v[52:55]
    ds_read_b128 v[84:87], v209 offset:18432
    v_mfma_f32_16x16x32_bf16 v[60:63], v[168:171], v[108:111], v[60:63]
    buffer_load_dwordx4 v[148:151], v6, s[60:63], s21 offen offset:1024 sc1
    v_mfma_f32_16x16x32_bf16 v[32:35], v[164:167], v[112:115], v[32:35]
    ds_read_b128 v[88:91], v209 offset:20480
    v_mfma_f32_16x16x32_bf16 v[40:43], v[164:167], v[116:119], v[40:43]
    ds_read_b128 v[92:95], v209 offset:22528
    v_mfma_f32_16x16x32_bf16 v[48:51], v[164:167], v[120:123], v[48:51]
    v_mfma_f32_16x16x32_bf16 v[56:59], v[164:167], v[124:127], v[56:59]
    buffer_load_dwordx4 v[152:155], v6, s[60:63], s21 offen offset:2048 sc1
    v_mfma_f32_16x16x32_bf16 v[36:39], v[172:175], v[112:115], v[36:39]
    v_mfma_f32_16x16x32_bf16 v[44:47], v[172:175], v[116:119], v[44:47]
    v_mfma_f32_16x16x32_bf16 v[52:55], v[172:175], v[120:123], v[52:55]
    v_mfma_f32_16x16x32_bf16 v[60:63], v[172:175], v[124:127], v[60:63]
    buffer_load_dwordx4 v[156:159], v6, s[60:63], s21 offen offset:3072 sc1
    s_waitcnt lgkmcnt(0)
    s_barrier
    s_waitcnt vmcnt(12)
    s_add_u32 s21, s27, 22
    s_and_b32 s21, s21, 31
    s_lshl_b32 s21, s21, 14
    s_add_u32 s21, s21, s20
    v_mfma_f32_16x16x32_bf16 v[32:35], v[176:179], v[64:67], v[32:35]
    ds_read_b128 v[96:99], v208 offset:24576
    v_mfma_f32_16x16x32_bf16 v[40:43], v[176:179], v[68:71], v[40:43]
    ds_read_b128 v[100:103], v208 offset:26624
    v_mfma_f32_16x16x32_bf16 v[48:51], v[176:179], v[72:75], v[48:51]
    ds_read_b128 v[104:107], v208 offset:28672
    v_mfma_f32_16x16x32_bf16 v[56:59], v[176:179], v[76:79], v[56:59]
    buffer_load_dwordx4 v[160:163], v6, s[60:63], s21 offen offset:0 sc1
    v_mfma_f32_16x16x32_bf16 v[36:39], v[184:187], v[64:67], v[36:39]
    ds_read_b128 v[108:111], v208 offset:30720
    v_mfma_f32_16x16x32_bf16 v[44:47], v[184:187], v[68:71], v[44:47]
    ds_read_b128 v[112:115], v209 offset:24576
    v_mfma_f32_16x16x32_bf16 v[52:55], v[184:187], v[72:75], v[52:55]
    ds_read_b128 v[116:119], v209 offset:26624
    v_mfma_f32_16x16x32_bf16 v[60:63], v[184:187], v[76:79], v[60:63]
    buffer_load_dwordx4 v[164:167], v6, s[60:63], s21 offen offset:1024 sc1
    v_mfma_f32_16x16x32_bf16 v[32:35], v[180:183], v[80:83], v[32:35]
    ds_read_b128 v[120:123], v209 offset:28672
    v_mfma_f32_16x16x32_bf16 v[40:43], v[180:183], v[84:87], v[40:43]
    ds_read_b128 v[124:127], v209 offset:30720
    v_mfma_f32_16x16x32_bf16 v[48:51], v[180:183], v[88:91], v[48:51]
    v_mfma_f32_16x16x32_bf16 v[56:59], v[180:183], v[92:95], v[56:59]
    buffer_load_dwordx4 v[168:171], v6, s[60:63], s21 offen offset:2048 sc1
    v_mfma_f32_16x16x32_bf16 v[36:39], v[188:191], v[80:83], v[36:39]
    v_mfma_f32_16x16x32_bf16 v[44:47], v[188:191], v[84:87], v[44:47]
    v_mfma_f32_16x16x32_bf16 v[52:55], v[188:191], v[88:91], v[52:55]
    v_mfma_f32_16x16x32_bf16 v[60:63], v[188:191], v[92:95], v[60:63]
    buffer_load_dwordx4 v[172:175], v6, s[60:63], s21 offen offset:3072 sc1
    s_waitcnt lgkmcnt(0)
    s_waitcnt vmcnt(12)
    s_add_u32 s21, s27, 23
    s_and_b32 s21, s21, 31
    s_lshl_b32 s21, s21, 14
    s_add_u32 s21, s21, s20
    v_mfma_f32_16x16x32_bf16 v[32:35], v[192:195], v[96:99], v[32:35]
    ds_read_b128 v[64:67], v208 offset:32768
    v_mfma_f32_16x16x32_bf16 v[40:43], v[192:195], v[100:103], v[40:43]
    ds_read_b128 v[68:71], v208 offset:34816
    v_mfma_f32_16x16x32_bf16 v[48:51], v[192:195], v[104:107], v[48:51]
    ds_read_b128 v[72:75], v208 offset:36864
    v_mfma_f32_16x16x32_bf16 v[56:59], v[192:195], v[108:111], v[56:59]
    buffer_load_dwordx4 v[176:179], v6, s[60:63], s21 offen offset:0 sc1
    v_mfma_f32_16x16x32_bf16 v[36:39], v[200:203], v[96:99], v[36:39]
    ds_read_b128 v[76:79], v208 offset:38912
    v_mfma_f32_16x16x32_bf16 v[44:47], v[200:203], v[100:103], v[44:47]
    ds_read_b128 v[80:83], v209 offset:32768
    v_mfma_f32_16x16x32_bf16 v[52:55], v[200:203], v[104:107], v[52:55]
    ds_read_b128 v[84:87], v209 offset:34816
    v_mfma_f32_16x16x32_bf16 v[60:63], v[200:203], v[108:111], v[60:63]
    buffer_load_dwordx4 v[180:183], v6, s[60:63], s21 offen offset:1024 sc1
    v_mfma_f32_16x16x32_bf16 v[32:35], v[196:199], v[112:115], v[32:35]
    ds_read_b128 v[88:91], v209 offset:36864
    v_mfma_f32_16x16x32_bf16 v[40:43], v[196:199], v[116:119], v[40:43]
    ds_read_b128 v[92:95], v209 offset:38912
    v_mfma_f32_16x16x32_bf16 v[48:51], v[196:199], v[120:123], v[48:51]
    v_mfma_f32_16x16x32_bf16 v[56:59], v[196:199], v[124:127], v[56:59]
    buffer_load_dwordx4 v[184:187], v6, s[60:63], s21 offen offset:2048 sc1
    v_mfma_f32_16x16x32_bf16 v[36:39], v[204:207], v[112:115], v[36:39]
    v_mfma_f32_16x16x32_bf16 v[44:47], v[204:207], v[116:119], v[44:47]
    v_mfma_f32_16x16x32_bf16 v[52:55], v[204:207], v[120:123], v[52:55]
    v_mfma_f32_16x16x32_bf16 v[60:63], v[204:207], v[124:127], v[60:63]
    buffer_load_dwordx4 v[188:191], v6, s[60:63], s21 offen offset:3072 sc1
    s_waitcnt lgkmcnt(0)
    s_barrier
    s_waitcnt vmcnt(12)
    s_add_u32 s21, s27, 24
    s_and_b32 s21, s21, 31
    s_lshl_b32 s21, s21, 14
    s_add_u32 s21, s21, s20
    v_mfma_f32_16x16x32_bf16 v[32:35], v[128:131], v[64:67], v[32:35]
    ds_read_b128 v[96:99], v208 offset:40960
    v_mfma_f32_16x16x32_bf16 v[40:43], v[128:131], v[68:71], v[40:43]
    ds_read_b128 v[100:103], v208 offset:43008
    v_mfma_f32_16x16x32_bf16 v[48:51], v[128:131], v[72:75], v[48:51]
    ds_read_b128 v[104:107], v208 offset:45056
    v_mfma_f32_16x16x32_bf16 v[56:59], v[128:131], v[76:79], v[56:59]
    buffer_load_dwordx4 v[192:195], v6, s[60:63], s21 offen offset:0 sc1
    v_mfma_f32_16x16x32_bf16 v[36:39], v[136:139], v[64:67], v[36:39]
    ds_read_b128 v[108:111], v208 offset:47104
    v_mfma_f32_16x16x32_bf16 v[44:47], v[136:139], v[68:71], v[44:47]
    ds_read_b128 v[112:115], v209 offset:40960
    v_mfma_f32_16x16x32_bf16 v[52:55], v[136:139], v[72:75], v[52:55]
    ds_read_b128 v[116:119], v209 offset:43008
    v_mfma_f32_16x16x32_bf16 v[60:63], v[136:139], v[76:79], v[60:63]
    buffer_load_dwordx4 v[196:199], v6, s[60:63], s21 offen offset:1024 sc1
    v_mfma_f32_16x16x32_bf16 v[32:35], v[132:135], v[80:83], v[32:35]
    ds_read_b128 v[120:123], v209 offset:45056
    v_mfma_f32_16x16x32_bf16 v[40:43], v[132:135], v[84:87], v[40:43]
    ds_read_b128 v[124:127], v209 offset:47104
    v_mfma_f32_16x16x32_bf16 v[48:51], v[132:135], v[88:91], v[48:51]
    v_mfma_f32_16x16x32_bf16 v[56:59], v[132:135], v[92:95], v[56:59]
    buffer_load_dwordx4 v[200:203], v6, s[60:63], s21 offen offset:2048 sc1
    v_mfma_f32_16x16x32_bf16 v[36:39], v[140:143], v[80:83], v[36:39]
    v_mfma_f32_16x16x32_bf16 v[44:47], v[140:143], v[84:87], v[44:47]
    v_mfma_f32_16x16x32_bf16 v[52:55], v[140:143], v[88:91], v[52:55]
    v_mfma_f32_16x16x32_bf16 v[60:63], v[140:143], v[92:95], v[60:63]
    buffer_load_dwordx4 v[204:207], v6, s[60:63], s21 offen offset:3072 sc1
    s_waitcnt lgkmcnt(0)
    s_waitcnt vmcnt(12)
    s_add_u32 s21, s27, 25
    s_and_b32 s21, s21, 31
    s_lshl_b32 s21, s21, 14
    s_add_u32 s21, s21, s20
    v_mfma_f32_16x16x32_bf16 v[32:35], v[144:147], v[96:99], v[32:35]
    ds_read_b128 v[64:67], v208 offset:49152
    v_mfma_f32_16x16x32_bf16 v[40:43], v[144:147], v[100:103], v[40:43]
    ds_read_b128 v[68:71], v208 offset:51200
    v_mfma_f32_16x16x32_bf16 v[48:51], v[144:147], v[104:107], v[48:51]
    ds_read_b128 v[72:75], v208 offset:53248
    v_mfma_f32_16x16x32_bf16 v[56:59], v[144:147], v[108:111], v[56:59]
    buffer_load_dwordx4 v[128:131], v6, s[60:63], s21 offen offset:0 sc1
    v_mfma_f32_16x16x32_bf16 v[36:39], v[152:155], v[96:99], v[36:39]
    ds_read_b128 v[76:79], v208 offset:55296
    v_mfma_f32_16x16x32_bf16 v[44:47], v[152:155], v[100:103], v[44:47]
    ds_read_b128 v[80:83], v209 offset:49152
    v_mfma_f32_16x16x32_bf16 v[52:55], v[152:155], v[104:107], v[52:55]
    ds_read_b128 v[84:87], v209 offset:51200
    v_mfma_f32_16x16x32_bf16 v[60:63], v[152:155], v[108:111], v[60:63]
    buffer_load_dwordx4 v[132:135], v6, s[60:63], s21 offen offset:1024 sc1
    v_mfma_f32_16x16x32_bf16 v[32:35], v[148:151], v[112:115], v[32:35]
    ds_read_b128 v[88:91], v209 offset:53248
    v_mfma_f32_16x16x32_bf16 v[40:43], v[148:151], v[116:119], v[40:43]
    ds_read_b128 v[92:95], v209 offset:55296
    v_mfma_f32_16x16x32_bf16 v[48:51], v[148:151], v[120:123], v[48:51]
    v_mfma_f32_16x16x32_bf16 v[56:59], v[148:151], v[124:127], v[56:59]
    buffer_load_dwordx4 v[136:139], v6, s[60:63], s21 offen offset:2048 sc1
    v_mfma_f32_16x16x32_bf16 v[36:39], v[156:159], v[112:115], v[36:39]
    v_mfma_f32_16x16x32_bf16 v[44:47], v[156:159], v[116:119], v[44:47]
    v_mfma_f32_16x16x32_bf16 v[52:55], v[156:159], v[120:123], v[52:55]
    v_mfma_f32_16x16x32_bf16 v[60:63], v[156:159], v[124:127], v[60:63]
    buffer_load_dwordx4 v[140:143], v6, s[60:63], s21 offen offset:3072 sc1
    s_waitcnt lgkmcnt(0)
    s_barrier
    s_waitcnt vmcnt(12)
    s_add_u32 s21, s27, 26
    s_and_b32 s21, s21, 31
    s_lshl_b32 s21, s21, 14
    s_add_u32 s21, s21, s20
    v_mfma_f32_16x16x32_bf16 v[32:35], v[160:163], v[64:67], v[32:35]
    ds_read_b128 v[96:99], v208 offset:57344
    v_mfma_f32_16x16x32_bf16 v[40:43], v[160:163], v[68:71], v[40:43]
    ds_read_b128 v[100:103], v208 offset:59392
    v_mfma_f32_16x16x32_bf16 v[48:51], v[160:163], v[72:75], v[48:51]
    ds_read_b128 v[104:107], v208 offset:61440
    v_mfma_f32_16x16x32_bf16 v[56:59], v[160:163], v[76:79], v[56:59]
    buffer_load_dwordx4 v[144:147], v6, s[60:63], s21 offen offset:0 sc1
    v_mfma_f32_16x16x32_bf16 v[36:39], v[168:171], v[64:67], v[36:39]
    ds_read_b128 v[108:111], v208 offset:63488
    v_mfma_f32_16x16x32_bf16 v[44:47], v[168:171], v[68:71], v[44:47]
    ds_read_b128 v[112:115], v209 offset:57344
    v_mfma_f32_16x16x32_bf16 v[52:55], v[168:171], v[72:75], v[52:55]
    ds_read_b128 v[116:119], v209 offset:59392
    v_mfma_f32_16x16x32_bf16 v[60:63], v[168:171], v[76:79], v[60:63]
    buffer_load_dwordx4 v[148:151], v6, s[60:63], s21 offen offset:1024 sc1
    v_mfma_f32_16x16x32_bf16 v[32:35], v[164:167], v[80:83], v[32:35]
    ds_read_b128 v[120:123], v209 offset:61440
    v_mfma_f32_16x16x32_bf16 v[40:43], v[164:167], v[84:87], v[40:43]
    ds_read_b128 v[124:127], v209 offset:63488
    v_mfma_f32_16x16x32_bf16 v[48:51], v[164:167], v[88:91], v[48:51]
    v_mfma_f32_16x16x32_bf16 v[56:59], v[164:167], v[92:95], v[56:59]
    buffer_load_dwordx4 v[152:155], v6, s[60:63], s21 offen offset:2048 sc1
    v_mfma_f32_16x16x32_bf16 v[36:39], v[172:175], v[80:83], v[36:39]
    v_mfma_f32_16x16x32_bf16 v[44:47], v[172:175], v[84:87], v[44:47]
    v_mfma_f32_16x16x32_bf16 v[52:55], v[172:175], v[88:91], v[52:55]
    v_mfma_f32_16x16x32_bf16 v[60:63], v[172:175], v[92:95], v[60:63]
    buffer_load_dwordx4 v[156:159], v6, s[60:63], s21 offen offset:3072 sc1
    s_waitcnt lgkmcnt(0)
    s_waitcnt vmcnt(12)
    s_add_u32 s21, s27, 27
    s_and_b32 s21, s21, 31
    s_lshl_b32 s21, s21, 14
    s_add_u32 s21, s21, s20
    v_mfma_f32_16x16x32_bf16 v[32:35], v[176:179], v[96:99], v[32:35]
    ds_read_b128 v[64:67], v208 offset:0
    v_mfma_f32_16x16x32_bf16 v[40:43], v[176:179], v[100:103], v[40:43]
    ds_read_b128 v[68:71], v208 offset:2048
    v_mfma_f32_16x16x32_bf16 v[48:51], v[176:179], v[104:107], v[48:51]
    ds_read_b128 v[72:75], v208 offset:4096
    v_mfma_f32_16x16x32_bf16 v[56:59], v[176:179], v[108:111], v[56:59]
    buffer_load_dwordx4 v[160:163], v6, s[60:63], s21 offen offset:0 sc1
    v_mfma_f32_16x16x32_bf16 v[36:39], v[184:187], v[96:99], v[36:39]
    ds_read_b128 v[76:79], v208 offset:6144
    v_mfma_f32_16x16x32_bf16 v[44:47], v[184:187], v[100:103], v[44:47]
    ds_read_b128 v[80:83], v209 offset:0
    v_mfma_f32_16x16x32_bf16 v[52:55], v[184:187], v[104:107], v[52:55]
    ds_read_b128 v[84:87], v209 offset:2048
    v_mfma_f32_16x16x32_bf16 v[60:63], v[184:187], v[108:111], v[60:63]
    buffer_load_dwordx4 v[164:167], v6, s[60:63], s21 offen offset:1024 sc1
    v_mfma_f32_16x16x32_bf16 v[32:35], v[180:183], v[112:115], v[32:35]
    ds_read_b128 v[88:91], v209 offset:4096
    v_mfma_f32_16x16x32_bf16 v[40:43], v[180:183], v[116:119], v[40:43]
    ds_read_b128 v[92:95], v209 offset:6144
    v_mfma_f32_16x16x32_bf16 v[48:51], v[180:183], v[120:123], v[48:51]
    v_mfma_f32_16x16x32_bf16 v[56:59], v[180:183], v[124:127], v[56:59]
    buffer_load_dwordx4 v[168:171], v6, s[60:63], s21 offen offset:2048 sc1
    v_mfma_f32_16x16x32_bf16 v[36:39], v[188:191], v[112:115], v[36:39]
    v_mfma_f32_16x16x32_bf16 v[44:47], v[188:191], v[116:119], v[44:47]
    v_mfma_f32_16x16x32_bf16 v[52:55], v[188:191], v[120:123], v[52:55]
    v_mfma_f32_16x16x32_bf16 v[60:63], v[188:191], v[124:127], v[60:63]
    buffer_load_dwordx4 v[172:175], v6, s[60:63], s21 offen offset:3072 sc1
    s_waitcnt lgkmcnt(0)
    s_barrier
    s_waitcnt vmcnt(12)
    s_add_u32 s21, s27, 28
    s_and_b32 s21, s21, 31
    s_lshl_b32 s21, s21, 14
    s_add_u32 s21, s21, s20
    v_mfma_f32_16x16x32_bf16 v[32:35], v[192:195], v[64:67], v[32:35]
    ds_read_b128 v[96:99], v208 offset:8192
    v_mfma_f32_16x16x32_bf16 v[40:43], v[192:195], v[68:71], v[40:43]
    ds_read_b128 v[100:103], v208 offset:10240
    v_mfma_f32_16x16x32_bf16 v[48:51], v[192:195], v[72:75], v[48:51]
    ds_read_b128 v[104:107], v208 offset:12288
    v_mfma_f32_16x16x32_bf16 v[56:59], v[192:195], v[76:79], v[56:59]
    buffer_load_dwordx4 v[176:179], v6, s[60:63], s21 offen offset:0 sc1
    v_mfma_f32_16x16x32_bf16 v[36:39], v[200:203], v[64:67], v[36:39]
    ds_read_b128 v[108:111], v208 offset:14336
    v_mfma_f32_16x16x32_bf16 v[44:47], v[200:203], v[68:71], v[44:47]
    ds_read_b128 v[112:115], v209 offset:8192
    v_mfma_f32_16x16x32_bf16 v[52:55], v[200:203], v[72:75], v[52:55]
    ds_read_b128 v[116:119], v209 offset:10240
    v_mfma_f32_16x16x32_bf16 v[60:63], v[200:203], v[76:79], v[60:63]
    buffer_load_dwordx4 v[180:183], v6, s[60:63], s21 offen offset:1024 sc1
    v_mfma_f32_16x16x32_bf16 v[32:35], v[196:199], v[80:83], v[32:35]
    ds_read_b128 v[120:123], v209 offset:12288
    v_mfma_f32_16x16x32_bf16 v[40:43], v[196:199], v[84:87], v[40:43]
    ds_read_b128 v[124:127], v209 offset:14336
    v_mfma_f32_16x16x32_bf16 v[48:51], v[196:199], v[88:91], v[48:51]
    v_mfma_f32_16x16x32_bf16 v[56:59], v[196:199], v[92:95], v[56:59]
    buffer_load_dwordx4 v[184:187], v6, s[60:63], s21 offen offset:2048 sc1
    v_mfma_f32_16x16x32_bf16 v[36:39], v[204:207], v[80:83], v[36:39]
    v_mfma_f32_16x16x32_bf16 v[44:47], v[204:207], v[84:87], v[44:47]
    v_mfma_f32_16x16x32_bf16 v[52:55], v[204:207], v[88:91], v[52:55]
    v_mfma_f32_16x16x32_bf16 v[60:63], v[204:207], v[92:95], v[60:63]
    buffer_load_dwordx4 v[188:191], v6, s[60:63], s21 offen offset:3072 sc1
    s_waitcnt lgkmcnt(0)
    s_waitcnt vmcnt(12)
    s_add_u32 s21, s27, 29
    s_and_b32 s21, s21, 31
    s_lshl_b32 s21, s21, 14
    s_add_u32 s21, s21, s20
    v_mfma_f32_16x16x32_bf16 v[32:35], v[128:131], v[96:99], v[32:35]
    ds_read_b128 v[64:67], v208 offset:16384
    v_mfma_f32_16x16x32_bf16 v[40:43], v[128:131], v[100:103], v[40:43]
    ds_read_b128 v[68:71], v208 offset:18432
    v_mfma_f32_16x16x32_bf16 v[48:51], v[128:131], v[104:107], v[48:51]
    ds_read_b128 v[72:75], v208 offset:20480
    v_mfma_f32_16x16x32_bf16 v[56:59], v[128:131], v[108:111], v[56:59]
    buffer_load_dwordx4 v[192:195], v6, s[60:63], s21 offen offset:0 sc1
    v_mfma_f32_16x16x32_bf16 v[36:39], v[136:139], v[96:99], v[36:39]
    ds_read_b128 v[76:79], v208 offset:22528
    v_mfma_f32_16x16x32_bf16 v[44:47], v[136:139], v[100:103], v[44:47]
    ds_read_b128 v[80:83], v209 offset:16384
    v_mfma_f32_16x16x32_bf16 v[52:55], v[136:139], v[104:107], v[52:55]
    ds_read_b128 v[84:87], v209 offset:18432
    v_mfma_f32_16x16x32_bf16 v[60:63], v[136:139], v[108:111], v[60:63]
    buffer_load_dwordx4 v[196:199], v6, s[60:63], s21 offen offset:1024 sc1
    v_mfma_f32_16x16x32_bf16 v[32:35], v[132:135], v[112:115], v[32:35]
    ds_read_b128 v[88:91], v209 offset:20480
    v_mfma_f32_16x16x32_bf16 v[40:43], v[132:135], v[116:119], v[40:43]
    ds_read_b128 v[92:95], v209 offset:22528
    v_mfma_f32_16x16x32_bf16 v[48:51], v[132:135], v[120:123], v[48:51]
    v_mfma_f32_16x16x32_bf16 v[56:59], v[132:135], v[124:127], v[56:59]
    buffer_load_dwordx4 v[200:203], v6, s[60:63], s21 offen offset:2048 sc1
    v_mfma_f32_16x16x32_bf16 v[36:39], v[140:143], v[112:115], v[36:39]
    v_mfma_f32_16x16x32_bf16 v[44:47], v[140:143], v[116:119], v[44:47]
    v_mfma_f32_16x16x32_bf16 v[52:55], v[140:143], v[120:123], v[52:55]
    v_mfma_f32_16x16x32_bf16 v[60:63], v[140:143], v[124:127], v[60:63]
    buffer_load_dwordx4 v[204:207], v6, s[60:63], s21 offen offset:3072 sc1
    s_waitcnt lgkmcnt(0)
    s_barrier
    s_waitcnt vmcnt(12)
    s_add_u32 s21, s27, 30
    s_and_b32 s21, s21, 31
    s_lshl_b32 s21, s21, 14
    s_add_u32 s21, s21, s20
    v_mfma_f32_16x16x32_bf16 v[32:35], v[144:147], v[64:67], v[32:35]
    ds_read_b128 v[96:99], v208 offset:24576
    v_mfma_f32_16x16x32_bf16 v[40:43], v[144:147], v[68:71], v[40:43]
    ds_read_b128 v[100:103], v208 offset:26624
    v_mfma_f32_16x16x32_bf16 v[48:51], v[144:147], v[72:75], v[48:51]
    ds_read_b128 v[104:107], v208 offset:28672
    v_mfma_f32_16x16x32_bf16 v[56:59], v[144:147], v[76:79], v[56:59]
    buffer_load_dwordx4 v[128:131], v6, s[60:63], s21 offen offset:0 sc1
    v_mfma_f32_16x16x32_bf16 v[36:39], v[152:155], v[64:67], v[36:39]
    ds_read_b128 v[108:111], v208 offset:30720
    v_mfma_f32_16x16x32_bf16 v[44:47], v[152:155], v[68:71], v[44:47]
    ds_read_b128 v[112:115], v209 offset:24576
    v_mfma_f32_16x16x32_bf16 v[52:55], v[152:155], v[72:75], v[52:55]
    ds_read_b128 v[116:119], v209 offset:26624
    v_mfma_f32_16x16x32_bf16 v[60:63], v[152:155], v[76:79], v[60:63]
    buffer_load_dwordx4 v[132:135], v6, s[60:63], s21 offen offset:1024 sc1
    v_mfma_f32_16x16x32_bf16 v[32:35], v[148:151], v[80:83], v[32:35]
    ds_read_b128 v[120:123], v209 offset:28672
    v_mfma_f32_16x16x32_bf16 v[40:43], v[148:151], v[84:87], v[40:43]
    ds_read_b128 v[124:127], v209 offset:30720
    v_mfma_f32_16x16x32_bf16 v[48:51], v[148:151], v[88:91], v[48:51]
    v_mfma_f32_16x16x32_bf16 v[56:59], v[148:151], v[92:95], v[56:59]
    buffer_load_dwordx4 v[136:139], v6, s[60:63], s21 offen offset:2048 sc1
    v_mfma_f32_16x16x32_bf16 v[36:39], v[156:159], v[80:83], v[36:39]
    v_mfma_f32_16x16x32_bf16 v[44:47], v[156:159], v[84:87], v[44:47]
    v_mfma_f32_16x16x32_bf16 v[52:55], v[156:159], v[88:91], v[52:55]
    v_mfma_f32_16x16x32_bf16 v[60:63], v[156:159], v[92:95], v[60:63]
    buffer_load_dwordx4 v[140:143], v6, s[60:63], s21 offen offset:3072 sc1
    s_waitcnt lgkmcnt(0)
    s_waitcnt vmcnt(12)
    s_add_u32 s21, s27, 31
    s_and_b32 s21, s21, 31
    s_lshl_b32 s21, s21, 14
    s_add_u32 s21, s21, s20
    v_mfma_f32_16x16x32_bf16 v[32:35], v[160:163], v[96:99], v[32:35]
    ds_read_b128 v[64:67], v208 offset:32768
    v_mfma_f32_16x16x32_bf16 v[40:43], v[160:163], v[100:103], v[40:43]
    ds_read_b128 v[68:71], v208 offset:34816
    v_mfma_f32_16x16x32_bf16 v[48:51], v[160:163], v[104:107], v[48:51]
    ds_read_b128 v[72:75], v208 offset:36864
    v_mfma_f32_16x16x32_bf16 v[56:59], v[160:163], v[108:111], v[56:59]
    buffer_load_dwordx4 v[144:147], v6, s[60:63], s21 offen offset:0 sc1
    v_mfma_f32_16x16x32_bf16 v[36:39], v[168:171], v[96:99], v[36:39]
    ds_read_b128 v[76:79], v208 offset:38912
    v_mfma_f32_16x16x32_bf16 v[44:47], v[168:171], v[100:103], v[44:47]
    ds_read_b128 v[80:83], v209 offset:32768
    v_mfma_f32_16x16x32_bf16 v[52:55], v[168:171], v[104:107], v[52:55]
    ds_read_b128 v[84:87], v209 offset:34816
    v_mfma_f32_16x16x32_bf16 v[60:63], v[168:171], v[108:111], v[60:63]
    buffer_load_dwordx4 v[148:151], v6, s[60:63], s21 offen offset:1024 sc1
    v_mfma_f32_16x16x32_bf16 v[32:35], v[164:167], v[112:115], v[32:35]
    ds_read_b128 v[88:91], v209 offset:36864
    v_mfma_f32_16x16x32_bf16 v[40:43], v[164:167], v[116:119], v[40:43]
    ds_read_b128 v[92:95], v209 offset:38912
    v_mfma_f32_16x16x32_bf16 v[48:51], v[164:167], v[120:123], v[48:51]
    v_mfma_f32_16x16x32_bf16 v[56:59], v[164:167], v[124:127], v[56:59]
    buffer_load_dwordx4 v[152:155], v6, s[60:63], s21 offen offset:2048 sc1
    v_mfma_f32_16x16x32_bf16 v[36:39], v[172:175], v[112:115], v[36:39]
    v_mfma_f32_16x16x32_bf16 v[44:47], v[172:175], v[116:119], v[44:47]
    v_mfma_f32_16x16x32_bf16 v[52:55], v[172:175], v[120:123], v[52:55]
    v_mfma_f32_16x16x32_bf16 v[60:63], v[172:175], v[124:127], v[60:63]
    buffer_load_dwordx4 v[156:159], v6, s[60:63], s21 offen offset:3072 sc1
    s_waitcnt lgkmcnt(0)
    s_barrier
    s_waitcnt vmcnt(12)
    v_mfma_f32_16x16x32_bf16 v[32:35], v[176:179], v[64:67], v[32:35]
    ds_read_b128 v[96:99], v208 offset:40960
    v_mfma_f32_16x16x32_bf16 v[40:43], v[176:179], v[68:71], v[40:43]
    ds_read_b128 v[100:103], v208 offset:43008
    v_mfma_f32_16x16x32_bf16 v[48:51], v[176:179], v[72:75], v[48:51]
    ds_read_b128 v[104:107], v208 offset:45056
    v_mfma_f32_16x16x32_bf16 v[56:59], v[176:179], v[76:79], v[56:59]
    ds_read_b128 v[108:111], v208 offset:47104
    v_mfma_f32_16x16x32_bf16 v[36:39], v[184:187], v[64:67], v[36:39]
    ds_read_b128 v[112:115], v209 offset:40960
    v_mfma_f32_16x16x32_bf16 v[44:47], v[184:187], v[68:71], v[44:47]
    ds_read_b128 v[116:119], v209 offset:43008
    v_mfma_f32_16x16x32_bf16 v[52:55], v[184:187], v[72:75], v[52:55]
    ds_read_b128 v[120:123], v209 offset:45056
    v_mfma_f32_16x16x32_bf16 v[60:63], v[184:187], v[76:79], v[60:63]
    ds_read_b128 v[124:127], v209 offset:47104
    v_mfma_f32_16x16x32_bf16 v[32:35], v[180:183], v[80:83], v[32:35]
    v_mfma_f32_16x16x32_bf16 v[40:43], v[180:183], v[84:87], v[40:43]
    v_mfma_f32_16x16x32_bf16 v[48:51], v[180:183], v[88:91], v[48:51]
    v_mfma_f32_16x16x32_bf16 v[56:59], v[180:183], v[92:95], v[56:59]
    v_mfma_f32_16x16x32_bf16 v[36:39], v[188:191], v[80:83], v[36:39]
    v_mfma_f32_16x16x32_bf16 v[44:47], v[188:191], v[84:87], v[44:47]
    v_mfma_f32_16x16x32_bf16 v[52:55], v[188:191], v[88:91], v[52:55]
    v_mfma_f32_16x16x32_bf16 v[60:63], v[188:191], v[92:95], v[60:63]
    s_waitcnt lgkmcnt(0)
    s_waitcnt vmcnt(8)
    v_mfma_f32_16x16x32_bf16 v[32:35], v[192:195], v[96:99], v[32:35]
    ds_read_b128 v[64:67], v208 offset:49152
    v_mfma_f32_16x16x32_bf16 v[40:43], v[192:195], v[100:103], v[40:43]
    ds_read_b128 v[68:71], v208 offset:51200
    v_mfma_f32_16x16x32_bf16 v[48:51], v[192:195], v[104:107], v[48:51]
    ds_read_b128 v[72:75], v208 offset:53248
    v_mfma_f32_16x16x32_bf16 v[56:59], v[192:195], v[108:111], v[56:59]
    ds_read_b128 v[76:79], v208 offset:55296
    v_mfma_f32_16x16x32_bf16 v[36:39], v[200:203], v[96:99], v[36:39]
    ds_read_b128 v[80:83], v209 offset:49152
    v_mfma_f32_16x16x32_bf16 v[44:47], v[200:203], v[100:103], v[44:47]
    ds_read_b128 v[84:87], v209 offset:51200
    v_mfma_f32_16x16x32_bf16 v[52:55], v[200:203], v[104:107], v[52:55]
    ds_read_b128 v[88:91], v209 offset:53248
    v_mfma_f32_16x16x32_bf16 v[60:63], v[200:203], v[108:111], v[60:63]
    ds_read_b128 v[92:95], v209 offset:55296
    v_mfma_f32_16x16x32_bf16 v[32:35], v[196:199], v[112:115], v[32:35]
    v_mfma_f32_16x16x32_bf16 v[40:43], v[196:199], v[116:119], v[40:43]
    v_mfma_f32_16x16x32_bf16 v[48:51], v[196:199], v[120:123], v[48:51]
    v_mfma_f32_16x16x32_bf16 v[56:59], v[196:199], v[124:127], v[56:59]
    v_mfma_f32_16x16x32_bf16 v[36:39], v[204:207], v[112:115], v[36:39]
    v_mfma_f32_16x16x32_bf16 v[44:47], v[204:207], v[116:119], v[44:47]
    v_mfma_f32_16x16x32_bf16 v[52:55], v[204:207], v[120:123], v[52:55]
    v_mfma_f32_16x16x32_bf16 v[60:63], v[204:207], v[124:127], v[60:63]
    s_waitcnt lgkmcnt(0)
    s_barrier
    s_waitcnt vmcnt(4)
    v_mfma_f32_16x16x32_bf16 v[32:35], v[128:131], v[64:67], v[32:35]
    ds_read_b128 v[96:99], v208 offset:57344
    v_mfma_f32_16x16x32_bf16 v[40:43], v[128:131], v[68:71], v[40:43]
    ds_read_b128 v[100:103], v208 offset:59392
    v_mfma_f32_16x16x32_bf16 v[48:51], v[128:131], v[72:75], v[48:51]
    ds_read_b128 v[104:107], v208 offset:61440
    v_mfma_f32_16x16x32_bf16 v[56:59], v[128:131], v[76:79], v[56:59]
    ds_read_b128 v[108:111], v208 offset:63488
    v_mfma_f32_16x16x32_bf16 v[36:39], v[136:139], v[64:67], v[36:39]
    ds_read_b128 v[112:115], v209 offset:57344
    v_mfma_f32_16x16x32_bf16 v[44:47], v[136:139], v[68:71], v[44:47]
    ds_read_b128 v[116:119], v209 offset:59392
    v_mfma_f32_16x16x32_bf16 v[52:55], v[136:139], v[72:75], v[52:55]
    ds_read_b128 v[120:123], v209 offset:61440
    v_mfma_f32_16x16x32_bf16 v[60:63], v[136:139], v[76:79], v[60:63]
    ds_read_b128 v[124:127], v209 offset:63488
    v_mfma_f32_16x16x32_bf16 v[32:35], v[132:135], v[80:83], v[32:35]
    v_mfma_f32_16x16x32_bf16 v[40:43], v[132:135], v[84:87], v[40:43]
    v_mfma_f32_16x16x32_bf16 v[48:51], v[132:135], v[88:91], v[48:51]
    v_mfma_f32_16x16x32_bf16 v[56:59], v[132:135], v[92:95], v[56:59]
    v_mfma_f32_16x16x32_bf16 v[36:39], v[140:143], v[80:83], v[36:39]
    v_mfma_f32_16x16x32_bf16 v[44:47], v[140:143], v[84:87], v[44:47]
    v_mfma_f32_16x16x32_bf16 v[52:55], v[140:143], v[88:91], v[52:55]
    v_mfma_f32_16x16x32_bf16 v[60:63], v[140:143], v[92:95], v[60:63]
    s_waitcnt lgkmcnt(0)
    s_waitcnt vmcnt(0)
    v_mfma_f32_16x16x32_bf16 v[32:35], v[144:147], v[96:99], v[32:35]
    v_mfma_f32_16x16x32_bf16 v[40:43], v[144:147], v[100:103], v[40:43]
    v_mfma_f32_16x16x32_bf16 v[48:51], v[144:147], v[104:107], v[48:51]
    v_mfma_f32_16x16x32_bf16 v[56:59], v[144:147], v[108:111], v[56:59]
    v_mfma_f32_16x16x32_bf16 v[36:39], v[152:155], v[96:99], v[36:39]
    v_mfma_f32_16x16x32_bf16 v[44:47], v[152:155], v[100:103], v[44:47]
    v_mfma_f32_16x16x32_bf16 v[52:55], v[152:155], v[104:107], v[52:55]
    v_mfma_f32_16x16x32_bf16 v[60:63], v[152:155], v[108:111], v[60:63]
    v_mfma_f32_16x16x32_bf16 v[32:35], v[148:151], v[112:115], v[32:35]
    v_mfma_f32_16x16x32_bf16 v[40:43], v[148:151], v[116:119], v[40:43]
    v_mfma_f32_16x16x32_bf16 v[48:51], v[148:151], v[120:123], v[48:51]
    v_mfma_f32_16x16x32_bf16 v[56:59], v[148:151], v[124:127], v[56:59]
    v_mfma_f32_16x16x32_bf16 v[36:39], v[156:159], v[112:115], v[36:39]
    v_mfma_f32_16x16x32_bf16 v[44:47], v[156:159], v[116:119], v[44:47]
    v_mfma_f32_16x16x32_bf16 v[52:55], v[156:159], v[120:123], v[52:55]
    v_mfma_f32_16x16x32_bf16 v[60:63], v[156:159], v[124:127], v[60:63]
    v_lshlrev_b32 v220, 16, v210
    v_lshlrev_b32 v216, 16, v16
    v_and_b32 v217, 0xffff0000, v16
    v_pk_add_f32 v[32:33], v[32:33], v[220:221] op_sel_hi:[1,0]
    v_lshlrev_b32 v218, 16, v17
    v_and_b32 v219, 0xffff0000, v17
    v_pk_add_f32 v[34:35], v[34:35], v[220:221] op_sel_hi:[1,0]
    v_pk_mul_f32 v[32:33], v[32:33], v[216:217]
    v_pk_mul_f32 v[34:35], v[34:35], v[218:219]
    v_lshlrev_b32 v216, 16, v18
    v_and_b32 v217, 0xffff0000, v18
    v_pk_add_f32 v[36:37], v[36:37], v[220:221] op_sel_hi:[1,0]
    v_lshlrev_b32 v218, 16, v19
    v_and_b32 v219, 0xffff0000, v19
    v_pk_add_f32 v[38:39], v[38:39], v[220:221] op_sel_hi:[1,0]
    v_pk_mul_f32 v[36:37], v[36:37], v[216:217]
    v_pk_mul_f32 v[38:39], v[38:39], v[218:219]
    v_lshlrev_b32 v222, 16, v211
    v_lshlrev_b32 v216, 16, v20
    v_and_b32 v217, 0xffff0000, v20
    v_pk_add_f32 v[40:41], v[40:41], v[222:223] op_sel_hi:[1,0]
    v_lshlrev_b32 v218, 16, v21
    v_and_b32 v219, 0xffff0000, v21
    v_pk_add_f32 v[42:43], v[42:43], v[222:223] op_sel_hi:[1,0]
    v_pk_mul_f32 v[40:41], v[40:41], v[216:217]
    v_pk_mul_f32 v[42:43], v[42:43], v[218:219]
    v_lshlrev_b32 v216, 16, v22
    v_and_b32 v217, 0xffff0000, v22
    v_pk_add_f32 v[44:45], v[44:45], v[222:223] op_sel_hi:[1,0]
    v_lshlrev_b32 v218, 16, v23
    v_and_b32 v219, 0xffff0000, v23
    v_pk_add_f32 v[46:47], v[46:47], v[222:223] op_sel_hi:[1,0]
    v_pk_mul_f32 v[44:45], v[44:45], v[216:217]
    v_pk_mul_f32 v[46:47], v[46:47], v[218:219]
    v_lshlrev_b32 v224, 16, v212
    v_lshlrev_b32 v216, 16, v24
    v_and_b32 v217, 0xffff0000, v24
    v_pk_add_f32 v[48:49], v[48:49], v[224:225] op_sel_hi:[1,0]
    v_lshlrev_b32 v218, 16, v25
    v_and_b32 v219, 0xffff0000, v25
    v_pk_add_f32 v[50:51], v[50:51], v[224:225] op_sel_hi:[1,0]
    v_pk_mul_f32 v[48:49], v[48:49], v[216:217]
    v_pk_mul_f32 v[50:51], v[50:51], v[218:219]
    v_lshlrev_b32 v216, 16, v26
    v_and_b32 v217, 0xffff0000, v26
    v_pk_add_f32 v[52:53], v[52:53], v[224:225] op_sel_hi:[1,0]
    v_lshlrev_b32 v218, 16, v27
    v_and_b32 v219, 0xffff0000, v27
    v_pk_add_f32 v[54:55], v[54:55], v[224:225] op_sel_hi:[1,0]
    v_pk_mul_f32 v[52:53], v[52:53], v[216:217]
    v_pk_mul_f32 v[54:55], v[54:55], v[218:219]
    v_lshlrev_b32 v226, 16, v213
    v_lshlrev_b32 v216, 16, v28
    v_and_b32 v217, 0xffff0000, v28
    v_pk_add_f32 v[56:57], v[56:57], v[226:227] op_sel_hi:[1,0]
    v_lshlrev_b32 v218, 16, v29
    v_and_b32 v219, 0xffff0000, v29
    v_pk_add_f32 v[58:59], v[58:59], v[226:227] op_sel_hi:[1,0]
    v_pk_mul_f32 v[56:57], v[56:57], v[216:217]
    v_pk_mul_f32 v[58:59], v[58:59], v[218:219]
    v_lshlrev_b32 v216, 16, v30
    v_and_b32 v217, 0xffff0000, v30
    v_pk_add_f32 v[60:61], v[60:61], v[226:227] op_sel_hi:[1,0]
    v_lshlrev_b32 v218, 16, v31
    v_and_b32 v219, 0xffff0000, v31
    v_pk_add_f32 v[62:63], v[62:63], v[226:227] op_sel_hi:[1,0]
    v_pk_mul_f32 v[60:61], v[60:61], v[216:217]
    v_pk_mul_f32 v[62:63], v[62:63], v[218:219]
    s_lshl_b32 s7, s77, 8
    s_lshl_b32 s8, s44, 6
    s_add_u32 s7, s7, s8
    s_add_u32 s8, s7, 57344
    v_cvt_pk_bf16_f32 v128, v32, v33
    v_cvt_pk_bf16_f32 v129, v34, v35
    v_cvt_pk_bf16_f32 v130, v40, v41
    v_cvt_pk_bf16_f32 v131, v42, v43
    s_nop 0
    v_permlane16_swap_b32 v128, v130
    v_permlane16_swap_b32 v129, v131
    v_cvt_pk_bf16_f32 v132, v36, v37
    v_cvt_pk_bf16_f32 v133, v38, v39
    v_cvt_pk_bf16_f32 v134, v44, v45
    v_cvt_pk_bf16_f32 v135, v46, v47
    s_nop 0
    v_permlane16_swap_b32 v132, v134
    v_permlane16_swap_b32 v133, v135
    s_nop 0
    v_permlane16_swap_b32 v128, v132
    v_permlane16_swap_b32 v129, v133
    v_permlane16_swap_b32 v130, v134
    v_permlane16_swap_b32 v131, v135
    buffer_store_dwordx4 v[128:131], v214, s[64:67], s7 offen offset:0 sc1
    buffer_store_dwordx4 v[132:135], v215, s[64:67], s7 offen offset:0 sc1
    v_cvt_pk_bf16_f32 v136, v48, v49
    v_cvt_pk_bf16_f32 v137, v50, v51
    v_cvt_pk_bf16_f32 v138, v56, v57
    v_cvt_pk_bf16_f32 v139, v58, v59
    s_nop 0
    v_permlane16_swap_b32 v136, v138
    v_permlane16_swap_b32 v137, v139
    v_cvt_pk_bf16_f32 v140, v52, v53
    v_cvt_pk_bf16_f32 v141, v54, v55
    v_cvt_pk_bf16_f32 v142, v60, v61
    v_cvt_pk_bf16_f32 v143, v62, v63
    s_nop 0
    v_permlane16_swap_b32 v140, v142
    v_permlane16_swap_b32 v141, v143
    s_nop 0
    v_permlane16_swap_b32 v136, v140
    v_permlane16_swap_b32 v137, v141
    v_permlane16_swap_b32 v138, v142
    v_permlane16_swap_b32 v139, v143
    buffer_store_dwordx4 v[136:139], v214, s[64:67], s8 offen offset:0 sc1
    buffer_store_dwordx4 v[140:143], v215, s[64:67], s8 offen offset:0 sc1
    s_barrier
    s_waitcnt vmcnt(0)
    s_mov_b64 exec, 1
    v_mov_b32 v2, 156688
    v_mov_b32 v3, 1
    ds_add_rtn_u32 v4, v2, v3
    s_waitcnt lgkmcnt(0)
    v_readfirstlane_b32 s4, v4
    s_nop 2
    s_cmp_lg_u32 s4, 3
    s_cbranch_scc1 sig_sequential_preLN__grouped_kv_mqa__mixer_gmlp__prompt_kernel_26
    s_lshl_b32 s4, s77, 2
    s_add_u32 s4, s4, s88
    s_add_u32 s4, s4, 16384
    v_mov_b32 v2, 0
    v_mov_b32 v3, s26
    buffer_store_dword v3, v2, s[72:75], s4 offen sc1
sig_sequential_preLN__grouped_kv_mqa__mixer_gmlp__prompt_kernel_26:
    s_mov_b64 exec, -1
sequential_preLN__grouped_kv_mqa__mixer_gmlp__prompt_kernel_c6:
    v_and_b32 v2, 15, v1
    v_lshrrev_b32 v3, 4, v1
    v_lshrrev_b32 v4, 1, v2
    s_lshl_b32 s5, s79, 12
    v_add_u32 v5, 0, v3
    v_xor_b32 v5, v5, v4
    v_lshlrev_b32 v5, 4, v5
    v_lshl_add_u32 v5, v2, 7, v5
    v_add_u32 v5, s5, v5
    v_add_u32 v112, 0, v5
    v_add_u32 v114, 65536, v5
    v_add_u32 v5, 4, v3
    v_xor_b32 v5, v5, v4
    v_lshlrev_b32 v5, 4, v5
    v_lshl_add_u32 v5, v2, 7, v5
    v_add_u32 v5, s5, v5
    v_add_u32 v113, 0, v5
    v_add_u32 v115, 65536, v5
    v_lshrrev_b32 v4, 2, v2
    v_and_b32 v2, 3, v2
    v_lshl_add_u32 v5, v3, 3, v4
    v_lshlrev_b32 v5, 7, v5
    v_lshl_add_u32 v5, v2, 3, v5
    v_and_b32 v3, 1, v3
    v_lshrrev_b32 v4, 1, v4
    v_lshl_or_b32 v4, v3, 1, v4
    s_mul_i32 s5, s80, 2
    v_mov_b32 v2, s5
    v_xor_b32 v2, v2, v4
    v_lshl_add_u32 v2, v2, 5, v5
    v_add_u32 v116, 65536, v2
    v_add_u32 v118, 131072, v2
    v_mov_b32 v2, s5
    v_add_u32 v2, 1, v2
    v_xor_b32 v2, v2, v4
    v_lshl_add_u32 v2, v2, 5, v5
    v_add_u32 v117, 65536, v2
    v_add_u32 v119, 131072, v2
    v_mov_b32 v32, 0
    v_mov_b32 v33, 0
    v_mov_b32 v34, 0
    v_mov_b32 v35, 0
    v_mov_b32 v36, 0
    v_mov_b32 v37, 0
    v_mov_b32 v38, 0
    v_mov_b32 v39, 0
    v_mov_b32 v40, 0
    v_mov_b32 v41, 0
    v_mov_b32 v42, 0
    v_mov_b32 v43, 0
    v_mov_b32 v44, 0
    v_mov_b32 v45, 0
    v_mov_b32 v46, 0
    v_mov_b32 v47, 0
    s_mov_b32 s60, s36
    s_mov_b32 s61, s37
    s_mov_b32 s62, 2097152
    s_mov_b32 s63, 0x00020000
    s_lshl_b32 s5, s79, 5
    s_add_u32 s5, s5, s47
    v_and_b32 v2, 15, v1
    v_add_u32 v2, s5, v2
    s_mov_b32 s6, 1024
    v_mul_lo_u32 v2, v2, s6
    v_bfe_u32 v3, v1, 4, 1
    v_lshl_add_u32 v2, v3, 5, v2
    v_lshrrev_b32 v3, 5, v1
    v_lshl_add_u32 v120, v3, 4, v2
    v_add_u32 v121, 16384, v120
    s_cmp_lg_u32 s44, 0
    s_cbranch_scc1 rel_sequential_preLN__grouped_kv_mqa__mixer_gmlp__prompt_kernel_27
    s_add_u32 s4, s82, 16384
    v_lshlrev_b32 v2, 2, v1
    s_mov_b64 exec, 127
    s_mov_b32 s83, 0x40000
poll_sequential_preLN__grouped_kv_mqa__mixer_gmlp__prompt_kernel_28:
    buffer_load_dword v3, v2, s[72:75], s4 offen sc1
    s_waitcnt vmcnt(0)
    v_cmp_ne_u32 vcc, s26, v3
    s_nop 2
    s_cmp_eq_u64 vcc, 0
    s_cbranch_scc1 polld_sequential_preLN__grouped_kv_mqa__mixer_gmlp__prompt_kernel_29
    s_sleep 0
    s_sub_u32 s83, s83, 1
    s_cmp_lg_u32 s83, 0
    s_cbranch_scc1 poll_sequential_preLN__grouped_kv_mqa__mixer_gmlp__prompt_kernel_28
polld_sequential_preLN__grouped_kv_mqa__mixer_gmlp__prompt_kernel_29:
    s_mov_b64 exec, -1
rel_sequential_preLN__grouped_kv_mqa__mixer_gmlp__prompt_kernel_27:
    s_barrier
    s_barrier
    ds_read_b128 v[48:51], v112 offset:0
    ds_read_b128 v[52:55], v112 offset:2048
    ds_read_b64_tr_b16 v[80:81], v116 offset:49152
    ds_read_b64_tr_b16 v[82:83], v116 offset:49664
    ds_read_b64_tr_b16 v[84:85], v117 offset:49152
    ds_read_b64_tr_b16 v[86:87], v117 offset:49664
    ds_read_b128 v[56:59], v113 offset:0
    ds_read_b128 v[60:63], v113 offset:2048
    ds_read_b64_tr_b16 v[88:89], v116 offset:53248
    ds_read_b64_tr_b16 v[90:91], v116 offset:53760
    ds_read_b64_tr_b16 v[92:93], v117 offset:53248
    ds_read_b64_tr_b16 v[94:95], v117 offset:53760
    s_waitcnt lgkmcnt(0)
    s_barrier
    v_mfma_f32_16x16x32_bf16 v[32:35], v[80:83], v[48:51], v[32:35]
    ds_read_b128 v[64:67], v112 offset:8192
    ds_read_b128 v[68:71], v112 offset:10240
    v_mfma_f32_16x16x32_bf16 v[40:43], v[80:83], v[52:55], v[40:43]
    ds_read_b64_tr_b16 v[96:97], v116 offset:57344
    ds_read_b64_tr_b16 v[98:99], v116 offset:57856
    v_mfma_f32_16x16x32_bf16 v[36:39], v[84:87], v[48:51], v[36:39]
    ds_read_b64_tr_b16 v[100:101], v117 offset:57344
    ds_read_b64_tr_b16 v[102:103], v117 offset:57856
    v_mfma_f32_16x16x32_bf16 v[44:47], v[84:87], v[52:55], v[44:47]
    ds_read_b128 v[72:75], v113 offset:8192
    ds_read_b128 v[76:79], v113 offset:10240
    v_mfma_f32_16x16x32_bf16 v[32:35], v[88:91], v[56:59], v[32:35]
    ds_read_b64_tr_b16 v[104:105], v116 offset:61440
    ds_read_b64_tr_b16 v[106:107], v116 offset:61952
    v_mfma_f32_16x16x32_bf16 v[40:43], v[88:91], v[60:63], v[40:43]
    ds_read_b64_tr_b16 v[108:109], v117 offset:61440
    ds_read_b64_tr_b16 v[110:111], v117 offset:61952
    v_mfma_f32_16x16x32_bf16 v[36:39], v[92:95], v[56:59], v[36:39]
    v_mfma_f32_16x16x32_bf16 v[44:47], v[92:95], v[60:63], v[44:47]
    s_waitcnt lgkmcnt(0)
    s_barrier
    v_mfma_f32_16x16x32_bf16 v[32:35], v[96:99], v[64:67], v[32:35]
    ds_read_b128 v[48:51], v112 offset:16384
    ds_read_b128 v[52:55], v112 offset:18432
    v_mfma_f32_16x16x32_bf16 v[40:43], v[96:99], v[68:71], v[40:43]
    ds_read_b64_tr_b16 v[80:81], v118 offset:0
    ds_read_b64_tr_b16 v[82:83], v118 offset:512
    v_mfma_f32_16x16x32_bf16 v[36:39], v[100:103], v[64:67], v[36:39]
    ds_read_b64_tr_b16 v[84:85], v119 offset:0
    ds_read_b64_tr_b16 v[86:87], v119 offset:512
    v_mfma_f32_16x16x32_bf16 v[44:47], v[100:103], v[68:71], v[44:47]
    ds_read_b128 v[56:59], v113 offset:16384
    ds_read_b128 v[60:63], v113 offset:18432
    v_mfma_f32_16x16x32_bf16 v[32:35], v[104:107], v[72:75], v[32:35]
    ds_read_b64_tr_b16 v[88:89], v118 offset:4096
    ds_read_b64_tr_b16 v[90:91], v118 offset:4608
    v_mfma_f32_16x16x32_bf16 v[40:43], v[104:107], v[76:79], v[40:43]
    ds_read_b64_tr_b16 v[92:93], v119 offset:4096
    ds_read_b64_tr_b16 v[94:95], v119 offset:4608
    v_mfma_f32_16x16x32_bf16 v[36:39], v[108:111], v[72:75], v[36:39]
    v_mfma_f32_16x16x32_bf16 v[44:47], v[108:111], v[76:79], v[44:47]
    s_waitcnt lgkmcnt(0)
    s_barrier
    v_mfma_f32_16x16x32_bf16 v[32:35], v[80:83], v[48:51], v[32:35]
    ds_read_b128 v[64:67], v112 offset:24576
    ds_read_b128 v[68:71], v112 offset:26624
    v_mfma_f32_16x16x32_bf16 v[40:43], v[80:83], v[52:55], v[40:43]
    ds_read_b64_tr_b16 v[96:97], v118 offset:8192
    ds_read_b64_tr_b16 v[98:99], v118 offset:8704
    v_mfma_f32_16x16x32_bf16 v[36:39], v[84:87], v[48:51], v[36:39]
    ds_read_b64_tr_b16 v[100:101], v119 offset:8192
    ds_read_b64_tr_b16 v[102:103], v119 offset:8704
    v_mfma_f32_16x16x32_bf16 v[44:47], v[84:87], v[52:55], v[44:47]
    ds_read_b128 v[72:75], v113 offset:24576
    ds_read_b128 v[76:79], v113 offset:26624
    v_mfma_f32_16x16x32_bf16 v[32:35], v[88:91], v[56:59], v[32:35]
    ds_read_b64_tr_b16 v[104:105], v118 offset:12288
    ds_read_b64_tr_b16 v[106:107], v118 offset:12800
    v_mfma_f32_16x16x32_bf16 v[40:43], v[88:91], v[60:63], v[40:43]
    ds_read_b64_tr_b16 v[108:109], v119 offset:12288
    ds_read_b64_tr_b16 v[110:111], v119 offset:12800
    v_mfma_f32_16x16x32_bf16 v[36:39], v[92:95], v[56:59], v[36:39]
    v_mfma_f32_16x16x32_bf16 v[44:47], v[92:95], v[60:63], v[44:47]
    s_waitcnt lgkmcnt(0)
    s_barrier
    v_mfma_f32_16x16x32_bf16 v[32:35], v[96:99], v[64:67], v[32:35]
    ds_read_b128 v[48:51], v112 offset:32768
    ds_read_b128 v[52:55], v112 offset:34816
    v_mfma_f32_16x16x32_bf16 v[40:43], v[96:99], v[68:71], v[40:43]
    ds_read_b64_tr_b16 v[80:81], v118 offset:16384
    ds_read_b64_tr_b16 v[82:83], v118 offset:16896
    v_mfma_f32_16x16x32_bf16 v[36:39], v[100:103], v[64:67], v[36:39]
    ds_read_b64_tr_b16 v[84:85], v119 offset:16384
    ds_read_b64_tr_b16 v[86:87], v119 offset:16896
    v_mfma_f32_16x16x32_bf16 v[44:47], v[100:103], v[68:71], v[44:47]
    ds_read_b128 v[56:59], v113 offset:32768
    ds_read_b128 v[60:63], v113 offset:34816
    v_mfma_f32_16x16x32_bf16 v[32:35], v[104:107], v[72:75], v[32:35]
    ds_read_b64_tr_b16 v[88:89], v118 offset:20480
    ds_read_b64_tr_b16 v[90:91], v118 offset:20992
    v_mfma_f32_16x16x32_bf16 v[40:43], v[104:107], v[76:79], v[40:43]
    ds_read_b64_tr_b16 v[92:93], v119 offset:20480
    ds_read_b64_tr_b16 v[94:95], v119 offset:20992
    v_mfma_f32_16x16x32_bf16 v[36:39], v[108:111], v[72:75], v[36:39]
    v_mfma_f32_16x16x32_bf16 v[44:47], v[108:111], v[76:79], v[44:47]
    s_waitcnt lgkmcnt(0)
    s_barrier
    v_mfma_f32_16x16x32_bf16 v[32:35], v[80:83], v[48:51], v[32:35]
    ds_read_b128 v[64:67], v112 offset:40960
    ds_read_b128 v[68:71], v112 offset:43008
    v_mfma_f32_16x16x32_bf16 v[40:43], v[80:83], v[52:55], v[40:43]
    ds_read_b64_tr_b16 v[96:97], v116 offset:49152
    ds_read_b64_tr_b16 v[98:99], v116 offset:49664
    v_mfma_f32_16x16x32_bf16 v[36:39], v[84:87], v[48:51], v[36:39]
    ds_read_b64_tr_b16 v[100:101], v117 offset:49152
    ds_read_b64_tr_b16 v[102:103], v117 offset:49664
    v_mfma_f32_16x16x32_bf16 v[44:47], v[84:87], v[52:55], v[44:47]
    ds_read_b128 v[72:75], v113 offset:40960
    ds_read_b128 v[76:79], v113 offset:43008
    v_mfma_f32_16x16x32_bf16 v[32:35], v[88:91], v[56:59], v[32:35]
    ds_read_b64_tr_b16 v[104:105], v116 offset:53248
    ds_read_b64_tr_b16 v[106:107], v116 offset:53760
    v_mfma_f32_16x16x32_bf16 v[40:43], v[88:91], v[60:63], v[40:43]
    ds_read_b64_tr_b16 v[108:109], v117 offset:53248
    ds_read_b64_tr_b16 v[110:111], v117 offset:53760
    v_mfma_f32_16x16x32_bf16 v[36:39], v[92:95], v[56:59], v[36:39]
    v_mfma_f32_16x16x32_bf16 v[44:47], v[92:95], v[60:63], v[44:47]
    s_waitcnt lgkmcnt(0)
    s_barrier
    v_mfma_f32_16x16x32_bf16 v[32:35], v[96:99], v[64:67], v[32:35]
    ds_read_b128 v[48:51], v112 offset:49152
    ds_read_b128 v[52:55], v112 offset:51200
    v_mfma_f32_16x16x32_bf16 v[40:43], v[96:99], v[68:71], v[40:43]
    ds_read_b64_tr_b16 v[80:81], v116 offset:57344
    ds_read_b64_tr_b16 v[82:83], v116 offset:57856
    v_mfma_f32_16x16x32_bf16 v[36:39], v[100:103], v[64:67], v[36:39]
    ds_read_b64_tr_b16 v[84:85], v117 offset:57344
    ds_read_b64_tr_b16 v[86:87], v117 offset:57856
    v_mfma_f32_16x16x32_bf16 v[44:47], v[100:103], v[68:71], v[44:47]
    ds_read_b128 v[56:59], v113 offset:49152
    ds_read_b128 v[60:63], v113 offset:51200
    v_mfma_f32_16x16x32_bf16 v[32:35], v[104:107], v[72:75], v[32:35]
    ds_read_b64_tr_b16 v[88:89], v116 offset:61440
    ds_read_b64_tr_b16 v[90:91], v116 offset:61952
    v_mfma_f32_16x16x32_bf16 v[40:43], v[104:107], v[76:79], v[40:43]
    ds_read_b64_tr_b16 v[92:93], v117 offset:61440
    ds_read_b64_tr_b16 v[94:95], v117 offset:61952
    v_mfma_f32_16x16x32_bf16 v[36:39], v[108:111], v[72:75], v[36:39]
    v_mfma_f32_16x16x32_bf16 v[44:47], v[108:111], v[76:79], v[44:47]
    s_waitcnt lgkmcnt(0)
    s_barrier
    v_mfma_f32_16x16x32_bf16 v[32:35], v[80:83], v[48:51], v[32:35]
    ds_read_b128 v[64:67], v112 offset:57344
    ds_read_b128 v[68:71], v112 offset:59392
    v_mfma_f32_16x16x32_bf16 v[40:43], v[80:83], v[52:55], v[40:43]
    ds_read_b64_tr_b16 v[96:97], v118 offset:0
    ds_read_b64_tr_b16 v[98:99], v118 offset:512
    v_mfma_f32_16x16x32_bf16 v[36:39], v[84:87], v[48:51], v[36:39]
    ds_read_b64_tr_b16 v[100:101], v119 offset:0
    ds_read_b64_tr_b16 v[102:103], v119 offset:512
    v_mfma_f32_16x16x32_bf16 v[44:47], v[84:87], v[52:55], v[44:47]
    ds_read_b128 v[72:75], v113 offset:57344
    ds_read_b128 v[76:79], v113 offset:59392
    v_mfma_f32_16x16x32_bf16 v[32:35], v[88:91], v[56:59], v[32:35]
    ds_read_b64_tr_b16 v[104:105], v118 offset:4096
    ds_read_b64_tr_b16 v[106:107], v118 offset:4608
    v_mfma_f32_16x16x32_bf16 v[40:43], v[88:91], v[60:63], v[40:43]
    ds_read_b64_tr_b16 v[108:109], v119 offset:4096
    ds_read_b64_tr_b16 v[110:111], v119 offset:4608
    v_mfma_f32_16x16x32_bf16 v[36:39], v[92:95], v[56:59], v[36:39]
    v_mfma_f32_16x16x32_bf16 v[44:47], v[92:95], v[60:63], v[44:47]
    s_waitcnt lgkmcnt(0)
    s_barrier
    v_mfma_f32_16x16x32_bf16 v[32:35], v[96:99], v[64:67], v[32:35]
    ds_read_b128 v[48:51], v114 offset:0
    ds_read_b128 v[52:55], v114 offset:2048
    v_mfma_f32_16x16x32_bf16 v[40:43], v[96:99], v[68:71], v[40:43]
    ds_read_b64_tr_b16 v[80:81], v118 offset:8192
    ds_read_b64_tr_b16 v[82:83], v118 offset:8704
    v_mfma_f32_16x16x32_bf16 v[36:39], v[100:103], v[64:67], v[36:39]
    ds_read_b64_tr_b16 v[84:85], v119 offset:8192
    ds_read_b64_tr_b16 v[86:87], v119 offset:8704
    v_mfma_f32_16x16x32_bf16 v[44:47], v[100:103], v[68:71], v[44:47]
    ds_read_b128 v[56:59], v115 offset:0
    ds_read_b128 v[60:63], v115 offset:2048
    v_mfma_f32_16x16x32_bf16 v[32:35], v[104:107], v[72:75], v[32:35]
    ds_read_b64_tr_b16 v[88:89], v118 offset:12288
    ds_read_b64_tr_b16 v[90:91], v118 offset:12800
    v_mfma_f32_16x16x32_bf16 v[40:43], v[104:107], v[76:79], v[40:43]
    ds_read_b64_tr_b16 v[92:93], v119 offset:12288
    ds_read_b64_tr_b16 v[94:95], v119 offset:12800
    v_mfma_f32_16x16x32_bf16 v[36:39], v[108:111], v[72:75], v[36:39]
    v_mfma_f32_16x16x32_bf16 v[44:47], v[108:111], v[76:79], v[44:47]
    s_waitcnt lgkmcnt(0)
    s_barrier
    v_mfma_f32_16x16x32_bf16 v[32:35], v[80:83], v[48:51], v[32:35]
    ds_read_b128 v[64:67], v114 offset:8192
    ds_read_b128 v[68:71], v114 offset:10240
    v_mfma_f32_16x16x32_bf16 v[40:43], v[80:83], v[52:55], v[40:43]
    ds_read_b64_tr_b16 v[96:97], v118 offset:16384
    ds_read_b64_tr_b16 v[98:99], v118 offset:16896
    v_mfma_f32_16x16x32_bf16 v[36:39], v[84:87], v[48:51], v[36:39]
    ds_read_b64_tr_b16 v[100:101], v119 offset:16384
    ds_read_b64_tr_b16 v[102:103], v119 offset:16896
    v_mfma_f32_16x16x32_bf16 v[44:47], v[84:87], v[52:55], v[44:47]
    ds_read_b128 v[72:75], v115 offset:8192
    ds_read_b128 v[76:79], v115 offset:10240
    v_mfma_f32_16x16x32_bf16 v[32:35], v[88:91], v[56:59], v[32:35]
    ds_read_b64_tr_b16 v[104:105], v118 offset:20480
    ds_read_b64_tr_b16 v[106:107], v118 offset:20992
    v_mfma_f32_16x16x32_bf16 v[40:43], v[88:91], v[60:63], v[40:43]
    ds_read_b64_tr_b16 v[108:109], v119 offset:20480
    ds_read_b64_tr_b16 v[110:111], v119 offset:20992
    v_mfma_f32_16x16x32_bf16 v[36:39], v[92:95], v[56:59], v[36:39]
    v_mfma_f32_16x16x32_bf16 v[44:47], v[92:95], v[60:63], v[44:47]
    s_waitcnt lgkmcnt(0)
    s_barrier
    v_mfma_f32_16x16x32_bf16 v[32:35], v[96:99], v[64:67], v[32:35]
    ds_read_b128 v[48:51], v114 offset:16384
    ds_read_b128 v[52:55], v114 offset:18432
    v_mfma_f32_16x16x32_bf16 v[40:43], v[96:99], v[68:71], v[40:43]
    ds_read_b64_tr_b16 v[80:81], v116 offset:49152
    ds_read_b64_tr_b16 v[82:83], v116 offset:49664
    v_mfma_f32_16x16x32_bf16 v[36:39], v[100:103], v[64:67], v[36:39]
    ds_read_b64_tr_b16 v[84:85], v117 offset:49152
    ds_read_b64_tr_b16 v[86:87], v117 offset:49664
    v_mfma_f32_16x16x32_bf16 v[44:47], v[100:103], v[68:71], v[44:47]
    ds_read_b128 v[56:59], v115 offset:16384
    ds_read_b128 v[60:63], v115 offset:18432
    v_mfma_f32_16x16x32_bf16 v[32:35], v[104:107], v[72:75], v[32:35]
    ds_read_b64_tr_b16 v[88:89], v116 offset:53248
    ds_read_b64_tr_b16 v[90:91], v116 offset:53760
    v_mfma_f32_16x16x32_bf16 v[40:43], v[104:107], v[76:79], v[40:43]
    ds_read_b64_tr_b16 v[92:93], v117 offset:53248
    ds_read_b64_tr_b16 v[94:95], v117 offset:53760
    v_mfma_f32_16x16x32_bf16 v[36:39], v[108:111], v[72:75], v[36:39]
    v_mfma_f32_16x16x32_bf16 v[44:47], v[108:111], v[76:79], v[44:47]
    s_waitcnt lgkmcnt(0)
    s_barrier
    v_mfma_f32_16x16x32_bf16 v[32:35], v[80:83], v[48:51], v[32:35]
    ds_read_b128 v[64:67], v114 offset:24576
    ds_read_b128 v[68:71], v114 offset:26624
    v_mfma_f32_16x16x32_bf16 v[40:43], v[80:83], v[52:55], v[40:43]
    ds_read_b64_tr_b16 v[96:97], v116 offset:57344
    ds_read_b64_tr_b16 v[98:99], v116 offset:57856
    v_mfma_f32_16x16x32_bf16 v[36:39], v[84:87], v[48:51], v[36:39]
    ds_read_b64_tr_b16 v[100:101], v117 offset:57344
    ds_read_b64_tr_b16 v[102:103], v117 offset:57856
    v_mfma_f32_16x16x32_bf16 v[44:47], v[84:87], v[52:55], v[44:47]
    ds_read_b128 v[72:75], v115 offset:24576
    ds_read_b128 v[76:79], v115 offset:26624
    v_mfma_f32_16x16x32_bf16 v[32:35], v[88:91], v[56:59], v[32:35]
    ds_read_b64_tr_b16 v[104:105], v116 offset:61440
    ds_read_b64_tr_b16 v[106:107], v116 offset:61952
    v_mfma_f32_16x16x32_bf16 v[40:43], v[88:91], v[60:63], v[40:43]
    ds_read_b64_tr_b16 v[108:109], v117 offset:61440
    ds_read_b64_tr_b16 v[110:111], v117 offset:61952
    v_mfma_f32_16x16x32_bf16 v[36:39], v[92:95], v[56:59], v[36:39]
    v_mfma_f32_16x16x32_bf16 v[44:47], v[92:95], v[60:63], v[44:47]
    s_waitcnt lgkmcnt(0)
    s_barrier
    v_mfma_f32_16x16x32_bf16 v[32:35], v[96:99], v[64:67], v[32:35]
    ds_read_b128 v[48:51], v114 offset:32768
    ds_read_b128 v[52:55], v114 offset:34816
    v_mfma_f32_16x16x32_bf16 v[40:43], v[96:99], v[68:71], v[40:43]
    ds_read_b64_tr_b16 v[80:81], v118 offset:0
    ds_read_b64_tr_b16 v[82:83], v118 offset:512
    v_mfma_f32_16x16x32_bf16 v[36:39], v[100:103], v[64:67], v[36:39]
    ds_read_b64_tr_b16 v[84:85], v119 offset:0
    ds_read_b64_tr_b16 v[86:87], v119 offset:512
    v_mfma_f32_16x16x32_bf16 v[44:47], v[100:103], v[68:71], v[44:47]
    ds_read_b128 v[56:59], v115 offset:32768
    ds_read_b128 v[60:63], v115 offset:34816
    v_mfma_f32_16x16x32_bf16 v[32:35], v[104:107], v[72:75], v[32:35]
    ds_read_b64_tr_b16 v[88:89], v118 offset:4096
    ds_read_b64_tr_b16 v[90:91], v118 offset:4608
    v_mfma_f32_16x16x32_bf16 v[40:43], v[104:107], v[76:79], v[40:43]
    ds_read_b64_tr_b16 v[92:93], v119 offset:4096
    ds_read_b64_tr_b16 v[94:95], v119 offset:4608
    v_mfma_f32_16x16x32_bf16 v[36:39], v[108:111], v[72:75], v[36:39]
    v_mfma_f32_16x16x32_bf16 v[44:47], v[108:111], v[76:79], v[44:47]
    s_waitcnt lgkmcnt(0)
    s_barrier
    v_mfma_f32_16x16x32_bf16 v[32:35], v[80:83], v[48:51], v[32:35]
    ds_read_b128 v[64:67], v114 offset:40960
    ds_read_b128 v[68:71], v114 offset:43008
    v_mfma_f32_16x16x32_bf16 v[40:43], v[80:83], v[52:55], v[40:43]
    ds_read_b64_tr_b16 v[96:97], v118 offset:8192
    ds_read_b64_tr_b16 v[98:99], v118 offset:8704
    v_mfma_f32_16x16x32_bf16 v[36:39], v[84:87], v[48:51], v[36:39]
    ds_read_b64_tr_b16 v[100:101], v119 offset:8192
    ds_read_b64_tr_b16 v[102:103], v119 offset:8704
    v_mfma_f32_16x16x32_bf16 v[44:47], v[84:87], v[52:55], v[44:47]
    ds_read_b128 v[72:75], v115 offset:40960
    ds_read_b128 v[76:79], v115 offset:43008
    v_mfma_f32_16x16x32_bf16 v[32:35], v[88:91], v[56:59], v[32:35]
    ds_read_b64_tr_b16 v[104:105], v118 offset:12288
    ds_read_b64_tr_b16 v[106:107], v118 offset:12800
    v_mfma_f32_16x16x32_bf16 v[40:43], v[88:91], v[60:63], v[40:43]
    ds_read_b64_tr_b16 v[108:109], v119 offset:12288
    ds_read_b64_tr_b16 v[110:111], v119 offset:12800
    v_mfma_f32_16x16x32_bf16 v[36:39], v[92:95], v[56:59], v[36:39]
    v_mfma_f32_16x16x32_bf16 v[44:47], v[92:95], v[60:63], v[44:47]
    s_waitcnt lgkmcnt(0)
    v_mfma_f32_16x16x32_bf16 v[32:35], v[96:99], v[64:67], v[32:35]
    v_mfma_f32_16x16x32_bf16 v[40:43], v[96:99], v[68:71], v[40:43]
    v_mfma_f32_16x16x32_bf16 v[36:39], v[100:103], v[64:67], v[36:39]
    v_mfma_f32_16x16x32_bf16 v[44:47], v[100:103], v[68:71], v[44:47]
    v_mfma_f32_16x16x32_bf16 v[32:35], v[104:107], v[72:75], v[32:35]
    v_mfma_f32_16x16x32_bf16 v[40:43], v[104:107], v[76:79], v[40:43]
    v_mfma_f32_16x16x32_bf16 v[36:39], v[108:111], v[72:75], v[36:39]
    v_mfma_f32_16x16x32_bf16 v[44:47], v[108:111], v[76:79], v[44:47]
    v_lshlrev_b32 v2, 16, v8
    v_and_b32 v3, 0xffff0000, v8
    s_nop 2
    v_add_f32 v32, v32, v2
    v_add_f32 v33, v33, v3
    v_lshlrev_b32 v2, 16, v9
    v_and_b32 v3, 0xffff0000, v9
    v_add_f32 v34, v34, v2
    v_add_f32 v35, v35, v3
    v_lshlrev_b32 v2, 16, v10
    v_and_b32 v3, 0xffff0000, v10
    v_add_f32 v36, v36, v2
    v_add_f32 v37, v37, v3
    v_lshlrev_b32 v2, 16, v11
    v_and_b32 v3, 0xffff0000, v11
    v_add_f32 v38, v38, v2
    v_add_f32 v39, v39, v3
    v_lshlrev_b32 v2, 16, v12
    v_and_b32 v3, 0xffff0000, v12
    v_add_f32 v40, v40, v2
    v_add_f32 v41, v41, v3
    v_lshlrev_b32 v2, 16, v13
    v_and_b32 v3, 0xffff0000, v13
    v_add_f32 v42, v42, v2
    v_add_f32 v43, v43, v3
    v_lshlrev_b32 v2, 16, v14
    v_and_b32 v3, 0xffff0000, v14
    v_add_f32 v44, v44, v2
    v_add_f32 v45, v45, v3
    v_lshlrev_b32 v2, 16, v15
    v_and_b32 v3, 0xffff0000, v15
    v_add_f32 v46, v46, v2
    v_add_f32 v47, v47, v3
    v_cvt_pk_bf16_f32 v124, v32, v33
    v_cvt_pk_bf16_f32 v125, v34, v35
    v_cvt_pk_bf16_f32 v126, v40, v41
    v_cvt_pk_bf16_f32 v127, v42, v43
    s_nop 0
    v_permlane16_swap_b32 v124, v126
    v_permlane16_swap_b32 v125, v127
    v_cvt_pk_bf16_f32 v128, v36, v37
    v_cvt_pk_bf16_f32 v129, v38, v39
    v_cvt_pk_bf16_f32 v130, v44, v45
    v_cvt_pk_bf16_f32 v131, v46, v47
    s_nop 0
    v_permlane16_swap_b32 v128, v130
    v_permlane16_swap_b32 v129, v131
    s_nop 0
    v_permlane16_swap_b32 v124, v128
    v_permlane16_swap_b32 v125, v129
    v_permlane16_swap_b32 v126, v130
    v_permlane16_swap_b32 v127, v131
    buffer_store_dwordx4 v[124:127], v120, s[60:63], s22 offen offset:0
    buffer_store_dwordx4 v[128:131], v121, s[60:63], s22 offen offset:0
    s_endpgm
sequential_preLN__grouped_kv_mqa__mixer_gmlp__prompt_kernel_loader:
    s_lshl_b32 s79, s51, 10
    s_and_b32 s4, s51, 1
    s_lshl_b32 s4, s4, 2
    v_lshrrev_b32 v2, 4, v1
    v_add_u32 v2, s4, v2
    v_and_b32 v2, 7, v2
    v_and_b32 v3, 7, v1
    v_xor_b32 v2, v2, v3
    v_lshlrev_b32 v2, 4, v2
    s_lshl_b32 s5, s51, 3
    s_add_u32 s5, s5, s47
    v_lshrrev_b32 v3, 3, v1
    v_add_u32 v3, s5, v3
    s_mov_b32 s4, 1024
    v_mul_lo_u32 v3, v3, s4
    v_add_u32 v7, v2, v3
    v_add_u32 v8, 32768, v7
    s_and_b32 s4, s51, 1
    s_lshl_b32 s4, s4, 1
    v_bfe_u32 v2, v1, 4, 1
    v_or_b32 v2, s4, v2
    v_lshlrev_b32 v2, 1, v2
    v_and_b32 v3, 7, v1
    v_xor_b32 v2, v2, v3
    v_lshrrev_b32 v3, 3, v1
    s_mul_i32 s5, s51, 8
    v_add_u32 v3, s5, v3
    s_mov_b32 s4, 1024
    v_mul_lo_u32 v3, v3, s4
    v_lshl_add_u32 v3, v2, 4, v3
    s_lshl_b32 s83, s46, 7
    v_add_u32 v9, s83, v3
    v_add_u32 v10, 32768, v9
    v_lshrrev_b32 v2, 1, v1
    v_bfe_u32 v3, v2, 3, 1
    v_lshlrev_b32 v3, 2, v3
    v_xor_b32 v2, v2, v3
    v_lshlrev_b32 v2, 5, v2
    v_and_b32 v3, 1, v1
    v_lshl_add_u32 v2, v3, 4, v2
    v_add_u32 v13, s79, v2
    s_memrealtime s[14:15]
    s_waitcnt lgkmcnt(0)
    s_or_b32 s85, s2, s51
    s_cmp_lg_u32 s85, 0
    s_cbranch_scc1 tag_sequential_preLN__grouped_kv_mqa__mixer_gmlp__prompt_kernel_30
    s_mov_b32 s56, s38
    s_mov_b32 s57, s39
    s_mov_b32 s58, 256
    s_mov_b32 s59, 0x00020000
    s_or_b32 s14, s14, 1
    v_mov_b32 v2, 0
    v_mov_b32 v3, s14
    s_mov_b64 exec, 1
    buffer_store_dword v3, v2, s[56:59], 0 offen sc1
    s_mov_b64 exec, -1
tag_sequential_preLN__grouped_kv_mqa__mixer_gmlp__prompt_kernel_30:
    s_mov_b32 s56, s16
    s_mov_b32 s57, s17
    s_mov_b32 s58, 2097152
    s_mov_b32 s59, 0x00020000
    s_mov_b32 s60, s18
    s_mov_b32 s61, s19
    s_mov_b32 s62, 524288
    s_mov_b32 s63, 0x00020000
    s_cmp_lt_u32 s46, 4
    s_cselect_b32 s64, s20, s22
    s_cselect_b32 s65, s21, s23
    s_mov_b32 s66, 16384
    s_mov_b32 s67, 0x00020000
    s_getpc_b64 s[68:69]
sequential_preLN__grouped_kv_mqa__mixer_gmlp__prompt_kernel_pc:
    s_sub_u32 s68, s68, sequential_preLN__grouped_kv_mqa__mixer_gmlp__prompt_kernel_pc-sequential_preLN__grouped_kv_mqa__mixer_gmlp__prompt_kernel_codebeg
    s_subb_u32 s69, s69, 0
    s_mov_b32 s70, sequential_preLN__grouped_kv_mqa__mixer_gmlp__prompt_kernel_codeend-sequential_preLN__grouped_kv_mqa__mixer_gmlp__prompt_kernel_codebeg
    s_mov_b32 s71, 0x00020000
    s_lshr_b32 s85, s2, 3
    s_lshl_b32 s85, s85, 2
    s_add_u32 s85, s85, s51
    s_lshl_b32 s85, s85, 10
    buffer_load_dwordx4 v[16:19], v6, s[68:71], s85 offen
    s_and_b32 s85, s46, 3
    s_cmp_lg_u32 s85, 0
    s_cbranch_scc1 sequential_preLN__grouped_kv_mqa__mixer_gmlp__prompt_kernel_lq
    s_mov_b32 s85, 0
    s_add_u32 m0, s79, 131072
    s_nop 0
    buffer_load_dwordx4 v13, s[64:67], s85 offen lds
    s_mov_b32 s80, 0
    s_add_u32 m0, s79, 0
    s_nop 0
    buffer_load_dwordx4 v7, s[56:59], s80 offen lds
    s_add_u32 m0, s79, 4096
    s_nop 0
    buffer_load_dwordx4 v8, s[56:59], s80 offen lds
    s_mov_b32 s80, 128
    s_add_u32 m0, s79, 8192
    s_nop 0
    buffer_load_dwordx4 v7, s[56:59], s80 offen lds
    s_add_u32 m0, s79, 12288
    s_nop 0
    buffer_load_dwordx4 v8, s[56:59], s80 offen lds
    s_mov_b32 s85, 4096
    s_add_u32 m0, s79, 135168
    s_nop 0
    buffer_load_dwordx4 v13, s[64:67], s85 offen lds
    s_mov_b32 s80, 256
    s_add_u32 m0, s79, 16384
    s_nop 0
    buffer_load_dwordx4 v7, s[56:59], s80 offen lds
    s_add_u32 m0, s79, 20480
    s_nop 0
    buffer_load_dwordx4 v8, s[56:59], s80 offen lds
    s_mov_b32 s80, 384
    s_add_u32 m0, s79, 24576
    s_nop 0
    buffer_load_dwordx4 v7, s[56:59], s80 offen lds
    s_add_u32 m0, s79, 28672
    s_nop 0
    buffer_load_dwordx4 v8, s[56:59], s80 offen lds
    s_mov_b32 s85, 8192
    s_add_u32 m0, s79, 139264
    s_nop 0
    buffer_load_dwordx4 v13, s[64:67], s85 offen lds
    s_mov_b32 s80, 512
    s_add_u32 m0, s79, 32768
    s_nop 0
    buffer_load_dwordx4 v7, s[56:59], s80 offen lds
    s_add_u32 m0, s79, 36864
    s_nop 0
    buffer_load_dwordx4 v8, s[56:59], s80 offen lds
    s_mov_b32 s80, 640
    s_add_u32 m0, s79, 40960
    s_nop 0
    buffer_load_dwordx4 v7, s[56:59], s80 offen lds
    s_add_u32 m0, s79, 45056
    s_nop 0
    buffer_load_dwordx4 v8, s[56:59], s80 offen lds
    s_mov_b32 s85, 12288
    s_add_u32 m0, s79, 143360
    s_nop 0
    buffer_load_dwordx4 v13, s[64:67], s85 offen lds
    s_mov_b32 s80, 768
    s_add_u32 m0, s79, 49152
    s_nop 0
    buffer_load_dwordx4 v7, s[56:59], s80 offen lds
    s_add_u32 m0, s79, 53248
    s_nop 0
    buffer_load_dwordx4 v8, s[56:59], s80 offen lds
    s_mov_b32 s80, 896
    s_add_u32 m0, s79, 57344
    s_nop 0
    buffer_load_dwordx4 v7, s[56:59], s80 offen lds
    s_add_u32 m0, s79, 61440
    s_nop 0
    buffer_load_dwordx4 v8, s[56:59], s80 offen lds
    s_mov_b32 s81, 0
    s_add_u32 m0, s79, 65536
    s_nop 0
    buffer_load_dwordx4 v9, s[60:63], s81 offen lds
    s_add_u32 m0, s79, 69632
    s_nop 0
    buffer_load_dwordx4 v10, s[60:63], s81 offen lds
    s_mov_b32 s81, 65536
    s_add_u32 m0, s79, 73728
    s_nop 0
    buffer_load_dwordx4 v9, s[60:63], s81 offen lds
    s_add_u32 m0, s79, 77824
    s_nop 0
    buffer_load_dwordx4 v10, s[60:63], s81 offen lds
    s_mov_b32 s81, 131072
    s_add_u32 m0, s79, 81920
    s_nop 0
    buffer_load_dwordx4 v9, s[60:63], s81 offen lds
    s_add_u32 m0, s79, 86016
    s_nop 0
    buffer_load_dwordx4 v10, s[60:63], s81 offen lds
    s_mov_b32 s81, 196608
    s_add_u32 m0, s79, 90112
    s_nop 0
    buffer_load_dwordx4 v9, s[60:63], s81 offen lds
    s_add_u32 m0, s79, 94208
    s_nop 0
    buffer_load_dwordx4 v10, s[60:63], s81 offen lds
    s_mov_b32 s81, 262144
    s_add_u32 m0, s79, 98304
    s_nop 0
    buffer_load_dwordx4 v9, s[60:63], s81 offen lds
    s_add_u32 m0, s79, 102400
    s_nop 0
    buffer_load_dwordx4 v10, s[60:63], s81 offen lds
    s_mov_b32 s81, 327680
    s_add_u32 m0, s79, 106496
    s_nop 0
    buffer_load_dwordx4 v9, s[60:63], s81 offen lds
    s_add_u32 m0, s79, 110592
    s_nop 0
    buffer_load_dwordx4 v10, s[60:63], s81 offen lds
    s_mov_b32 s81, 393216
    s_add_u32 m0, s79, 114688
    s_nop 0
    buffer_load_dwordx4 v9, s[60:63], s81 offen lds
    s_add_u32 m0, s79, 118784
    s_nop 0
    buffer_load_dwordx4 v10, s[60:63], s81 offen lds
    s_mov_b32 s81, 458752
    s_add_u32 m0, s79, 122880
    s_nop 0
    buffer_load_dwordx4 v9, s[60:63], s81 offen lds
    s_add_u32 m0, s79, 126976
    s_nop 0
    buffer_load_dwordx4 v10, s[60:63], s81 offen lds
    s_waitcnt vmcnt(33)
    s_barrier
    s_waitcnt vmcnt(31)
    s_barrier
    s_waitcnt vmcnt(28)
    s_barrier
    s_waitcnt vmcnt(26)
    s_barrier
    s_waitcnt vmcnt(23)
    s_barrier
    s_waitcnt vmcnt(21)
    s_barrier
    s_waitcnt vmcnt(18)
    s_barrier
    s_waitcnt vmcnt(16)
    s_barrier
    s_waitcnt vmcnt(0)
    s_barrier
    s_branch sequential_preLN__grouped_kv_mqa__mixer_gmlp__prompt_kernel_lj
sequential_preLN__grouped_kv_mqa__mixer_gmlp__prompt_kernel_lq:
    s_mov_b32 s80, 0
    s_add_u32 m0, s79, 0
    s_nop 0
    buffer_load_dwordx4 v7, s[56:59], s80 offen lds
    s_add_u32 m0, s79, 4096
    s_nop 0
    buffer_load_dwordx4 v8, s[56:59], s80 offen lds
    s_mov_b32 s81, 0
    s_add_u32 m0, s79, 65536
    s_nop 0
    buffer_load_dwordx4 v9, s[60:63], s81 offen lds
    s_add_u32 m0, s79, 69632
    s_nop 0
    buffer_load_dwordx4 v10, s[60:63], s81 offen lds
    s_mov_b32 s80, 128
    s_add_u32 m0, s79, 8192
    s_nop 0
    buffer_load_dwordx4 v7, s[56:59], s80 offen lds
    s_add_u32 m0, s79, 12288
    s_nop 0
    buffer_load_dwordx4 v8, s[56:59], s80 offen lds
    s_mov_b32 s81, 65536
    s_add_u32 m0, s79, 73728
    s_nop 0
    buffer_load_dwordx4 v9, s[60:63], s81 offen lds
    s_add_u32 m0, s79, 77824
    s_nop 0
    buffer_load_dwordx4 v10, s[60:63], s81 offen lds
    s_mov_b32 s80, 256
    s_add_u32 m0, s79, 16384
    s_nop 0
    buffer_load_dwordx4 v7, s[56:59], s80 offen lds
    s_add_u32 m0, s79, 20480
    s_nop 0
    buffer_load_dwordx4 v8, s[56:59], s80 offen lds
    s_mov_b32 s81, 131072
    s_add_u32 m0, s79, 81920
    s_nop 0
    buffer_load_dwordx4 v9, s[60:63], s81 offen lds
    s_add_u32 m0, s79, 86016
    s_nop 0
    buffer_load_dwordx4 v10, s[60:63], s81 offen lds
    s_mov_b32 s80, 384
    s_add_u32 m0, s79, 24576
    s_nop 0
    buffer_load_dwordx4 v7, s[56:59], s80 offen lds
    s_add_u32 m0, s79, 28672
    s_nop 0
    buffer_load_dwordx4 v8, s[56:59], s80 offen lds
    s_mov_b32 s81, 196608
    s_add_u32 m0, s79, 90112
    s_nop 0
    buffer_load_dwordx4 v9, s[60:63], s81 offen lds
    s_add_u32 m0, s79, 94208
    s_nop 0
    buffer_load_dwordx4 v10, s[60:63], s81 offen lds
    s_mov_b32 s80, 512
    s_add_u32 m0, s79, 32768
    s_nop 0
    buffer_load_dwordx4 v7, s[56:59], s80 offen lds
    s_add_u32 m0, s79, 36864
    s_nop 0
    buffer_load_dwordx4 v8, s[56:59], s80 offen lds
    s_mov_b32 s81, 262144
    s_add_u32 m0, s79, 98304
    s_nop 0
    buffer_load_dwordx4 v9, s[60:63], s81 offen lds
    s_add_u32 m0, s79, 102400
    s_nop 0
    buffer_load_dwordx4 v10, s[60:63], s81 offen lds
    s_mov_b32 s80, 640
    s_add_u32 m0, s79, 40960
    s_nop 0
    buffer_load_dwordx4 v7, s[56:59], s80 offen lds
    s_add_u32 m0, s79, 45056
    s_nop 0
    buffer_load_dwordx4 v8, s[56:59], s80 offen lds
    s_mov_b32 s81, 327680
    s_add_u32 m0, s79, 106496
    s_nop 0
    buffer_load_dwordx4 v9, s[60:63], s81 offen lds
    s_add_u32 m0, s79, 110592
    s_nop 0
    buffer_load_dwordx4 v10, s[60:63], s81 offen lds
    s_mov_b32 s80, 768
    s_add_u32 m0, s79, 49152
    s_nop 0
    buffer_load_dwordx4 v7, s[56:59], s80 offen lds
    s_add_u32 m0, s79, 53248
    s_nop 0
    buffer_load_dwordx4 v8, s[56:59], s80 offen lds
    s_mov_b32 s81, 393216
    s_add_u32 m0, s79, 114688
    s_nop 0
    buffer_load_dwordx4 v9, s[60:63], s81 offen lds
    s_add_u32 m0, s79, 118784
    s_nop 0
    buffer_load_dwordx4 v10, s[60:63], s81 offen lds
    s_mov_b32 s80, 896
    s_add_u32 m0, s79, 57344
    s_nop 0
    buffer_load_dwordx4 v7, s[56:59], s80 offen lds
    s_add_u32 m0, s79, 61440
    s_nop 0
    buffer_load_dwordx4 v8, s[56:59], s80 offen lds
    s_mov_b32 s81, 458752
    s_add_u32 m0, s79, 122880
    s_nop 0
    buffer_load_dwordx4 v9, s[60:63], s81 offen lds
    s_add_u32 m0, s79, 126976
    s_nop 0
    buffer_load_dwordx4 v10, s[60:63], s81 offen lds
    s_waitcnt vmcnt(28)
    s_barrier
    s_waitcnt vmcnt(24)
    s_barrier
    s_waitcnt vmcnt(20)
    s_barrier
    s_waitcnt vmcnt(16)
    s_barrier
    s_waitcnt vmcnt(12)
    s_barrier
    s_waitcnt vmcnt(8)
    s_barrier
    s_waitcnt vmcnt(4)
    s_barrier
    s_waitcnt vmcnt(0)
    s_barrier
sequential_preLN__grouped_kv_mqa__mixer_gmlp__prompt_kernel_lj:
    s_barrier
    v_add_u32 v248, s79, v6
    s_add_u32 s56, s40, 2097152
    s_addc_u32 s57, s41, 0
    s_mov_b32 s58, 131072
    s_mov_b32 s59, 0x00020000
    s_barrier
    s_add_u32 s82, s79, 0
    s_mov_b32 m0, s82
    s_nop 0
    buffer_load_dwordx4 v6, s[56:59], s82 offen sc1 lds
    s_add_u32 s82, s79, 65536
    s_mov_b32 m0, s82
    s_nop 0
    buffer_load_dwordx4 v6, s[56:59], s82 offen sc1 lds
    s_add_u32 s82, s79, 4096
    s_mov_b32 m0, s82
    s_nop 0
    buffer_load_dwordx4 v6, s[56:59], s82 offen sc1 lds
    s_add_u32 s82, s79, 69632
    s_mov_b32 m0, s82
    s_nop 0
    buffer_load_dwordx4 v6, s[56:59], s82 offen sc1 lds
    s_add_u32 s82, s79, 8192
    s_mov_b32 m0, s82
    s_nop 0
    buffer_load_dwordx4 v6, s[56:59], s82 offen sc1 lds
    s_add_u32 s82, s79, 73728
    s_mov_b32 m0, s82
    s_nop 0
    buffer_load_dwordx4 v6, s[56:59], s82 offen sc1 lds
    s_add_u32 s82, s79, 12288
    s_mov_b32 m0, s82
    s_nop 0
    buffer_load_dwordx4 v6, s[56:59], s82 offen sc1 lds
    s_add_u32 s82, s79, 77824
    s_mov_b32 m0, s82
    s_nop 0
    buffer_load_dwordx4 v6, s[56:59], s82 offen sc1 lds
    s_add_u32 s82, s79, 16384
    s_mov_b32 m0, s82
    s_nop 0
    buffer_load_dwordx4 v6, s[56:59], s82 offen sc1 lds
    s_add_u32 s82, s79, 81920
    s_mov_b32 m0, s82
    s_nop 0
    buffer_load_dwordx4 v6, s[56:59], s82 offen sc1 lds
    s_add_u32 s82, s79, 20480
    s_mov_b32 m0, s82
    s_nop 0
    buffer_load_dwordx4 v6, s[56:59], s82 offen sc1 lds
    s_add_u32 s82, s79, 86016
    s_mov_b32 m0, s82
    s_nop 0
    buffer_load_dwordx4 v6, s[56:59], s82 offen sc1 lds
    s_add_u32 s82, s79, 24576
    s_mov_b32 m0, s82
    s_nop 0
    buffer_load_dwordx4 v6, s[56:59], s82 offen sc1 lds
    s_add_u32 s82, s79, 90112
    s_mov_b32 m0, s82
    s_nop 0
    buffer_load_dwordx4 v6, s[56:59], s82 offen sc1 lds
    s_waitcnt vmcnt(4)
    s_barrier
    s_add_u32 s82, s79, 28672
    s_mov_b32 m0, s82
    s_nop 0
    buffer_load_dwordx4 v6, s[56:59], s82 offen sc1 lds
    s_add_u32 s82, s79, 94208
    s_mov_b32 m0, s82
    s_nop 0
    buffer_load_dwordx4 v6, s[56:59], s82 offen sc1 lds
    s_add_u32 s82, s79, 32768
    s_mov_b32 m0, s82
    s_nop 0
    buffer_load_dwordx4 v6, s[56:59], s82 offen sc1 lds
    s_add_u32 s82, s79, 98304
    s_mov_b32 m0, s82
    s_nop 0
    buffer_load_dwordx4 v6, s[56:59], s82 offen sc1 lds
    s_add_u32 s82, s79, 36864
    s_mov_b32 m0, s82
    s_nop 0
    buffer_load_dwordx4 v6, s[56:59], s82 offen sc1 lds
    s_add_u32 s82, s79, 102400
    s_mov_b32 m0, s82
    s_nop 0
    buffer_load_dwordx4 v6, s[56:59], s82 offen sc1 lds
    s_add_u32 s82, s79, 40960
    s_mov_b32 m0, s82
    s_nop 0
    buffer_load_dwordx4 v6, s[56:59], s82 offen sc1 lds
    s_add_u32 s82, s79, 106496
    s_mov_b32 m0, s82
    s_nop 0
    buffer_load_dwordx4 v6, s[56:59], s82 offen sc1 lds
    s_add_u32 s82, s79, 45056
    s_mov_b32 m0, s82
    s_nop 0
    buffer_load_dwordx4 v6, s[56:59], s82 offen sc1 lds
    s_add_u32 s82, s79, 110592
    s_mov_b32 m0, s82
    s_nop 0
    buffer_load_dwordx4 v6, s[56:59], s82 offen sc1 lds
    s_add_u32 s82, s79, 49152
    s_mov_b32 m0, s82
    s_nop 0
    buffer_load_dwordx4 v6, s[56:59], s82 offen sc1 lds
    s_add_u32 s82, s79, 114688
    s_mov_b32 m0, s82
    s_nop 0
    buffer_load_dwordx4 v6, s[56:59], s82 offen sc1 lds
    s_add_u32 s82, s79, 53248
    s_mov_b32 m0, s82
    s_nop 0
    buffer_load_dwordx4 v6, s[56:59], s82 offen sc1 lds
    s_add_u32 s82, s79, 118784
    s_mov_b32 m0, s82
    s_nop 0
    buffer_load_dwordx4 v6, s[56:59], s82 offen sc1 lds
    s_add_u32 s82, s79, 57344
    s_mov_b32 m0, s82
    s_nop 0
    buffer_load_dwordx4 v6, s[56:59], s82 offen sc1 lds
    s_add_u32 s82, s79, 122880
    s_mov_b32 m0, s82
    s_nop 0
    buffer_load_dwordx4 v6, s[56:59], s82 offen sc1 lds
    s_add_u32 s82, s79, 61440
    s_mov_b32 m0, s82
    s_nop 0
    buffer_load_dwordx4 v6, s[56:59], s82 offen sc1 lds
    s_add_u32 s82, s79, 126976
    s_mov_b32 m0, s82
    s_nop 0
    buffer_load_dwordx4 v6, s[56:59], s82 offen sc1 lds
    s_and_b32 s4, s51, 1
    s_lshl_b32 s4, s4, 1
    v_bfe_u32 v2, v1, 4, 1
    v_or_b32 v2, s4, v2
    v_lshlrev_b32 v2, 1, v2
    v_and_b32 v3, 7, v1
    v_xor_b32 v2, v2, v3
    v_lshrrev_b32 v3, 3, v1
    s_mul_i32 s5, s51, 8
    v_add_u32 v3, s5, v3
    s_mov_b32 s4, 1024
    v_mul_lo_u32 v3, v3, s4
    v_lshl_add_u32 v3, v2, 4, v3
    s_lshl_b32 s83, s46, 7
    v_add_u32 v9, s83, v3
    v_add_u32 v10, 32768, v9
    s_mov_b32 s60, s24
    s_mov_b32 s61, s25
    s_mov_b32 s62, 524288
    s_mov_b32 s63, 0x00020000
    s_and_b32 s27, s76, 7
    s_lshl_b32 s27, s27, 0
    s_and_b32 s4, s51, 1
    s_lshl_b32 s4, s4, 2
    v_lshrrev_b32 v2, 4, v1
    v_add_u32 v2, s4, v2
    v_and_b32 v2, 7, v2
    v_and_b32 v3, 7, v1
    v_xor_b32 v2, v2, v3
    v_lshlrev_b32 v2, 4, v2
    s_lshl_b32 s5, s51, 3
    s_add_u32 s5, s5, s78
    v_lshrrev_b32 v3, 3, v1
    v_add_u32 v3, s5, v3
    s_mov_b32 s4, 4096
    v_mul_lo_u32 v3, v3, s4
    v_add_u32 v7, v2, v3
    v_add_u32 v8, 131072, v7
    s_mov_b32 s68, s30
    s_mov_b32 s69, s31
    s_mov_b32 s70, 8388608
    s_mov_b32 s71, 0x00020000
    s_add_u32 s86, s27, 4
    s_and_b32 s86, s86, 31
    s_lshl_b32 s86, s86, 7
    buffer_load_dwordx4 v[24:27], v7, s[68:71], s86 offen
    buffer_load_dwordx4 v[28:31], v8, s[68:71], s86 offen
    s_add_u32 s86, s27, 5
    s_and_b32 s86, s86, 31
    s_lshl_b32 s86, s86, 7
    buffer_load_dwordx4 v[32:35], v7, s[68:71], s86 offen
    buffer_load_dwordx4 v[36:39], v8, s[68:71], s86 offen
    s_add_u32 s86, s27, 6
    s_and_b32 s86, s86, 31
    s_lshl_b32 s86, s86, 7
    buffer_load_dwordx4 v[40:43], v7, s[68:71], s86 offen
    buffer_load_dwordx4 v[44:47], v8, s[68:71], s86 offen
    s_add_u32 s86, s27, 7
    s_and_b32 s86, s86, 31
    s_lshl_b32 s86, s86, 7
    buffer_load_dwordx4 v[48:51], v7, s[68:71], s86 offen
    buffer_load_dwordx4 v[52:55], v8, s[68:71], s86 offen
    s_add_u32 s86, s27, 8
    s_and_b32 s86, s86, 31
    s_lshl_b32 s86, s86, 7
    buffer_load_dwordx4 v[56:59], v7, s[68:71], s86 offen
    buffer_load_dwordx4 v[60:63], v8, s[68:71], s86 offen
    s_add_u32 s86, s27, 9
    s_and_b32 s86, s86, 31
    s_lshl_b32 s86, s86, 7
    buffer_load_dwordx4 v[64:67], v7, s[68:71], s86 offen
    buffer_load_dwordx4 v[68:71], v8, s[68:71], s86 offen
    s_add_u32 s86, s27, 10
    s_and_b32 s86, s86, 31
    s_lshl_b32 s86, s86, 7
    buffer_load_dwordx4 v[72:75], v7, s[68:71], s86 offen
    buffer_load_dwordx4 v[76:79], v8, s[68:71], s86 offen
    s_add_u32 s86, s27, 11
    s_and_b32 s86, s86, 31
    s_lshl_b32 s86, s86, 7
    buffer_load_dwordx4 v[80:83], v7, s[68:71], s86 offen
    buffer_load_dwordx4 v[84:87], v8, s[68:71], s86 offen
    s_waitcnt vmcnt(30)
    s_barrier
    s_waitcnt vmcnt(0)
    s_mov_b32 s60, s24
    s_mov_b32 s61, s25
    s_mov_b32 s62, 524288
    s_mov_b32 s63, 0x00020000
    s_lshr_b32 s86, s2, 3
    s_mul_i32 s86, s86, 16384
    s_mul_i32 s82, s51, 4096
    s_add_u32 s86, s86, s82
    buffer_load_dwordx4 v[20:23], v6, s[60:63], s86 offen
    s_add_u32 s86, s86, 1024
    buffer_load_dwordx4 v[20:23], v6, s[60:63], s86 offen
    s_add_u32 s86, s86, 1024
    buffer_load_dwordx4 v[20:23], v6, s[60:63], s86 offen
    s_add_u32 s86, s86, 1024
    buffer_load_dwordx4 v[20:23], v6, s[60:63], s86 offen
    s_mov_b32 s60, s34
    s_mov_b32 s61, s35
    s_mov_b32 s62, 917504
    s_mov_b32 s63, 0x00020000
    s_lshr_b32 s86, s2, 3
    s_mul_i32 s86, s86, 28672
    s_mul_i32 s82, s51, 7168
    s_add_u32 s86, s86, s82
    buffer_load_dwordx4 v[20:23], v6, s[60:63], s86 offen
    s_add_u32 s86, s86, 1024
    buffer_load_dwordx4 v[20:23], v6, s[60:63], s86 offen
    s_add_u32 s86, s86, 1024
    buffer_load_dwordx4 v[20:23], v6, s[60:63], s86 offen
    s_add_u32 s86, s86, 1024
    buffer_load_dwordx4 v[20:23], v6, s[60:63], s86 offen
    s_add_u32 s86, s86, 1024
    buffer_load_dwordx4 v[20:23], v6, s[60:63], s86 offen
    s_add_u32 s86, s86, 1024
    buffer_load_dwordx4 v[20:23], v6, s[60:63], s86 offen
    s_add_u32 s86, s86, 1024
    buffer_load_dwordx4 v[20:23], v6, s[60:63], s86 offen
    s_mov_b32 s60, s28
    s_mov_b32 s61, s29
    s_mov_b32 s62, 1835008
    s_mov_b32 s63, 0x00020000
    v_lshrrev_b32 v2, 4, v1
    v_mul_u32_u24 v2, 3584, v2
    v_and_b32 v3, 15, v1
    v_lshl_add_u32 v2, v3, 4, v2
    s_and_b32 s86, s76, 7
    s_lshl_b32 s86, s86, 6
    s_lshl_b32 s82, s51, 4
    s_add_u32 s86, s86, s82
    s_mul_i32 s86, s86, 3584
    s_lshl_b32 s82, s77, 8
    s_add_u32 s86, s86, s82
    buffer_load_dwordx4 v[20:23], v2, s[60:63], s86 offen
    buffer_load_dwordx4 v[20:23], v2, s[60:63], s86 offen offset:1792
    s_add_u32 s86, s86, 14336
    buffer_load_dwordx4 v[20:23], v2, s[60:63], s86 offen
    buffer_load_dwordx4 v[20:23], v2, s[60:63], s86 offen offset:1792
    s_add_u32 s86, s86, 14336
    buffer_load_dwordx4 v[20:23], v2, s[60:63], s86 offen
    buffer_load_dwordx4 v[20:23], v2, s[60:63], s86 offen offset:1792
    s_add_u32 s86, s86, 14336
    buffer_load_dwordx4 v[20:23], v2, s[60:63], s86 offen
    buffer_load_dwordx4 v[20:23], v2, s[60:63], s86 offen offset:1792
    s_mov_b32 s60, s24
    s_mov_b32 s61, s25
    s_mov_b32 s62, 524288
    s_mov_b32 s63, 0x00020000
    s_add_u32 s86, s27, 12
    s_and_b32 s86, s86, 31
    s_lshl_b32 s86, s86, 7
    buffer_load_dwordx4 v[88:91], v7, s[68:71], s86 offen
    buffer_load_dwordx4 v[92:95], v8, s[68:71], s86 offen
    s_add_u32 s86, s27, 13
    s_and_b32 s86, s86, 31
    s_lshl_b32 s86, s86, 7
    buffer_load_dwordx4 v[96:99], v7, s[68:71], s86 offen
    buffer_load_dwordx4 v[100:103], v8, s[68:71], s86 offen
    s_add_u32 s86, s27, 14
    s_and_b32 s86, s86, 31
    s_lshl_b32 s86, s86, 7
    buffer_load_dwordx4 v[104:107], v7, s[68:71], s86 offen
    buffer_load_dwordx4 v[108:111], v8, s[68:71], s86 offen
    s_add_u32 s86, s27, 15
    s_and_b32 s86, s86, 31
    s_lshl_b32 s86, s86, 7
    buffer_load_dwordx4 v[112:115], v7, s[68:71], s86 offen
    buffer_load_dwordx4 v[116:119], v8, s[68:71], s86 offen
    s_add_u32 s86, s27, 16
    s_and_b32 s86, s86, 31
    s_lshl_b32 s86, s86, 7
    buffer_load_dwordx4 v[120:123], v7, s[68:71], s86 offen
    buffer_load_dwordx4 v[124:127], v8, s[68:71], s86 offen
    s_add_u32 s86, s27, 17
    s_and_b32 s86, s86, 31
    s_lshl_b32 s86, s86, 7
    buffer_load_dwordx4 v[128:131], v7, s[68:71], s86 offen
    buffer_load_dwordx4 v[132:135], v8, s[68:71], s86 offen
    s_waitcnt vmcnt(53)
    s_barrier
    s_waitcnt vmcnt(0)
    s_add_u32 s86, s27, 18
    s_and_b32 s86, s86, 31
    s_lshl_b32 s86, s86, 7
    buffer_load_dwordx4 v[136:139], v7, s[68:71], s86 offen
    buffer_load_dwordx4 v[140:143], v8, s[68:71], s86 offen
    s_add_u32 s86, s27, 19
    s_and_b32 s86, s86, 31
    s_lshl_b32 s86, s86, 7
    buffer_load_dwordx4 v[144:147], v7, s[68:71], s86 offen
    buffer_load_dwordx4 v[148:151], v8, s[68:71], s86 offen
    s_add_u32 s86, s27, 20
    s_and_b32 s86, s86, 31
    s_lshl_b32 s86, s86, 7
    buffer_load_dwordx4 v[152:155], v7, s[68:71], s86 offen
    buffer_load_dwordx4 v[156:159], v8, s[68:71], s86 offen
    s_add_u32 s86, s27, 21
    s_and_b32 s86, s86, 31
    s_lshl_b32 s86, s86, 7
    buffer_load_dwordx4 v[160:163], v7, s[68:71], s86 offen
    buffer_load_dwordx4 v[164:167], v8, s[68:71], s86 offen
    s_add_u32 s86, s27, 22
    s_and_b32 s86, s86, 31
    s_lshl_b32 s86, s86, 7
    buffer_load_dwordx4 v[168:171], v7, s[68:71], s86 offen
    buffer_load_dwordx4 v[172:175], v8, s[68:71], s86 offen
    s_add_u32 s86, s27, 23
    s_and_b32 s86, s86, 31
    s_lshl_b32 s86, s86, 7
    buffer_load_dwordx4 v[176:179], v7, s[68:71], s86 offen
    buffer_load_dwordx4 v[180:183], v8, s[68:71], s86 offen
    s_add_u32 s86, s27, 24
    s_and_b32 s86, s86, 31
    s_lshl_b32 s86, s86, 7
    buffer_load_dwordx4 v[184:187], v7, s[68:71], s86 offen
    buffer_load_dwordx4 v[188:191], v8, s[68:71], s86 offen
    s_add_u32 s86, s27, 25
    s_and_b32 s86, s86, 31
    s_lshl_b32 s86, s86, 7
    buffer_load_dwordx4 v[192:195], v7, s[68:71], s86 offen
    buffer_load_dwordx4 v[196:199], v8, s[68:71], s86 offen
    s_add_u32 s86, s27, 26
    s_and_b32 s86, s86, 31
    s_lshl_b32 s86, s86, 7
    buffer_load_dwordx4 v[200:203], v7, s[68:71], s86 offen
    buffer_load_dwordx4 v[204:207], v8, s[68:71], s86 offen
    s_add_u32 s86, s27, 27
    s_and_b32 s86, s86, 31
    s_lshl_b32 s86, s86, 7
    buffer_load_dwordx4 v[208:211], v7, s[68:71], s86 offen
    buffer_load_dwordx4 v[212:215], v8, s[68:71], s86 offen
    s_add_u32 s86, s27, 28
    s_and_b32 s86, s86, 31
    s_lshl_b32 s86, s86, 7
    buffer_load_dwordx4 v[216:219], v7, s[68:71], s86 offen
    buffer_load_dwordx4 v[220:223], v8, s[68:71], s86 offen
    s_add_u32 s86, s27, 29
    s_and_b32 s86, s86, 31
    s_lshl_b32 s86, s86, 7
    buffer_load_dwordx4 v[224:227], v7, s[68:71], s86 offen
    buffer_load_dwordx4 v[228:231], v8, s[68:71], s86 offen
    s_add_u32 s86, s27, 30
    s_and_b32 s86, s86, 31
    s_lshl_b32 s86, s86, 7
    buffer_load_dwordx4 v[232:235], v7, s[68:71], s86 offen
    buffer_load_dwordx4 v[236:239], v8, s[68:71], s86 offen
    s_add_u32 s86, s27, 31
    s_and_b32 s86, s86, 31
    s_lshl_b32 s86, s86, 7
    buffer_load_dwordx4 v[240:243], v7, s[68:71], s86 offen
    buffer_load_dwordx4 v[244:247], v8, s[68:71], s86 offen
    s_waitcnt vmcnt(63)
    s_barrier
    s_waitcnt vmcnt(0)
    v_mov_b32 v2, 156704
    ds_read_b32 v3, v2
    s_waitcnt lgkmcnt(0)
    v_readfirstlane_b32 s84, v3
    s_nop 2
    s_cmp_lg_u32 s84, 0
    s_cbranch_scc1 sequential_preLN__grouped_kv_mqa__mixer_gmlp__prompt_kernel_wo_late
    s_mov_b32 s81, 0
    s_add_u32 m0, s79, 0
    s_nop 0
    buffer_load_dwordx4 v9, s[60:63], s81 offen lds
    s_add_u32 m0, s79, 4096
    s_nop 0
    buffer_load_dwordx4 v10, s[60:63], s81 offen lds
    s_mov_b32 s81, 65536
    s_add_u32 m0, s79, 8192
    s_nop 0
    buffer_load_dwordx4 v9, s[60:63], s81 offen lds
    s_add_u32 m0, s79, 12288
    s_nop 0
    buffer_load_dwordx4 v10, s[60:63], s81 offen lds
    s_mov_b32 s81, 131072
    s_add_u32 m0, s79, 16384
    s_nop 0
    buffer_load_dwordx4 v9, s[60:63], s81 offen lds
    s_add_u32 m0, s79, 20480
    s_nop 0
    buffer_load_dwordx4 v10, s[60:63], s81 offen lds
    s_mov_b32 s81, 196608
    s_add_u32 m0, s79, 24576
    s_nop 0
    buffer_load_dwordx4 v9, s[60:63], s81 offen lds
    s_add_u32 m0, s79, 28672
    s_nop 0
    buffer_load_dwordx4 v10, s[60:63], s81 offen lds
    s_mov_b32 s81, 262144
    s_add_u32 m0, s79, 65536
    s_nop 0
    buffer_load_dwordx4 v9, s[60:63], s81 offen lds
    s_add_u32 m0, s79, 69632
    s_nop 0
    buffer_load_dwordx4 v10, s[60:63], s81 offen lds
    s_mov_b32 s81, 327680
    s_add_u32 m0, s79, 73728
    s_nop 0
    buffer_load_dwordx4 v9, s[60:63], s81 offen lds
    s_add_u32 m0, s79, 77824
    s_nop 0
    buffer_load_dwordx4 v10, s[60:63], s81 offen lds
    s_mov_b32 s81, 393216
    s_add_u32 m0, s79, 81920
    s_nop 0
    buffer_load_dwordx4 v9, s[60:63], s81 offen lds
    s_add_u32 m0, s79, 86016
    s_nop 0
    buffer_load_dwordx4 v10, s[60:63], s81 offen lds
    s_mov_b32 s81, 458752
    s_add_u32 m0, s79, 90112
    s_nop 0
    buffer_load_dwordx4 v9, s[60:63], s81 offen lds
    s_add_u32 m0, s79, 94208
    s_nop 0
    buffer_load_dwordx4 v10, s[60:63], s81 offen lds
sequential_preLN__grouped_kv_mqa__mixer_gmlp__prompt_kernel_wo_late:
    s_and_b32 s4, s51, 1
    s_lshl_b32 s4, s4, 2
    v_lshrrev_b32 v2, 4, v1
    v_add_u32 v2, s4, v2
    v_and_b32 v2, 7, v2
    v_and_b32 v3, 7, v1
    v_xor_b32 v2, v2, v3
    v_lshlrev_b32 v2, 4, v2
    s_lshl_b32 s5, s51, 3
    s_add_u32 s5, s5, s47
    v_lshrrev_b32 v3, 3, v1
    v_add_u32 v3, s5, v3
    s_mov_b32 s4, 1024
    v_mul_lo_u32 v3, v3, s4
    v_add_u32 v7, v2, v3
    v_add_u32 v8, 32768, v7
    s_add_u32 s64, s40, 3145728
    s_addc_u32 s65, s41, 0
    s_mov_b32 s66, 2097152
    s_mov_b32 s67, 0x00020000
    s_barrier
    s_cmp_eq_u32 s84, 0
    s_cbranch_scc1 sequential_preLN__grouped_kv_mqa__mixer_gmlp__prompt_kernel_wo_done
    s_mov_b32 s81, 0
    s_add_u32 m0, s79, 0
    s_nop 0
    buffer_load_dwordx4 v9, s[60:63], s81 offen lds
    s_add_u32 m0, s79, 4096
    s_nop 0
    buffer_load_dwordx4 v10, s[60:63], s81 offen lds
    s_mov_b32 s81, 65536
    s_add_u32 m0, s79, 8192
    s_nop 0
    buffer_load_dwordx4 v9, s[60:63], s81 offen lds
    s_add_u32 m0, s79, 12288
    s_nop 0
    buffer_load_dwordx4 v10, s[60:63], s81 offen lds
    s_mov_b32 s81, 131072
    s_add_u32 m0, s79, 16384
    s_nop 0
    buffer_load_dwordx4 v9, s[60:63], s81 offen lds
    s_add_u32 m0, s79, 20480
    s_nop 0
    buffer_load_dwordx4 v10, s[60:63], s81 offen lds
    s_mov_b32 s81, 196608
    s_add_u32 m0, s79, 24576
    s_nop 0
    buffer_load_dwordx4 v9, s[60:63], s81 offen lds
    s_add_u32 m0, s79, 28672
    s_nop 0
    buffer_load_dwordx4 v10, s[60:63], s81 offen lds
    s_mov_b32 s81, 262144
    s_add_u32 m0, s79, 65536
    s_nop 0
    buffer_load_dwordx4 v9, s[60:63], s81 offen lds
    s_add_u32 m0, s79, 69632
    s_nop 0
    buffer_load_dwordx4 v10, s[60:63], s81 offen lds
    s_mov_b32 s81, 327680
    s_add_u32 m0, s79, 73728
    s_nop 0
    buffer_load_dwordx4 v9, s[60:63], s81 offen lds
    s_add_u32 m0, s79, 77824
    s_nop 0
    buffer_load_dwordx4 v10, s[60:63], s81 offen lds
    s_mov_b32 s81, 393216
    s_add_u32 m0, s79, 81920
    s_nop 0
    buffer_load_dwordx4 v9, s[60:63], s81 offen lds
    s_add_u32 m0, s79, 86016
    s_nop 0
    buffer_load_dwordx4 v10, s[60:63], s81 offen lds
    s_mov_b32 s81, 458752
    s_add_u32 m0, s79, 90112
    s_nop 0
    buffer_load_dwordx4 v9, s[60:63], s81 offen lds
    s_add_u32 m0, s79, 94208
    s_nop 0
    buffer_load_dwordx4 v10, s[60:63], s81 offen lds
sequential_preLN__grouped_kv_mqa__mixer_gmlp__prompt_kernel_wo_done:
    s_mov_b32 s80, 0
    s_add_u32 m0, s79, 32768
    s_nop 0
    buffer_load_dwordx4 v7, s[64:67], s80 offen sc1 lds
    s_add_u32 m0, s79, 36864
    s_nop 0
    buffer_load_dwordx4 v8, s[64:67], s80 offen sc1 lds
    s_mov_b32 s80, 128
    s_add_u32 m0, s79, 40960
    s_nop 0
    buffer_load_dwordx4 v7, s[64:67], s80 offen sc1 lds
    s_add_u32 m0, s79, 45056
    s_nop 0
    buffer_load_dwordx4 v8, s[64:67], s80 offen sc1 lds
    s_mov_b32 s80, 256
    s_add_u32 m0, s79, 49152
    s_nop 0
    buffer_load_dwordx4 v7, s[64:67], s80 offen sc1 lds
    s_add_u32 m0, s79, 53248
    s_nop 0
    buffer_load_dwordx4 v8, s[64:67], s80 offen sc1 lds
    s_mov_b32 s80, 384
    s_add_u32 m0, s79, 57344
    s_nop 0
    buffer_load_dwordx4 v7, s[64:67], s80 offen sc1 lds
    s_add_u32 m0, s79, 61440
    s_nop 0
    buffer_load_dwordx4 v8, s[64:67], s80 offen sc1 lds
    s_mov_b32 s80, 512
    s_add_u32 m0, s79, 98304
    s_nop 0
    buffer_load_dwordx4 v7, s[64:67], s80 offen sc1 lds
    s_add_u32 m0, s79, 102400
    s_nop 0
    buffer_load_dwordx4 v8, s[64:67], s80 offen sc1 lds
    s_mov_b32 s80, 640
    s_add_u32 m0, s79, 106496
    s_nop 0
    buffer_load_dwordx4 v7, s[64:67], s80 offen sc1 lds
    s_add_u32 m0, s79, 110592
    s_nop 0
    buffer_load_dwordx4 v8, s[64:67], s80 offen sc1 lds
    s_mov_b32 s80, 768
    s_add_u32 m0, s79, 114688
    s_nop 0
    buffer_load_dwordx4 v7, s[64:67], s80 offen sc1 lds
    s_add_u32 m0, s79, 118784
    s_nop 0
    buffer_load_dwordx4 v8, s[64:67], s80 offen sc1 lds
    s_mov_b32 s80, 896
    s_add_u32 m0, s79, 122880
    s_nop 0
    buffer_load_dwordx4 v7, s[64:67], s80 offen sc1 lds
    s_add_u32 m0, s79, 126976
    s_nop 0
    buffer_load_dwordx4 v8, s[64:67], s80 offen sc1 lds
    s_waitcnt vmcnt(16)
    s_lshr_b32 s4, s51, 1
    s_and_b32 s4, s4, 1
    s_lshl_b32 s4, s4, 2
    v_lshrrev_b32 v3, 4, v1
    v_or_b32 v2, s4, v3
    v_lshlrev_b32 v2, 1, v2
    v_and_b32 v4, 15, v1
    v_xor_b32 v2, v2, v4
    s_mul_i32 s5, s51, 4
    v_add_u32 v3, s5, v3
    s_mov_b32 s4, 3584
    v_mul_lo_u32 v3, v3, s4
    v_lshl_add_u32 v3, v2, 4, v3
    s_lshl_b32 s83, s77, 8
    v_add_u32 v9, s83, v3
    v_add_u32 v10, 57344, v9
    v_add_u32 v11, 114688, v9
    v_add_u32 v12, 172032, v9
    s_mov_b32 s68, s28
    s_mov_b32 s69, s29
    s_mov_b32 s70, 1835008
    s_mov_b32 s71, 0x00020000
    s_mov_b32 s81, 1792
    s_add_u32 m0, s79, 131072
    s_nop 0
    buffer_load_dwordx4 v9, s[68:71], s81 offen lds
    s_add_u32 m0, s79, 135168
    s_nop 0
    buffer_load_dwordx4 v10, s[68:71], s81 offen lds
    s_add_u32 m0, s79, 139264
    s_nop 0
    buffer_load_dwordx4 v11, s[68:71], s81 offen lds
    s_add_u32 m0, s79, 143360
    s_nop 0
    buffer_load_dwordx4 v12, s[68:71], s81 offen lds
    s_waitcnt vmcnt(18)
    s_barrier
    s_waitcnt vmcnt(16)
    s_barrier
    s_waitcnt vmcnt(14)
    s_barrier
    s_waitcnt vmcnt(12)
    s_barrier
    s_waitcnt vmcnt(10)
    s_barrier
    s_waitcnt vmcnt(8)
    s_barrier
    s_waitcnt vmcnt(6)
    s_barrier
    s_waitcnt vmcnt(4)
    s_barrier
    s_barrier
    s_cmp_eq_u32 s77, 7
    s_cbranch_scc1 sequential_preLN__grouped_kv_mqa__mixer_gmlp__prompt_kernel_l6pre
    s_mov_b32 s81, 231168
    s_add_u32 m0, s79, 65536
    s_nop 0
    buffer_load_dwordx4 v9, s[68:71], s81 offen lds
    s_add_u32 m0, s79, 69632
    s_nop 0
    buffer_load_dwordx4 v10, s[68:71], s81 offen lds
    s_add_u32 m0, s79, 73728
    s_nop 0
    buffer_load_dwordx4 v11, s[68:71], s81 offen lds
    s_add_u32 m0, s79, 77824
    s_nop 0
    buffer_load_dwordx4 v12, s[68:71], s81 offen lds
    s_mov_b32 s81, 460544
    s_add_u32 m0, s79, 81920
    s_nop 0
    buffer_load_dwordx4 v9, s[68:71], s81 offen lds
    s_add_u32 m0, s79, 86016
    s_nop 0
    buffer_load_dwordx4 v10, s[68:71], s81 offen lds
    s_add_u32 m0, s79, 90112
    s_nop 0
    buffer_load_dwordx4 v11, s[68:71], s81 offen lds
    s_add_u32 m0, s79, 94208
    s_nop 0
    buffer_load_dwordx4 v12, s[68:71], s81 offen lds
    s_mov_b32 s81, 689920
    s_add_u32 m0, s79, 98304
    s_nop 0
    buffer_load_dwordx4 v9, s[68:71], s81 offen lds
    s_add_u32 m0, s79, 102400
    s_nop 0
    buffer_load_dwordx4 v10, s[68:71], s81 offen lds
    s_add_u32 m0, s79, 106496
    s_nop 0
    buffer_load_dwordx4 v11, s[68:71], s81 offen lds
    s_add_u32 m0, s79, 110592
    s_nop 0
    buffer_load_dwordx4 v12, s[68:71], s81 offen lds
    s_mov_b32 s81, 919296
    s_add_u32 m0, s79, 114688
    s_nop 0
    buffer_load_dwordx4 v9, s[68:71], s81 offen lds
    s_add_u32 m0, s79, 118784
    s_nop 0
    buffer_load_dwordx4 v10, s[68:71], s81 offen lds
    s_add_u32 m0, s79, 122880
    s_nop 0
    buffer_load_dwordx4 v11, s[68:71], s81 offen lds
    s_add_u32 m0, s79, 126976
    s_nop 0
    buffer_load_dwordx4 v12, s[68:71], s81 offen lds
    s_add_u32 s56, s40, 5242880
    s_addc_u32 s57, s41, 0
    s_mov_b32 s58, 2097152
    s_mov_b32 s59, 0x00020000
    s_and_b32 s4, s51, 1
    s_lshl_b32 s4, s4, 2
    v_lshrrev_b32 v2, 4, v1
    v_add_u32 v2, s4, v2
    v_and_b32 v2, 7, v2
    v_and_b32 v3, 7, v1
    v_xor_b32 v2, v2, v3
    v_lshlrev_b32 v2, 4, v2
    s_lshl_b32 s5, s51, 3
    s_add_u32 s5, s5, s78
    v_lshrrev_b32 v3, 3, v1
    v_add_u32 v3, s5, v3
    s_mov_b32 s4, 1024
    v_mul_lo_u32 v3, v3, s4
    v_add_u32 v7, v2, v3
    v_add_u32 v8, 32768, v7
    s_barrier
    s_mov_b32 s80, 0
    s_add_u32 m0, s79, 0
    s_nop 0
    buffer_load_dwordx4 v7, s[56:59], s80 offen sc1 lds
    s_add_u32 m0, s79, 4096
    s_nop 0
    buffer_load_dwordx4 v8, s[56:59], s80 offen sc1 lds
    s_mov_b32 s80, 128
    s_add_u32 m0, s79, 8192
    s_nop 0
    buffer_load_dwordx4 v7, s[56:59], s80 offen sc1 lds
    s_add_u32 m0, s79, 12288
    s_nop 0
    buffer_load_dwordx4 v8, s[56:59], s80 offen sc1 lds
    s_mov_b32 s80, 256
    s_add_u32 m0, s79, 16384
    s_nop 0
    buffer_load_dwordx4 v7, s[56:59], s80 offen sc1 lds
    s_add_u32 m0, s79, 20480
    s_nop 0
    buffer_load_dwordx4 v8, s[56:59], s80 offen sc1 lds
    s_mov_b32 s80, 384
    s_add_u32 m0, s79, 24576
    s_nop 0
    buffer_load_dwordx4 v7, s[56:59], s80 offen sc1 lds
    s_add_u32 m0, s79, 28672
    s_nop 0
    buffer_load_dwordx4 v8, s[56:59], s80 offen sc1 lds
    s_mov_b32 s80, 512
    s_add_u32 m0, s79, 32768
    s_nop 0
    buffer_load_dwordx4 v7, s[56:59], s80 offen sc1 lds
    s_add_u32 m0, s79, 36864
    s_nop 0
    buffer_load_dwordx4 v8, s[56:59], s80 offen sc1 lds
    s_mov_b32 s80, 640
    s_add_u32 m0, s79, 40960
    s_nop 0
    buffer_load_dwordx4 v7, s[56:59], s80 offen sc1 lds
    s_add_u32 m0, s79, 45056
    s_nop 0
    buffer_load_dwordx4 v8, s[56:59], s80 offen sc1 lds
    s_mov_b32 s80, 768
    s_add_u32 m0, s79, 49152
    s_nop 0
    buffer_load_dwordx4 v7, s[56:59], s80 offen sc1 lds
    s_add_u32 m0, s79, 53248
    s_nop 0
    buffer_load_dwordx4 v8, s[56:59], s80 offen sc1 lds
    s_mov_b32 s80, 896
    s_add_u32 m0, s79, 57344
    s_nop 0
    buffer_load_dwordx4 v7, s[56:59], s80 offen sc1 lds
    s_add_u32 m0, s79, 61440
    s_nop 0
    buffer_load_dwordx4 v8, s[56:59], s80 offen sc1 lds
    s_waitcnt vmcnt(14)
    s_barrier
    s_waitcnt vmcnt(12)
    s_barrier
    s_mov_b32 s81, 1148672
    s_add_u32 m0, s79, 131072
    s_nop 0
    buffer_load_dwordx4 v9, s[68:71], s81 offen lds
    s_add_u32 m0, s79, 135168
    s_nop 0
    buffer_load_dwordx4 v10, s[68:71], s81 offen lds
    s_add_u32 m0, s79, 139264
    s_nop 0
    buffer_load_dwordx4 v11, s[68:71], s81 offen lds
    s_add_u32 m0, s79, 143360
    s_nop 0
    buffer_load_dwordx4 v12, s[68:71], s81 offen lds
    s_waitcnt vmcnt(14)
    s_barrier
    s_mov_b32 s81, 1378048
    s_add_u32 m0, s79, 65536
    s_nop 0
    buffer_load_dwordx4 v9, s[68:71], s81 offen lds
    s_add_u32 m0, s79, 69632
    s_nop 0
    buffer_load_dwordx4 v10, s[68:71], s81 offen lds
    s_add_u32 m0, s79, 73728
    s_nop 0
    buffer_load_dwordx4 v11, s[68:71], s81 offen lds
    s_add_u32 m0, s79, 77824
    s_nop 0
    buffer_load_dwordx4 v12, s[68:71], s81 offen lds
    s_waitcnt vmcnt(16)
    s_barrier
    s_mov_b32 s81, 1607424
    s_add_u32 m0, s79, 81920
    s_nop 0
    buffer_load_dwordx4 v9, s[68:71], s81 offen lds
    s_add_u32 m0, s79, 86016
    s_nop 0
    buffer_load_dwordx4 v10, s[68:71], s81 offen lds
    s_add_u32 m0, s79, 90112
    s_nop 0
    buffer_load_dwordx4 v11, s[68:71], s81 offen lds
    s_add_u32 m0, s79, 94208
    s_nop 0
    buffer_load_dwordx4 v12, s[68:71], s81 offen lds
    s_waitcnt vmcnt(18)
    s_barrier
    s_mov_b32 s81, 0
    s_add_u32 m0, s79, 98304
    s_nop 0
    buffer_load_dwordx4 v9, s[68:71], s81 offen lds
    s_add_u32 m0, s79, 102400
    s_nop 0
    buffer_load_dwordx4 v10, s[68:71], s81 offen lds
    s_add_u32 m0, s79, 106496
    s_nop 0
    buffer_load_dwordx4 v11, s[68:71], s81 offen lds
    s_add_u32 m0, s79, 110592
    s_nop 0
    buffer_load_dwordx4 v12, s[68:71], s81 offen lds
    s_waitcnt vmcnt(12)
    s_barrier
    s_mov_b32 s81, 229376
    s_add_u32 m0, s79, 114688
    s_nop 0
    buffer_load_dwordx4 v9, s[68:71], s81 offen lds
    s_add_u32 m0, s79, 118784
    s_nop 0
    buffer_load_dwordx4 v10, s[68:71], s81 offen lds
    s_add_u32 m0, s79, 122880
    s_nop 0
    buffer_load_dwordx4 v11, s[68:71], s81 offen lds
    s_add_u32 m0, s79, 126976
    s_nop 0
    buffer_load_dwordx4 v12, s[68:71], s81 offen lds
    s_waitcnt vmcnt(12)
    s_barrier
    s_mov_b32 s81, 458752
    s_add_u32 m0, s79, 131072
    s_nop 0
    buffer_load_dwordx4 v9, s[68:71], s81 offen lds
    s_add_u32 m0, s79, 135168
    s_nop 0
    buffer_load_dwordx4 v10, s[68:71], s81 offen lds
    s_add_u32 m0, s79, 139264
    s_nop 0
    buffer_load_dwordx4 v11, s[68:71], s81 offen lds
    s_add_u32 m0, s79, 143360
    s_nop 0
    buffer_load_dwordx4 v12, s[68:71], s81 offen lds
    s_waitcnt vmcnt(12)
    s_barrier
    s_mov_b32 s81, 688128
    s_add_u32 m0, s79, 65536
    s_nop 0
    buffer_load_dwordx4 v9, s[68:71], s81 offen lds
    s_add_u32 m0, s79, 69632
    s_nop 0
    buffer_load_dwordx4 v10, s[68:71], s81 offen lds
    s_add_u32 m0, s79, 73728
    s_nop 0
    buffer_load_dwordx4 v11, s[68:71], s81 offen lds
    s_add_u32 m0, s79, 77824
    s_nop 0
    buffer_load_dwordx4 v12, s[68:71], s81 offen lds
    s_waitcnt vmcnt(12)
    s_barrier
    s_mov_b32 s81, 917504
    s_add_u32 m0, s79, 81920
    s_nop 0
    buffer_load_dwordx4 v9, s[68:71], s81 offen lds
    s_add_u32 m0, s79, 86016
    s_nop 0
    buffer_load_dwordx4 v10, s[68:71], s81 offen lds
    s_add_u32 m0, s79, 90112
    s_nop 0
    buffer_load_dwordx4 v11, s[68:71], s81 offen lds
    s_add_u32 m0, s79, 94208
    s_nop 0
    buffer_load_dwordx4 v12, s[68:71], s81 offen lds
    s_waitcnt vmcnt(12)
    s_barrier
    s_mov_b32 s81, 1146880
    s_add_u32 m0, s79, 98304
    s_nop 0
    buffer_load_dwordx4 v9, s[68:71], s81 offen lds
    s_add_u32 m0, s79, 102400
    s_nop 0
    buffer_load_dwordx4 v10, s[68:71], s81 offen lds
    s_add_u32 m0, s79, 106496
    s_nop 0
    buffer_load_dwordx4 v11, s[68:71], s81 offen lds
    s_add_u32 m0, s79, 110592
    s_nop 0
    buffer_load_dwordx4 v12, s[68:71], s81 offen lds
    s_waitcnt vmcnt(12)
    s_barrier
    s_mov_b32 s81, 1376256
    s_add_u32 m0, s79, 114688
    s_nop 0
    buffer_load_dwordx4 v9, s[68:71], s81 offen lds
    s_add_u32 m0, s79, 118784
    s_nop 0
    buffer_load_dwordx4 v10, s[68:71], s81 offen lds
    s_add_u32 m0, s79, 122880
    s_nop 0
    buffer_load_dwordx4 v11, s[68:71], s81 offen lds
    s_add_u32 m0, s79, 126976
    s_nop 0
    buffer_load_dwordx4 v12, s[68:71], s81 offen lds
    s_waitcnt vmcnt(12)
    s_barrier
    s_mov_b32 s81, 1605632
    s_add_u32 m0, s79, 131072
    s_nop 0
    buffer_load_dwordx4 v9, s[68:71], s81 offen lds
    s_add_u32 m0, s79, 135168
    s_nop 0
    buffer_load_dwordx4 v10, s[68:71], s81 offen lds
    s_add_u32 m0, s79, 139264
    s_nop 0
    buffer_load_dwordx4 v11, s[68:71], s81 offen lds
    s_add_u32 m0, s79, 143360
    s_nop 0
    buffer_load_dwordx4 v12, s[68:71], s81 offen lds
    s_waitcnt vmcnt(12)
    s_barrier
    s_waitcnt vmcnt(8)
    s_barrier
    s_waitcnt vmcnt(4)
    s_barrier
    s_waitcnt vmcnt(0)
    s_barrier
    s_barrier
    s_and_b32 s4, s51, 1
    s_lshl_b32 s4, s4, 2
    v_lshrrev_b32 v2, 4, v1
    v_add_u32 v2, s4, v2
    v_and_b32 v2, 7, v2
    v_and_b32 v3, 7, v1
    v_xor_b32 v2, v2, v3
    v_lshlrev_b32 v2, 4, v2
    s_lshl_b32 s5, s51, 3
    s_add_u32 s5, s5, s78
    v_lshrrev_b32 v3, 3, v1
    v_add_u32 v3, s5, v3
    s_mov_b32 s4, 4096
    v_mul_lo_u32 v3, v3, s4
    v_add_u32 v7, v2, v3
    v_add_u32 v8, 131072, v7
    s_mov_b32 s56, s30
    s_mov_b32 s57, s31
    s_mov_b32 s58, 8388608
    s_mov_b32 s59, 0x00020000
    s_add_u32 s80, s27, 0
    s_and_b32 s80, s80, 31
    s_lshl_b32 s80, s80, 7
    s_add_u32 m0, s79, 0
    s_nop 0
    buffer_load_dwordx4 v7, s[56:59], s80 offen lds
    s_add_u32 m0, s79, 4096
    s_nop 0
    buffer_load_dwordx4 v8, s[56:59], s80 offen lds
    s_add_u32 s80, s27, 1
    s_and_b32 s80, s80, 31
    s_lshl_b32 s80, s80, 7
    s_add_u32 m0, s79, 8192
    s_nop 0
    buffer_load_dwordx4 v7, s[56:59], s80 offen lds
    s_add_u32 m0, s79, 12288
    s_nop 0
    buffer_load_dwordx4 v8, s[56:59], s80 offen lds
    s_add_u32 s80, s27, 2
    s_and_b32 s80, s80, 31
    s_lshl_b32 s80, s80, 7
    s_add_u32 m0, s79, 16384
    s_nop 0
    buffer_load_dwordx4 v7, s[56:59], s80 offen lds
    s_add_u32 m0, s79, 20480
    s_nop 0
    buffer_load_dwordx4 v8, s[56:59], s80 offen lds
    s_add_u32 s80, s27, 3
    s_and_b32 s80, s80, 31
    s_lshl_b32 s80, s80, 7
    s_add_u32 m0, s79, 24576
    s_nop 0
    buffer_load_dwordx4 v7, s[56:59], s80 offen lds
    s_add_u32 m0, s79, 28672
    s_nop 0
    buffer_load_dwordx4 v8, s[56:59], s80 offen lds
    ds_write_b128 v248, v[24:27] offset:32768
    ds_write_b128 v248, v[28:31] offset:36864
    ds_write_b128 v248, v[32:35] offset:40960
    ds_write_b128 v248, v[36:39] offset:45056
    ds_write_b128 v248, v[40:43] offset:49152
    ds_write_b128 v248, v[44:47] offset:53248
    ds_write_b128 v248, v[48:51] offset:57344
    ds_write_b128 v248, v[52:55] offset:61440
    s_barrier
    s_waitcnt vmcnt(0)
    s_waitcnt lgkmcnt(0)
    s_barrier
    s_waitcnt lgkmcnt(0)
    s_barrier
    ds_write_b128 v248, v[56:59] offset:0
    ds_write_b128 v248, v[60:63] offset:4096
    s_waitcnt lgkmcnt(0)
    s_barrier
    ds_write_b128 v248, v[64:67] offset:8192
    ds_write_b128 v248, v[68:71] offset:12288
    ds_write_b128 v248, v[72:75] offset:16384
    ds_write_b128 v248, v[76:79] offset:20480
    s_waitcnt lgkmcnt(0)
    s_barrier
    ds_write_b128 v248, v[80:83] offset:24576
    ds_write_b128 v248, v[84:87] offset:28672
    ds_write_b128 v248, v[88:91] offset:32768
    ds_write_b128 v248, v[92:95] offset:36864
    s_waitcnt lgkmcnt(0)
    s_barrier
    ds_write_b128 v248, v[96:99] offset:40960
    ds_write_b128 v248, v[100:103] offset:45056
    ds_write_b128 v248, v[104:107] offset:49152
    ds_write_b128 v248, v[108:111] offset:53248
    s_waitcnt lgkmcnt(0)
    s_barrier
    ds_write_b128 v248, v[112:115] offset:57344
    ds_write_b128 v248, v[116:119] offset:61440
    ds_write_b128 v248, v[120:123] offset:0
    ds_write_b128 v248, v[124:127] offset:4096
    s_waitcnt lgkmcnt(0)
    s_barrier
    ds_write_b128 v248, v[128:131] offset:8192
    ds_write_b128 v248, v[132:135] offset:12288
    ds_write_b128 v248, v[136:139] offset:16384
    ds_write_b128 v248, v[140:143] offset:20480
    s_waitcnt lgkmcnt(0)
    s_barrier
    ds_write_b128 v248, v[144:147] offset:24576
    ds_write_b128 v248, v[148:151] offset:28672
    ds_write_b128 v248, v[152:155] offset:32768
    ds_write_b128 v248, v[156:159] offset:36864
    s_waitcnt lgkmcnt(0)
    s_barrier
    ds_write_b128 v248, v[160:163] offset:40960
    ds_write_b128 v248, v[164:167] offset:45056
    ds_write_b128 v248, v[168:171] offset:49152
    ds_write_b128 v248, v[172:175] offset:53248
    s_waitcnt lgkmcnt(0)
    s_barrier
    ds_write_b128 v248, v[176:179] offset:57344
    ds_write_b128 v248, v[180:183] offset:61440
    ds_write_b128 v248, v[184:187] offset:0
    ds_write_b128 v248, v[188:191] offset:4096
    s_waitcnt lgkmcnt(0)
    s_barrier
    ds_write_b128 v248, v[192:195] offset:8192
    ds_write_b128 v248, v[196:199] offset:12288
    ds_write_b128 v248, v[200:203] offset:16384
    ds_write_b128 v248, v[204:207] offset:20480
    s_waitcnt lgkmcnt(0)
    s_barrier
    ds_write_b128 v248, v[208:211] offset:24576
    ds_write_b128 v248, v[212:215] offset:28672
    ds_write_b128 v248, v[216:219] offset:32768
    ds_write_b128 v248, v[220:223] offset:36864
    s_waitcnt lgkmcnt(0)
    s_barrier
    ds_write_b128 v248, v[224:227] offset:40960
    ds_write_b128 v248, v[228:231] offset:45056
    ds_write_b128 v248, v[232:235] offset:49152
    ds_write_b128 v248, v[236:239] offset:53248
    s_waitcnt lgkmcnt(0)
    s_barrier
    ds_write_b128 v248, v[240:243] offset:57344
    ds_write_b128 v248, v[244:247] offset:61440
    s_waitcnt lgkmcnt(0)
    s_barrier
    s_waitcnt lgkmcnt(0)
    s_barrier
    s_waitcnt lgkmcnt(0)
    s_barrier
    s_barrier
sequential_preLN__grouped_kv_mqa__mixer_gmlp__prompt_kernel_l6pre:
    s_and_b32 s4, s51, 1
    s_lshl_b32 s4, s4, 1
    v_bfe_u32 v2, v1, 4, 1
    v_or_b32 v2, s4, v2
    v_lshlrev_b32 v2, 1, v2
    v_and_b32 v3, 7, v1
    v_xor_b32 v2, v2, v3
    v_lshrrev_b32 v3, 3, v1
    s_mul_i32 s5, s51, 8
    v_add_u32 v3, s5, v3
    s_mov_b32 s4, 1024
    v_mul_lo_u32 v3, v3, s4
    v_lshl_add_u32 v3, v2, 4, v3
    s_lshl_b32 s83, s46, 7
    v_add_u32 v9, s83, v3
    v_add_u32 v10, 32768, v9
    s_mov_b32 s68, s34
    s_mov_b32 s69, s35
    s_mov_b32 s70, 917504
    s_mov_b32 s71, 0x00020000
    s_and_b32 s4, s51, 1
    s_lshl_b32 s4, s4, 2
    v_lshrrev_b32 v2, 4, v1
    v_add_u32 v2, s4, v2
    v_and_b32 v2, 7, v2
    v_and_b32 v3, 7, v1
    v_xor_b32 v2, v2, v3
    v_lshlrev_b32 v2, 4, v2
    s_lshl_b32 s5, s51, 3
    s_add_u32 s5, s5, s47
    v_lshrrev_b32 v3, 3, v1
    v_add_u32 v3, s5, v3
    s_mov_b32 s4, 1792
    v_mul_lo_u32 v3, v3, s4
    v_add_u32 v7, v2, v3
    v_add_u32 v8, 57344, v7
    s_add_u32 s56, s40, 20971520
    s_addc_u32 s57, s41, 0
    s_mov_b32 s58, 3670016
    s_mov_b32 s59, 0x00020000
    s_lshl_b32 s87, s46, 1
    s_cmp_ge_u32 s87, 14
    s_cselect_b32 s87, 0, s87
    s_add_u32 s81, s87, 0
    s_sub_u32 s88, s81, 14
    s_cmp_ge_u32 s81, 14
    s_cselect_b32 s81, s88, s81
    s_mul_i32 s81, s81, 65536
    s_add_u32 m0, s79, 114688
    s_nop 0
    buffer_load_dwordx4 v9, s[68:71], s81 offen lds
    s_add_u32 m0, s79, 118784
    s_nop 0
    buffer_load_dwordx4 v10, s[68:71], s81 offen lds
    s_add_u32 s81, s87, 1
    s_sub_u32 s88, s81, 14
    s_cmp_ge_u32 s81, 14
    s_cselect_b32 s81, s88, s81
    s_mul_i32 s81, s81, 65536
    s_add_u32 m0, s79, 122880
    s_nop 0
    buffer_load_dwordx4 v9, s[68:71], s81 offen lds
    s_add_u32 m0, s79, 126976
    s_nop 0
    buffer_load_dwordx4 v10, s[68:71], s81 offen lds
    s_add_u32 s81, s87, 2
    s_sub_u32 s88, s81, 14
    s_cmp_ge_u32 s81, 14
    s_cselect_b32 s81, s88, s81
    s_mul_i32 s81, s81, 65536
    s_add_u32 m0, s79, 131072
    s_nop 0
    buffer_load_dwordx4 v9, s[68:71], s81 offen lds
    s_add_u32 m0, s79, 135168
    s_nop 0
    buffer_load_dwordx4 v10, s[68:71], s81 offen lds
    s_add_u32 s81, s87, 3
    s_sub_u32 s88, s81, 14
    s_cmp_ge_u32 s81, 14
    s_cselect_b32 s81, s88, s81
    s_mul_i32 s81, s81, 65536
    s_add_u32 m0, s79, 139264
    s_nop 0
    buffer_load_dwordx4 v9, s[68:71], s81 offen lds
    s_add_u32 m0, s79, 143360
    s_nop 0
    buffer_load_dwordx4 v10, s[68:71], s81 offen lds
    s_add_u32 s81, s87, 4
    s_sub_u32 s88, s81, 14
    s_cmp_ge_u32 s81, 14
    s_cselect_b32 s81, s88, s81
    s_mul_i32 s81, s81, 65536
    s_add_u32 m0, s79, 147456
    s_nop 0
    buffer_load_dwordx4 v9, s[68:71], s81 offen lds
    s_add_u32 m0, s79, 151552
    s_nop 0
    buffer_load_dwordx4 v10, s[68:71], s81 offen lds
    s_barrier
    s_add_u32 s80, s87, 0
    s_sub_u32 s88, s80, 14
    s_cmp_ge_u32 s80, 14
    s_cselect_b32 s80, s88, s80
    s_lshl_b32 s80, s80, 7
    s_add_u32 m0, s79, 0
    s_nop 0
    buffer_load_dwordx4 v7, s[56:59], s80 offen sc1 lds
    s_add_u32 m0, s79, 4096
    s_nop 0
    buffer_load_dwordx4 v8, s[56:59], s80 offen sc1 lds
    s_add_u32 s80, s87, 1
    s_sub_u32 s88, s80, 14
    s_cmp_ge_u32 s80, 14
    s_cselect_b32 s80, s88, s80
    s_lshl_b32 s80, s80, 7
    s_add_u32 m0, s79, 8192
    s_nop 0
    buffer_load_dwordx4 v7, s[56:59], s80 offen sc1 lds
    s_add_u32 m0, s79, 12288
    s_nop 0
    buffer_load_dwordx4 v8, s[56:59], s80 offen sc1 lds
    s_add_u32 s80, s87, 2
    s_sub_u32 s88, s80, 14
    s_cmp_ge_u32 s80, 14
    s_cselect_b32 s80, s88, s80
    s_lshl_b32 s80, s80, 7
    s_add_u32 m0, s79, 16384
    s_nop 0
    buffer_load_dwordx4 v7, s[56:59], s80 offen sc1 lds
    s_add_u32 m0, s79, 20480
    s_nop 0
    buffer_load_dwordx4 v8, s[56:59], s80 offen sc1 lds
    s_add_u32 s80, s87, 3
    s_sub_u32 s88, s80, 14
    s_cmp_ge_u32 s80, 14
    s_cselect_b32 s80, s88, s80
    s_lshl_b32 s80, s80, 7
    s_add_u32 m0, s79, 24576
    s_nop 0
    buffer_load_dwordx4 v7, s[56:59], s80 offen sc1 lds
    s_add_u32 m0, s79, 28672
    s_nop 0
    buffer_load_dwordx4 v8, s[56:59], s80 offen sc1 lds
    s_add_u32 s80, s87, 4
    s_sub_u32 s88, s80, 14
    s_cmp_ge_u32 s80, 14
    s_cselect_b32 s80, s88, s80
    s_lshl_b32 s80, s80, 7
    s_add_u32 m0, s79, 32768
    s_nop 0
    buffer_load_dwordx4 v7, s[56:59], s80 offen sc1 lds
    s_add_u32 m0, s79, 36864
    s_nop 0
    buffer_load_dwordx4 v8, s[56:59], s80 offen sc1 lds
    s_add_u32 s80, s87, 5
    s_sub_u32 s88, s80, 14
    s_cmp_ge_u32 s80, 14
    s_cselect_b32 s80, s88, s80
    s_lshl_b32 s80, s80, 7
    s_add_u32 m0, s79, 40960
    s_nop 0
    buffer_load_dwordx4 v7, s[56:59], s80 offen sc1 lds
    s_add_u32 m0, s79, 45056
    s_nop 0
    buffer_load_dwordx4 v8, s[56:59], s80 offen sc1 lds
    s_add_u32 s80, s87, 6
    s_sub_u32 s88, s80, 14
    s_cmp_ge_u32 s80, 14
    s_cselect_b32 s80, s88, s80
    s_lshl_b32 s80, s80, 7
    s_add_u32 m0, s79, 49152
    s_nop 0
    buffer_load_dwordx4 v7, s[56:59], s80 offen sc1 lds
    s_add_u32 m0, s79, 53248
    s_nop 0
    buffer_load_dwordx4 v8, s[56:59], s80 offen sc1 lds
    s_add_u32 s80, s87, 7
    s_sub_u32 s88, s80, 14
    s_cmp_ge_u32 s80, 14
    s_cselect_b32 s80, s88, s80
    s_lshl_b32 s80, s80, 7
    s_add_u32 m0, s79, 57344
    s_nop 0
    buffer_load_dwordx4 v7, s[56:59], s80 offen sc1 lds
    s_add_u32 m0, s79, 61440
    s_nop 0
    buffer_load_dwordx4 v8, s[56:59], s80 offen sc1 lds
    s_add_u32 s80, s87, 8
    s_sub_u32 s88, s80, 14
    s_cmp_ge_u32 s80, 14
    s_cselect_b32 s80, s88, s80
    s_lshl_b32 s80, s80, 7
    s_add_u32 m0, s79, 65536
    s_nop 0
    buffer_load_dwordx4 v7, s[56:59], s80 offen sc1 lds
    s_add_u32 m0, s79, 69632
    s_nop 0
    buffer_load_dwordx4 v8, s[56:59], s80 offen sc1 lds
    s_add_u32 s80, s87, 9
    s_sub_u32 s88, s80, 14
    s_cmp_ge_u32 s80, 14
    s_cselect_b32 s80, s88, s80
    s_lshl_b32 s80, s80, 7
    s_add_u32 m0, s79, 73728
    s_nop 0
    buffer_load_dwordx4 v7, s[56:59], s80 offen sc1 lds
    s_add_u32 m0, s79, 77824
    s_nop 0
    buffer_load_dwordx4 v8, s[56:59], s80 offen sc1 lds
    s_add_u32 s80, s87, 10
    s_sub_u32 s88, s80, 14
    s_cmp_ge_u32 s80, 14
    s_cselect_b32 s80, s88, s80
    s_lshl_b32 s80, s80, 7
    s_add_u32 m0, s79, 81920
    s_nop 0
    buffer_load_dwordx4 v7, s[56:59], s80 offen sc1 lds
    s_add_u32 m0, s79, 86016
    s_nop 0
    buffer_load_dwordx4 v8, s[56:59], s80 offen sc1 lds
    s_add_u32 s80, s87, 11
    s_sub_u32 s88, s80, 14
    s_cmp_ge_u32 s80, 14
    s_cselect_b32 s80, s88, s80
    s_lshl_b32 s80, s80, 7
    s_add_u32 m0, s79, 90112
    s_nop 0
    buffer_load_dwordx4 v7, s[56:59], s80 offen sc1 lds
    s_add_u32 m0, s79, 94208
    s_nop 0
    buffer_load_dwordx4 v8, s[56:59], s80 offen sc1 lds
    s_add_u32 s80, s87, 12
    s_sub_u32 s88, s80, 14
    s_cmp_ge_u32 s80, 14
    s_cselect_b32 s80, s88, s80
    s_lshl_b32 s80, s80, 7
    s_add_u32 m0, s79, 98304
    s_nop 0
    buffer_load_dwordx4 v7, s[56:59], s80 offen sc1 lds
    s_add_u32 m0, s79, 102400
    s_nop 0
    buffer_load_dwordx4 v8, s[56:59], s80 offen sc1 lds
    s_add_u32 s80, s87, 13
    s_sub_u32 s88, s80, 14
    s_cmp_ge_u32 s80, 14
    s_cselect_b32 s80, s88, s80
    s_lshl_b32 s80, s80, 7
    s_add_u32 m0, s79, 106496
    s_nop 0
    buffer_load_dwordx4 v7, s[56:59], s80 offen sc1 lds
    s_add_u32 m0, s79, 110592
    s_nop 0
    buffer_load_dwordx4 v8, s[56:59], s80 offen sc1 lds
    s_waitcnt vmcnt(26)
    s_barrier
    s_waitcnt vmcnt(24)
    s_barrier
    s_add_u32 s81, s87, 5
    s_sub_u32 s88, s81, 14
    s_cmp_ge_u32 s81, 14
    s_cselect_b32 s81, s88, s81
    s_mul_i32 s81, s81, 65536
    s_add_u32 m0, s79, 114688
    s_nop 0
    buffer_load_dwordx4 v9, s[68:71], s81 offen lds
    s_add_u32 m0, s79, 118784
    s_nop 0
    buffer_load_dwordx4 v10, s[68:71], s81 offen lds
    s_waitcnt vmcnt(24)
    s_barrier
    s_add_u32 s81, s87, 6
    s_sub_u32 s88, s81, 14
    s_cmp_ge_u32 s81, 14
    s_cselect_b32 s81, s88, s81
    s_mul_i32 s81, s81, 65536
    s_add_u32 m0, s79, 122880
    s_nop 0
    buffer_load_dwordx4 v9, s[68:71], s81 offen lds
    s_add_u32 m0, s79, 126976
    s_nop 0
    buffer_load_dwordx4 v10, s[68:71], s81 offen lds
    s_waitcnt vmcnt(24)
    s_barrier
    s_add_u32 s81, s87, 7
    s_sub_u32 s88, s81, 14
    s_cmp_ge_u32 s81, 14
    s_cselect_b32 s81, s88, s81
    s_mul_i32 s81, s81, 65536
    s_add_u32 m0, s79, 131072
    s_nop 0
    buffer_load_dwordx4 v9, s[68:71], s81 offen lds
    s_add_u32 m0, s79, 135168
    s_nop 0
    buffer_load_dwordx4 v10, s[68:71], s81 offen lds
    s_waitcnt vmcnt(24)
    s_barrier
    s_add_u32 s81, s87, 8
    s_sub_u32 s88, s81, 14
    s_cmp_ge_u32 s81, 14
    s_cselect_b32 s81, s88, s81
    s_mul_i32 s81, s81, 65536
    s_add_u32 m0, s79, 139264
    s_nop 0
    buffer_load_dwordx4 v9, s[68:71], s81 offen lds
    s_add_u32 m0, s79, 143360
    s_nop 0
    buffer_load_dwordx4 v10, s[68:71], s81 offen lds
    s_waitcnt vmcnt(6)
    s_barrier
    s_add_u32 s81, s87, 9
    s_sub_u32 s88, s81, 14
    s_cmp_ge_u32 s81, 14
    s_cselect_b32 s81, s88, s81
    s_mul_i32 s81, s81, 65536
    s_add_u32 m0, s79, 147456
    s_nop 0
    buffer_load_dwordx4 v9, s[68:71], s81 offen lds
    s_add_u32 m0, s79, 151552
    s_nop 0
    buffer_load_dwordx4 v10, s[68:71], s81 offen lds
    s_waitcnt vmcnt(6)
    s_barrier
    s_add_u32 s81, s87, 10
    s_sub_u32 s88, s81, 14
    s_cmp_ge_u32 s81, 14
    s_cselect_b32 s81, s88, s81
    s_mul_i32 s81, s81, 65536
    s_add_u32 m0, s79, 114688
    s_nop 0
    buffer_load_dwordx4 v9, s[68:71], s81 offen lds
    s_add_u32 m0, s79, 118784
    s_nop 0
    buffer_load_dwordx4 v10, s[68:71], s81 offen lds
    s_waitcnt vmcnt(6)
    s_barrier
    s_add_u32 s81, s87, 11
    s_sub_u32 s88, s81, 14
    s_cmp_ge_u32 s81, 14
    s_cselect_b32 s81, s88, s81
    s_mul_i32 s81, s81, 65536
    s_add_u32 m0, s79, 122880
    s_nop 0
    buffer_load_dwordx4 v9, s[68:71], s81 offen lds
    s_add_u32 m0, s79, 126976
    s_nop 0
    buffer_load_dwordx4 v10, s[68:71], s81 offen lds
    s_waitcnt vmcnt(6)
    s_barrier
    s_add_u32 s81, s87, 12
    s_sub_u32 s88, s81, 14
    s_cmp_ge_u32 s81, 14
    s_cselect_b32 s81, s88, s81
    s_mul_i32 s81, s81, 65536
    s_add_u32 m0, s79, 131072
    s_nop 0
    buffer_load_dwordx4 v9, s[68:71], s81 offen lds
    s_add_u32 m0, s79, 135168
    s_nop 0
    buffer_load_dwordx4 v10, s[68:71], s81 offen lds
    s_waitcnt vmcnt(6)
    s_barrier
    s_add_u32 s81, s87, 13
    s_sub_u32 s88, s81, 14
    s_cmp_ge_u32 s81, 14
    s_cselect_b32 s81, s88, s81
    s_mul_i32 s81, s81, 65536
    s_add_u32 m0, s79, 139264
    s_nop 0
    buffer_load_dwordx4 v9, s[68:71], s81 offen lds
    s_add_u32 m0, s79, 143360
    s_nop 0
    buffer_load_dwordx4 v10, s[68:71], s81 offen lds
    s_waitcnt vmcnt(6)
    s_barrier
    s_waitcnt vmcnt(4)
    s_barrier
    s_waitcnt vmcnt(2)
    s_barrier
    s_waitcnt vmcnt(0)
    s_barrier
    s_endpgm
sequential_preLN__grouped_kv_mqa__mixer_gmlp__prompt_kernel_end:
    s_endpgm
sequential_preLN__grouped_kv_mqa__mixer_gmlp__prompt_kernel_codeend:
    s_endpgm
.section .rodata,"a"
.p2align 6
.amdhsa_kernel sequential_preLN__grouped_kv_mqa__mixer_gmlp__prompt_kernel
  .amdhsa_next_free_vgpr 249
  .amdhsa_next_free_sgpr 89
  .amdhsa_accum_offset 252
  .amdhsa_group_segment_fixed_size 0
  .amdhsa_kernarg_size 104
  .amdhsa_user_sgpr_count 2
  .amdhsa_user_sgpr_kernarg_segment_ptr 1
  .amdhsa_system_sgpr_workgroup_id_x 1
  .amdhsa_float_denorm_mode_32 3
.end_amdhsa_kernel
```
